```python
import torch

def _softmax(x, axis=-1):
    return torch.softmax(x, dim=axis)
def _gelu(x):
    return torch.nn.functional.gelu(x, approximate="tanh")
def _silu(x):
    return torch.nn.functional.silu(x)
def _sigmoid(x):
    return torch.sigmoid(x)
def _layernorm(x, axis=-1, eps=1e-5):
    m = x.mean(dim=axis, keepdim=True)
    v = x.var(dim=axis, keepdim=True, unbiased=False)
    return (x - m) / torch.sqrt(v + eps)
def _scatter_add(tgt, idx, src, axis=0):
    return tgt.clone().index_add_(axis, idx, src)
def _segment_sum(src, seg, n):
    out = torch.zeros((n,) + src.shape[1:], dtype=src.dtype)
    return out.index_add_(0, seg, src)
def _pad(x, pw):
    flat = tuple(v for pair in reversed(pw) for v in pair)
    return torch.nn.functional.pad(x, flat)

kernel_name = 'parallel_sum__softmax_full_mha__dense_activation_silu__prompt'

def setup_inputs():

    _w = (lambda a: (lambda t: t.to(torch.bfloat16) if t.is_floating_point() else t)(torch.as_tensor(a)))
    def _A_setup():
        B, S, D = 1, 2048, 1024
        return {
            "x": _w((lambda *s: torch.randn(*s, dtype=torch.bfloat16) * 0.05)(B, S, D)),
            "wqkv": _w((lambda *s: torch.randn(*s, dtype=torch.bfloat16) * 0.05)(D, 3 * D)),
            "wo": _w((lambda *s: torch.randn(*s, dtype=torch.bfloat16) * 0.05)(D, D)),
        }
    _A_in = _A_setup()

    def _B_setup():
        B, S, D, F = 1, 2048, 1024, 3584
        return {
            "x": _w((lambda *s: torch.randn(*s, dtype=torch.bfloat16) * 0.05)(B, S, D)),
            "w1": _w((lambda *s: torch.randn(*s, dtype=torch.bfloat16) * 3.2)(D, F) * (D ** -0.5)),
            "w2": _w((lambda *s: torch.randn(*s, dtype=torch.bfloat16) * 0.4)(F, D) * (F ** -0.5)),
        }
    _B_in = _B_setup()

    return {
        "A_x": _A_in["x"],
        "A_wqkv": _A_in["wqkv"],
        "A_wo": _A_in["wo"],
        "B_x": _B_in["x"],
        "B_w1": _B_in["w1"],
        "B_w2": _B_in["w2"],
    }

def reference(A_x, A_wqkv, A_wo, B_x, B_w1, B_w2):
    def _A_ref(x, wqkv, wo):
        B, S, D = x.shape
        H = 32; Dh = D // H
        qkv = (lambda x, *d: x.permute(*d))((x @ wqkv).reshape(B, S, 3, H, Dh), 2, 0, 3, 1, 4)
        q, k, v = qkv[0], qkv[1], qkv[2]
        scale = Dh ** -0.5
        scores = torch.einsum("bhqd,bhkd->bhqk", q, k) * scale
        p = _softmax(scores, axis=-1)
        o = torch.einsum("bhqk,bhkd->bhqd", p, v)
        return (lambda x, *d: x.permute(*d))(o, 0, 2, 1, 3).reshape(B, S, D) @ wo

    def _B_ref(x, w1, w2):
        h = torch.einsum("bsd,df->bsf", x, w1)
        h = _silu(h)
        out = torch.einsum("bsf,fd->bsd", h, w2)
        return out

    x = A_x
    xn = _layernorm(x, axis=-1)
    return x + _A_ref(xn, A_wqkv, A_wo) + _B_ref(xn, B_w1, B_w2)
```

```asm
; @launch grid=(256,1,1) block=(256,1,1) lds=131328
.amdgcn_target "amdgcn-amd-amdhsa--gfx950"
.text
.globl parallel_sum__softmax_full_mha__dense_activation_silu__prompt_kernel
.p2align 8
.type parallel_sum__softmax_full_mha__dense_activation_silu__prompt_kernel,@function
parallel_sum__softmax_full_mha__dense_activation_silu__prompt_kernel:
    s_cmp_ge_u32 s2, 256
    s_cbranch_scc1 L_end
    s_load_dwordx2 s[4:5], s[0:1], 8
    s_load_dwordx2 s[6:7], s[0:1], 32
    s_load_dwordx2 s[40:41], s[0:1], 64
    s_load_dwordx2 s[44:45], s[0:1], 0
    s_load_dwordx2 s[46:47], s[0:1], 56
    v_mov_b32 v2, v0
    v_and_b32 v1, 63, v0
    v_lshrrev_b32 v3, 6, v0
    s_and_b32 s3, s2, 7
    v_readfirstlane_b32 s30, v3
    s_lshr_b32 s57, s2, 3
    s_and_b32 s48, s3, 1
    s_lshl_b32 s48, s48, 2
    s_and_b32 s34, s57, 3
    s_add_u32 s31, s48, s34
    s_lshr_b32 s3, s3, 1
    s_lshl_b32 s3, s3, 2
    s_lshr_b32 s34, s57, 2
    s_and_b32 s35, s34, 3
    s_add_u32 s3, s3, s35
    s_lshr_b32 s34, s34, 2
    s_lshl_b32 s34, s34, 4
    s_add_u32 s3, s3, s34
    s_mov_b32 s58, s3
    s_lshl_b32 s39, s31, 8
    s_lshl_b32 s34, s30, 6
    s_add_u32 s39, s39, s34
    s_waitcnt lgkmcnt(0)
    s_mov_b32 s20, s44
    s_and_b32 s21, s45, 0xffff
    s_mov_b32 s22, 4194304
    s_mov_b32 s23, 0x00020000
    s_mov_b32 s52, s46
    s_and_b32 s53, s47, 0xffff
    s_mov_b32 s54, 256
    s_mov_b32 s55, 0x00020000
    v_and_b32 v3, 7, v1
    v_lshrrev_b32 v4, 3, v1
    v_lshlrev_b32 v5, 11, v3
    v_lshl_add_u32 v5, v4, 4, v5
    s_lshl_b32 s34, s30, 9
    v_add_u32 v5, s34, v5
    s_lshl_b32 s35, s2, 14
    v_lshlrev_b32 v6, 11, v3
    buffer_load_ushort v30, v6, s[20:23], s35 offen
    buffer_load_dwordx4 v[32:35], v5, s[20:23], s35 offen offset:0
    buffer_load_dwordx4 v[36:39], v5, s[20:23], s35 offen offset:128
    buffer_load_dwordx4 v[40:43], v5, s[20:23], s35 offen offset:256
    buffer_load_dwordx4 v[44:47], v5, s[20:23], s35 offen offset:384
    s_getpc_b64 s[48:49]
L_p1_pc:
    s_sub_u32 s48, s48, L_p1_pc-parallel_sum__softmax_full_mha__dense_activation_silu__prompt_kernel
    s_subb_u32 s49, s49, 0
    s_lshl_b32 s34, s57, 2
    s_add_u32 s34, s34, s30
    s_lshl_b32 s34, s34, 9
    v_and_b32 v8, 3, v1
    v_lshlrev_b32 v8, 7, v8
    v_add_u32 v9, s34, v8
    v_min_u32 v9, L_end-parallel_sum__softmax_full_mha__dense_activation_silu__prompt_kernel, v9
    v_mov_b32 v21, s49
    v_add_co_u32 v20, vcc, s48, v9
    s_nop 1
    v_addc_co_u32 v21, vcc, 0, v21, vcc
    s_mov_b64 exec, 15
    global_load_dword a250, v[20:21], off
    s_mov_b64 exec, -1
    s_add_u32 s44, s40, 50331648
    s_addc_u32 s45, s41, 0
    s_mov_b32 s12, s44
    s_and_b32 s13, s45, 0xffff
    s_mov_b32 s14, 4259840
    s_mov_b32 s15, 0x00020000
    s_cmp_lt_u32 s3, 16
    s_cbranch_scc1 L_p1_qkv
    s_mov_b32 s33, 2
    s_sub_u32 s3, s3, 16
    s_mul_i32 s32, s3, 7
    s_mov_b32 s42, 7168
    s_mov_b32 s4, s6
    s_mov_b32 s5, s7
    s_mov_b32 s35, 7340032
    s_movk_i32 s59, 28
    s_branch L_p1_common
L_p1_qkv:
    s_mov_b32 s42, 6144
    s_mov_b32 s35, 6291456
    s_mul_i32 s32, s3, 6
    s_movk_i32 s59, 24
    s_cmp_lt_u32 s3, 10
    s_cselect_b32 s33, 0, 1
    s_cmp_eq_u32 s3, 10
    s_cselect_b32 s33, 3, s33
L_p1_common:
    s_lshl_b32 s34, s32, 6
    s_add_u32 s4, s4, s34
    s_addc_u32 s5, s5, 0
    s_sub_u32 s35, s35, s34
    s_mov_b32 s8, s4
    s_and_b32 s9, s5, 0xffff
    s_mov_b32 s10, s35
    s_mov_b32 s11, 0x00020000
    s_lshl_b32 s43, s42, 6
    s_lshl_b32 s34, s30, 4
    s_movk_i32 s36, 2341
    v_add_u32 v3, 0, v1
    v_mul_u32_u24 v4, s36, v3
    v_lshrrev_b32 v4, 16, v4
    v_mul_u32_u24 v6, 28, v4
    v_sub_u32 v6, v3, v6
    v_lshrrev_b32 v7, 3, v4
    v_lshlrev_b32 v7, 1, v7
    v_xor_b32 v6, v6, v7
    v_add_u32 v4, s34, v4
    v_mul_lo_u32 v4, v4, s42
    v_lshl_add_u32 v4, v6, 4, v4
    v_cmp_gt_u32 vcc, s59, v6
    v_mov_b32 v7, 0x7ffff000
    s_nop 0
    v_cndmask_b32 v10, v7, v4, vcc
    v_add_u32 v3, 64, v1
    v_mul_u32_u24 v4, s36, v3
    v_lshrrev_b32 v4, 16, v4
    v_mul_u32_u24 v6, 28, v4
    v_sub_u32 v6, v3, v6
    v_lshrrev_b32 v7, 3, v4
    v_lshlrev_b32 v7, 1, v7
    v_xor_b32 v6, v6, v7
    v_add_u32 v4, s34, v4
    v_mul_lo_u32 v4, v4, s42
    v_lshl_add_u32 v4, v6, 4, v4
    v_subrev_u32 v4, 1024, v4
    v_cmp_gt_u32 vcc, s59, v6
    v_mov_b32 v7, 0x7ffff000
    s_nop 0
    v_cndmask_b32 v11, v7, v4, vcc
    v_add_u32 v3, 128, v1
    v_mul_u32_u24 v4, s36, v3
    v_lshrrev_b32 v4, 16, v4
    v_mul_u32_u24 v6, 28, v4
    v_sub_u32 v6, v3, v6
    v_lshrrev_b32 v7, 3, v4
    v_lshlrev_b32 v7, 1, v7
    v_xor_b32 v6, v6, v7
    v_add_u32 v4, s34, v4
    v_mul_lo_u32 v4, v4, s42
    v_lshl_add_u32 v4, v6, 4, v4
    v_subrev_u32 v4, 2048, v4
    v_cmp_gt_u32 vcc, s59, v6
    v_mov_b32 v7, 0x7ffff000
    s_nop 0
    v_cndmask_b32 v12, v7, v4, vcc
    v_add_u32 v3, 192, v1
    v_mul_u32_u24 v4, s36, v3
    v_lshrrev_b32 v4, 16, v4
    v_mul_u32_u24 v6, 28, v4
    v_sub_u32 v6, v3, v6
    v_lshrrev_b32 v7, 3, v4
    v_lshlrev_b32 v7, 1, v7
    v_xor_b32 v6, v6, v7
    v_add_u32 v4, s34, v4
    v_mul_lo_u32 v4, v4, s42
    v_lshl_add_u32 v4, v6, 4, v4
    v_subrev_u32 v4, 3072, v4
    v_cmp_gt_u32 vcc, s59, v6
    v_mov_b32 v7, 0x7ffff000
    s_nop 0
    v_cndmask_b32 v13, v7, v4, vcc
    v_add_u32 v3, 256, v1
    v_mul_u32_u24 v4, s36, v3
    v_lshrrev_b32 v4, 16, v4
    v_mul_u32_u24 v6, 28, v4
    v_sub_u32 v6, v3, v6
    v_lshrrev_b32 v7, 3, v4
    v_lshlrev_b32 v7, 1, v7
    v_xor_b32 v6, v6, v7
    v_add_u32 v4, s34, v4
    v_mul_lo_u32 v4, v4, s42
    v_lshl_add_u32 v4, v6, 4, v4
    v_cmp_gt_u32 vcc, s59, v6
    v_mov_b32 v7, 0x7ffff000
    s_nop 0
    v_cndmask_b32 v14, v7, v4, vcc
    v_add_u32 v3, 320, v1
    v_mul_u32_u24 v4, s36, v3
    v_lshrrev_b32 v4, 16, v4
    v_mul_u32_u24 v6, 28, v4
    v_sub_u32 v6, v3, v6
    v_lshrrev_b32 v7, 3, v4
    v_lshlrev_b32 v7, 1, v7
    v_xor_b32 v6, v6, v7
    v_add_u32 v4, s34, v4
    v_mul_lo_u32 v4, v4, s42
    v_lshl_add_u32 v4, v6, 4, v4
    v_subrev_u32 v4, 1024, v4
    v_cmp_gt_u32 vcc, s59, v6
    v_mov_b32 v7, 0x7ffff000
    s_nop 0
    v_cndmask_b32 v15, v7, v4, vcc
    v_add_u32 v3, 384, v1
    v_mul_u32_u24 v4, s36, v3
    v_lshrrev_b32 v4, 16, v4
    v_mul_u32_u24 v6, 28, v4
    v_sub_u32 v6, v3, v6
    v_lshrrev_b32 v7, 3, v4
    v_lshlrev_b32 v7, 1, v7
    v_xor_b32 v6, v6, v7
    v_add_u32 v4, s34, v4
    v_mul_lo_u32 v4, v4, s42
    v_lshl_add_u32 v4, v6, 4, v4
    v_subrev_u32 v4, 2048, v4
    v_cmp_gt_u32 vcc, s59, v6
    v_mov_b32 v7, 0x7ffff000
    s_nop 0
    v_cndmask_b32 v16, v7, v4, vcc
    s_mul_i32 s56, s30, 7168
    v_and_b32 v24, 7, v1
    v_lshlrev_b32 v24, 3, v24
    v_add_u32 v24, 131072, v24
    s_lshl_b32 s34, s30, 6
    v_add_u32 v25, s34, v24
    s_mov_b32 s44, 0xffff0000
    s_waitcnt vmcnt(5)
    v_lshlrev_b32 v30, 16, v30
    v_sub_f32 v30, 0, v30
    v_mov_b32 v31, v30
    s_waitcnt vmcnt(4)
    v_lshlrev_b32 v64, 16, v32
    v_and_b32 v65, s44, v32
    v_lshlrev_b32 v66, 16, v33
    v_and_b32 v67, s44, v33
    v_lshlrev_b32 v68, 16, v34
    v_and_b32 v69, s44, v34
    v_lshlrev_b32 v70, 16, v35
    v_and_b32 v71, s44, v35
    v_pk_add_f32 v[64:65], v[64:65], v[30:31]
    v_pk_add_f32 v[66:67], v[66:67], v[30:31]
    v_pk_add_f32 v[68:69], v[68:69], v[30:31]
    v_pk_add_f32 v[70:71], v[70:71], v[30:31]
    s_waitcnt vmcnt(3)
    v_lshlrev_b32 v72, 16, v36
    v_and_b32 v73, s44, v36
    v_lshlrev_b32 v74, 16, v37
    v_and_b32 v75, s44, v37
    v_lshlrev_b32 v76, 16, v38
    v_and_b32 v77, s44, v38
    v_lshlrev_b32 v78, 16, v39
    v_and_b32 v79, s44, v39
    v_pk_add_f32 v[72:73], v[72:73], v[30:31]
    v_pk_add_f32 v[74:75], v[74:75], v[30:31]
    v_pk_add_f32 v[76:77], v[76:77], v[30:31]
    v_pk_add_f32 v[78:79], v[78:79], v[30:31]
    s_waitcnt vmcnt(2)
    v_lshlrev_b32 v80, 16, v40
    v_and_b32 v81, s44, v40
    v_lshlrev_b32 v82, 16, v41
    v_and_b32 v83, s44, v41
    v_lshlrev_b32 v84, 16, v42
    v_and_b32 v85, s44, v42
    v_lshlrev_b32 v86, 16, v43
    v_and_b32 v87, s44, v43
    v_pk_add_f32 v[80:81], v[80:81], v[30:31]
    v_pk_add_f32 v[82:83], v[82:83], v[30:31]
    v_pk_add_f32 v[84:85], v[84:85], v[30:31]
    v_pk_add_f32 v[86:87], v[86:87], v[30:31]
    s_waitcnt vmcnt(1)
    v_lshlrev_b32 v88, 16, v44
    v_and_b32 v89, s44, v44
    v_lshlrev_b32 v90, 16, v45
    v_and_b32 v91, s44, v45
    v_lshlrev_b32 v92, 16, v46
    v_and_b32 v93, s44, v46
    v_lshlrev_b32 v94, 16, v47
    v_and_b32 v95, s44, v47
    v_pk_add_f32 v[88:89], v[88:89], v[30:31]
    v_pk_add_f32 v[90:91], v[90:91], v[30:31]
    v_pk_add_f32 v[92:93], v[92:93], v[30:31]
    v_pk_add_f32 v[94:95], v[94:95], v[30:31]
    v_pk_add_f32 v[32:33], v[64:65], v[66:67]
    v_pk_mul_f32 v[34:35], v[64:65], v[64:65]
    v_pk_add_f32 v[36:37], v[68:69], v[70:71]
    v_pk_mul_f32 v[38:39], v[66:67], v[66:67]
    v_pk_fma_f32 v[34:35], v[68:69], v[68:69], v[34:35]
    v_pk_fma_f32 v[38:39], v[70:71], v[70:71], v[38:39]
    v_pk_fma_f32 v[34:35], v[72:73], v[72:73], v[34:35]
    v_pk_add_f32 v[32:33], v[32:33], v[72:73]
    v_pk_fma_f32 v[38:39], v[74:75], v[74:75], v[38:39]
    v_pk_add_f32 v[36:37], v[36:37], v[74:75]
    v_pk_fma_f32 v[34:35], v[76:77], v[76:77], v[34:35]
    v_pk_add_f32 v[32:33], v[32:33], v[76:77]
    v_pk_fma_f32 v[38:39], v[78:79], v[78:79], v[38:39]
    v_pk_add_f32 v[36:37], v[36:37], v[78:79]
    v_pk_fma_f32 v[34:35], v[80:81], v[80:81], v[34:35]
    v_pk_add_f32 v[32:33], v[32:33], v[80:81]
    v_pk_fma_f32 v[38:39], v[82:83], v[82:83], v[38:39]
    v_pk_add_f32 v[36:37], v[36:37], v[82:83]
    v_pk_fma_f32 v[34:35], v[84:85], v[84:85], v[34:35]
    v_pk_add_f32 v[32:33], v[32:33], v[84:85]
    v_pk_fma_f32 v[38:39], v[86:87], v[86:87], v[38:39]
    v_pk_add_f32 v[36:37], v[36:37], v[86:87]
    v_pk_fma_f32 v[34:35], v[88:89], v[88:89], v[34:35]
    v_pk_add_f32 v[32:33], v[32:33], v[88:89]
    v_pk_fma_f32 v[38:39], v[90:91], v[90:91], v[38:39]
    v_pk_add_f32 v[36:37], v[36:37], v[90:91]
    v_pk_fma_f32 v[34:35], v[92:93], v[92:93], v[34:35]
    v_pk_add_f32 v[32:33], v[32:33], v[92:93]
    v_pk_fma_f32 v[38:39], v[94:95], v[94:95], v[38:39]
    v_pk_add_f32 v[36:37], v[36:37], v[94:95]
    v_pk_add_f32 v[32:33], v[32:33], v[36:37]
    v_pk_add_f32 v[34:35], v[34:35], v[38:39]
    v_add_f32 v26, v32, v33
    v_add_f32 v27, v34, v35
    s_nop 0
    v_add_f32_dpp v26, v26, v26 row_ror:8 row_mask:0xf bank_mask:0xf
    v_add_f32_dpp v27, v27, v27 row_ror:8 row_mask:0xf bank_mask:0xf
    v_mov_b32 v28, v26
    v_mov_b32 v29, v27
    s_nop 0
    v_permlane16_swap_b32 v26, v28
    v_permlane16_swap_b32 v27, v29
    s_nop 0
    v_add_f32 v26, v26, v28
    v_add_f32 v27, v27, v29
    v_mov_b32 v28, v26
    v_mov_b32 v29, v27
    s_nop 0
    v_permlane32_swap_b32 v26, v28
    v_permlane32_swap_b32 v27, v29
    s_nop 0
    v_add_f32 v26, v26, v28
    v_add_f32 v27, v27, v29
    ds_write_b64 v25, v[26:27]
    s_waitcnt lgkmcnt(0)
    s_barrier
    ds_read_b64 v[32:33], v24 offset:0
    ds_read_b64 v[34:35], v24 offset:64
    ds_read_b64 v[36:37], v24 offset:128
    ds_read_b64 v[38:39], v24 offset:192
    s_waitcnt lgkmcnt(0)
    v_pk_add_f32 v[32:33], v[32:33], v[34:35]
    v_pk_add_f32 v[36:37], v[36:37], v[38:39]
    v_pk_add_f32 v[32:33], v[32:33], v[36:37]
    v_mul_f32 v32, 0x3a800000, v32
    v_mov_b32 v30, 0x3727c5ac
    v_fmac_f32 v30, 0x3a800000, v33
    v_fma_f32 v30, -v32, v32, v30
    v_max_f32 v30, 0x3727c5ac, v30
    v_rsq_f32 v30, v30
    s_nop 0
    v_mul_f32 v32, -v32, v30
    v_mov_b32 v31, v30
    v_mov_b32 v33, v32
    v_pk_fma_f32 v[64:65], v[64:65], v[30:31], v[32:33]
    v_pk_fma_f32 v[66:67], v[66:67], v[30:31], v[32:33]
    v_pk_fma_f32 v[68:69], v[68:69], v[30:31], v[32:33]
    v_pk_fma_f32 v[70:71], v[70:71], v[30:31], v[32:33]
    v_pk_fma_f32 v[72:73], v[72:73], v[30:31], v[32:33]
    v_pk_fma_f32 v[74:75], v[74:75], v[30:31], v[32:33]
    v_pk_fma_f32 v[76:77], v[76:77], v[30:31], v[32:33]
    v_pk_fma_f32 v[78:79], v[78:79], v[30:31], v[32:33]
    v_pk_fma_f32 v[80:81], v[80:81], v[30:31], v[32:33]
    v_pk_fma_f32 v[82:83], v[82:83], v[30:31], v[32:33]
    v_pk_fma_f32 v[84:85], v[84:85], v[30:31], v[32:33]
    v_pk_fma_f32 v[86:87], v[86:87], v[30:31], v[32:33]
    v_pk_fma_f32 v[88:89], v[88:89], v[30:31], v[32:33]
    v_pk_fma_f32 v[90:91], v[90:91], v[30:31], v[32:33]
    v_pk_fma_f32 v[92:93], v[92:93], v[30:31], v[32:33]
    v_pk_fma_f32 v[94:95], v[94:95], v[30:31], v[32:33]
    v_cvt_pk_bf16_f32 v40, v64, v65
    v_cvt_pk_bf16_f32 v41, v66, v67
    v_cvt_pk_bf16_f32 v42, v68, v69
    v_cvt_pk_bf16_f32 v43, v70, v71
    v_cvt_pk_bf16_f32 v44, v72, v73
    v_cvt_pk_bf16_f32 v45, v74, v75
    v_cvt_pk_bf16_f32 v46, v76, v77
    v_cvt_pk_bf16_f32 v47, v78, v79
    v_cvt_pk_bf16_f32 v48, v80, v81
    v_cvt_pk_bf16_f32 v49, v82, v83
    v_cvt_pk_bf16_f32 v50, v84, v85
    v_cvt_pk_bf16_f32 v51, v86, v87
    v_cvt_pk_bf16_f32 v52, v88, v89
    v_cvt_pk_bf16_f32 v53, v90, v91
    v_cvt_pk_bf16_f32 v54, v92, v93
    v_cvt_pk_bf16_f32 v55, v94, v95
    v_lshlrev_b32 v24, 4, v1
    s_lshl_b32 s34, s30, 12
    v_add_u32 v24, s34, v24
    s_mul_i32 s35, s2, 16640
    buffer_store_dwordx4 v[40:43], v24, s[12:15], s35 offen offset:0 sc1
    buffer_store_dwordx4 v[44:47], v24, s[12:15], s35 offen offset:1024 sc1
    buffer_store_dwordx4 v[48:51], v24, s[12:15], s35 offen offset:2048 sc1
    buffer_store_dwordx4 v[52:55], v24, s[12:15], s35 offen offset:3072 sc1
    v_mov_b64 v[32:33], 0
    v_mov_b64 v[34:35], 0
    v_mov_b64 v[36:37], 0
    v_mov_b64 v[38:39], 0
    v_mov_b64 v[64:65], 0
    v_mov_b64 v[66:67], 0
    v_mov_b64 v[68:69], 0
    v_mov_b64 v[70:71], 0
    v_mov_b64 v[72:73], 0
    v_mov_b64 v[74:75], 0
    v_mov_b64 v[76:77], 0
    v_mov_b64 v[78:79], 0
    v_mov_b64 v[80:81], 0
    v_mov_b64 v[82:83], 0
    v_mov_b64 v[84:85], 0
    v_mov_b64 v[86:87], 0
    v_mov_b64 v[88:89], 0
    v_mov_b64 v[90:91], 0
    v_mov_b64 v[92:93], 0
    v_mov_b64 v[94:95], 0
    v_mov_b64 v[96:97], 0
    v_mov_b64 v[98:99], 0
    v_mov_b64 v[100:101], 0
    v_mov_b64 v[102:103], 0
    v_mov_b64 v[104:105], 0
    v_mov_b64 v[106:107], 0
    v_mov_b64 v[108:109], 0
    v_mov_b64 v[110:111], 0
    v_mov_b64 v[112:113], 0
    v_mov_b64 v[114:115], 0
    v_mov_b64 v[116:117], 0
    v_mov_b64 v[118:119], 0
    v_mov_b64 v[120:121], 0
    v_mov_b64 v[122:123], 0
    v_mov_b64 v[124:125], 0
    v_mov_b64 v[126:127], 0
    v_mov_b64 v[128:129], 0
    v_mov_b64 v[130:131], 0
    v_mov_b64 v[132:133], 0
    v_mov_b64 v[134:135], 0
    v_mov_b64 v[136:137], 0
    v_mov_b64 v[138:139], 0
    v_mov_b64 v[140:141], 0
    v_mov_b64 v[142:143], 0
    v_mov_b64 v[144:145], 0
    v_mov_b64 v[146:147], 0
    v_mov_b64 v[148:149], 0
    v_mov_b64 v[150:151], 0
    v_mov_b64 v[152:153], 0
    v_mov_b64 v[154:155], 0
    v_mov_b64 v[156:157], 0
    v_mov_b64 v[158:159], 0
    v_mov_b64 v[160:161], 0
    v_mov_b64 v[162:163], 0
    v_mov_b64 v[164:165], 0
    v_mov_b64 v[166:167], 0
    v_mov_b64 v[168:169], 0
    v_mov_b64 v[170:171], 0
    v_mov_b64 v[172:173], 0
    v_mov_b64 v[174:175], 0
    v_mov_b64 v[176:177], 0
    v_mov_b64 v[178:179], 0
    v_mov_b64 v[180:181], 0
    v_mov_b64 v[182:183], 0
    v_mov_b64 v[184:185], 0
    v_mov_b64 v[186:187], 0
    v_mov_b64 v[188:189], 0
    v_mov_b64 v[190:191], 0
    v_mov_b64 v[192:193], 0
    v_mov_b64 v[194:195], 0
    v_mov_b64 v[196:197], 0
    v_mov_b64 v[198:199], 0
    v_mov_b64 v[200:201], 0
    v_mov_b64 v[202:203], 0
    v_mov_b64 v[204:205], 0
    v_mov_b64 v[206:207], 0
    v_mov_b64 v[208:209], 0
    v_mov_b64 v[210:211], 0
    v_mov_b64 v[212:213], 0
    v_mov_b64 v[214:215], 0
    v_mov_b64 v[216:217], 0
    v_mov_b64 v[218:219], 0
    v_mov_b64 v[220:221], 0
    v_mov_b64 v[222:223], 0
    v_mov_b64 v[224:225], 0
    v_mov_b64 v[226:227], 0
    v_mov_b64 v[228:229], 0
    v_mov_b64 v[230:231], 0
    v_mov_b64 v[232:233], 0
    v_mov_b64 v[234:235], 0
    v_mov_b64 v[236:237], 0
    v_mov_b64 v[238:239], 0
    v_mov_b64 v[240:241], 0
    v_mov_b64 v[242:243], 0
    v_mov_b64 v[244:245], 0
    v_mov_b64 v[246:247], 0
    v_mov_b64 v[248:249], 0
    v_mov_b64 v[250:251], 0
    v_mov_b64 v[252:253], 0
    v_mov_b64 v[254:255], 0
    s_cmp_lt_u32 s2, 8
    s_cbranch_scc0 L_p1_nz2
    s_add_u32 s44, s40, 131072
    s_addc_u32 s45, s41, 0
    s_mov_b32 s20, s44
    s_and_b32 s21, s45, 0xffff
    s_mov_b32 s22, 50176
    s_mov_b32 s23, 0x00020000
    v_mov_b32 v20, 0
    v_mov_b32 v21, 0
    v_mov_b32 v22, 0
    v_mov_b32 v23, 0
    v_lshlrev_b32 v9, 4, v2
    s_mul_i32 s35, s2, 6272
    buffer_store_dwordx4 v[20:23], v9, s[20:23], s35 offen sc1
    s_add_u32 s35, s35, 4096
    v_cmp_gt_u32 vcc, 136, v2
    s_and_saveexec_b64 s[44:45], vcc
    s_cbranch_execz L_p1_nz
    buffer_store_dwordx4 v[20:23], v9, s[20:23], s35 offen sc1
L_p1_nz:
    s_mov_b64 exec, s[44:45]
L_p1_nz2:
    s_waitcnt vmcnt(0)
    s_barrier
    v_mov_b64 v[40:41], 0
    v_mov_b64 v[42:43], 0
    v_mov_b64 v[44:45], 0
    v_mov_b64 v[46:47], 0
    v_mov_b64 v[48:49], 0
    v_mov_b64 v[50:51], 0
    v_mov_b64 v[52:53], 0
    v_mov_b64 v[54:55], 0
    v_mov_b64 v[56:57], 0
    v_mov_b64 v[58:59], 0
    v_mov_b64 v[60:61], 0
    v_mov_b64 v[62:63], 0
    s_cmp_eq_u32 s30, 0
    s_cbranch_scc0 L_l1_nosigt
    s_lshr_b32 s34, s2, 5
    s_lshl_b32 s34, s34, 5
    v_mov_b32 v24, 1
    s_mov_b64 s[44:45], exec
    s_mov_b64 exec, 1
    buffer_atomic_add v24, off, s[52:55], s34
    s_mov_b64 exec, s[44:45]
L_l1_nosigt:
    s_mul_i32 s24, s43, 0
    s_add_u32 s38, s56, 0
    s_mov_b32 m0, s38
    s_nop 0
    buffer_load_dwordx4 v10, s[8:11], s24 offen offset:0 lds
    buffer_load_dwordx4 v11, s[8:11], s24 offen offset:1024 lds
    buffer_load_dwordx4 v12, s[8:11], s24 offen offset:2048 lds
    buffer_load_dwordx4 v13, s[8:11], s24 offen offset:3072 lds
    s_add_u32 s34, s38, 4096
    s_mov_b32 m0, s34
    s_nop 0
    buffer_load_dwordx4 v14, s[8:11], s24 offen offset:0 lds
    buffer_load_dwordx4 v15, s[8:11], s24 offen offset:1024 lds
    buffer_load_dwordx4 v16, s[8:11], s24 offen offset:2048 lds
    s_mul_i32 s24, s43, 1
    s_add_u32 s38, s56, 32768
    s_mov_b32 m0, s38
    s_nop 0
    buffer_load_dwordx4 v10, s[8:11], s24 offen offset:0 lds
    buffer_load_dwordx4 v11, s[8:11], s24 offen offset:1024 lds
    buffer_load_dwordx4 v12, s[8:11], s24 offen offset:2048 lds
    buffer_load_dwordx4 v13, s[8:11], s24 offen offset:3072 lds
    s_add_u32 s34, s38, 4096
    s_mov_b32 m0, s34
    s_nop 0
    buffer_load_dwordx4 v14, s[8:11], s24 offen offset:0 lds
    buffer_load_dwordx4 v15, s[8:11], s24 offen offset:1024 lds
    buffer_load_dwordx4 v16, s[8:11], s24 offen offset:2048 lds
    s_mul_i32 s24, s43, 2
    s_add_u32 s38, s56, 65536
    s_mov_b32 m0, s38
    s_nop 0
    buffer_load_dwordx4 v10, s[8:11], s24 offen offset:0 lds
    buffer_load_dwordx4 v11, s[8:11], s24 offen offset:1024 lds
    buffer_load_dwordx4 v12, s[8:11], s24 offen offset:2048 lds
    buffer_load_dwordx4 v13, s[8:11], s24 offen offset:3072 lds
    v_and_b32 v3, 15, v1
    v_lshrrev_b32 v4, 4, v1
    v_lshrrev_b32 v5, 2, v3
    v_lshl_add_u32 v5, v4, 3, v5
    v_mul_u32_u24 v5, 448, v5
    v_and_b32 v6, 3, v3
    v_lshl_add_u32 v5, v6, 3, v5
    v_and_b32 v6, 1, v4
    v_lshlrev_b32 v6, 5, v6
    v_add_u32 v8, v5, v6
    v_sub_u32 v9, v5, v6
    v_lshrrev_b32 v5, 3, v3
    v_mul_u32_u24 v5, 16640, v5
    v_lshl_add_u32 v5, v4, 7, v5
    v_and_b32 v6, 7, v3
    v_lshl_add_u32 v0, v6, 4, v5
    v_mov_b32 v17, v1
    v_mov_b32 v1, v10
    v_mov_b32 v2, v11
    v_mov_b32 v3, v12
    v_mov_b32 v4, v13
    v_mov_b32 v5, v14
    v_mov_b32 v6, v15
    v_mov_b32 v7, v16
    s_lshr_b32 s25, s39, 3
    s_mul_i32 s25, s25, 16640
    s_add_u32 s26, s25, 33280
    s_add_u32 s27, s25, 66560
    s_add_u32 s28, s25, 99840
    s_cmp_eq_u32 s30, 0
    s_cbranch_scc0 L_p1_got
    s_lshl_b32 s34, s31, 5
    v_mov_b32 v19, s34
    v_mov_b32 v20, 0
    v_cmp_eq_u32 vcc, 0, v17
    s_nop 1
    v_cndmask_b32 v19, v19, v20, vcc
    s_mov_b32 s35, 0x8000
L_p1_poll:
    buffer_load_dword v18, v19, s[52:55], 0 offen sc1
    s_waitcnt vmcnt(0)
    v_cmp_le_u32 vcc, 32, v18
    s_sub_u32 s35, s35, 1
    s_cmp_eq_u32 s35, 0
    s_cbranch_scc1 L_p1_got
    s_nop 1
    s_cmp_eq_u64 vcc, -1
    s_cbranch_scc1 L_p1_got
    s_sleep 3
    s_branch L_p1_poll
L_p1_got:
    s_waitcnt vmcnt(0)
    s_barrier
    buffer_load_dwordx4 a[0:3], v0, s[12:15], s25 offen offset:0 sc1
    buffer_load_dwordx4 a[4:7], v0, s[12:15], s26 offen offset:0 sc1
    buffer_load_dwordx4 a[8:11], v0, s[12:15], s27 offen offset:0 sc1
    buffer_load_dwordx4 a[12:15], v0, s[12:15], s28 offen offset:0 sc1
    buffer_load_dwordx4 a[16:19], v0, s[12:15], s25 offen offset:512 sc1
    buffer_load_dwordx4 a[20:23], v0, s[12:15], s26 offen offset:512 sc1
    buffer_load_dwordx4 a[24:27], v0, s[12:15], s27 offen offset:512 sc1
    buffer_load_dwordx4 a[28:31], v0, s[12:15], s28 offen offset:512 sc1
    buffer_load_dwordx4 a[32:35], v0, s[12:15], s25 offen offset:1024 sc1
    buffer_load_dwordx4 a[36:39], v0, s[12:15], s26 offen offset:1024 sc1
    buffer_load_dwordx4 a[40:43], v0, s[12:15], s27 offen offset:1024 sc1
    buffer_load_dwordx4 a[44:47], v0, s[12:15], s28 offen offset:1024 sc1
    s_movk_i32 s29, 8
    s_cmp_eq_u32 s33, 2
    s_cbranch_scc1 L_p1_hpath
    s_cmp_eq_u32 s33, 1
    s_cbranch_scc1 L_p1_vpath
    s_cmp_eq_u32 s33, 3
    s_cbranch_scc1 L_p1_mpath
    ds_read_b64_tr_b16 a[64:65], v8 offset:0
    ds_read_b64_tr_b16 a[66:67], v8 offset:1792
    ds_read_b64_tr_b16 a[68:69], v9 offset:32
    ds_read_b64_tr_b16 a[70:71], v9 offset:1824
    ds_read_b64_tr_b16 a[72:73], v8 offset:64
    ds_read_b64_tr_b16 a[74:75], v8 offset:1856
    ds_read_b64_tr_b16 a[76:77], v9 offset:96
    ds_read_b64_tr_b16 a[78:79], v9 offset:1888
    ds_read_b64_tr_b16 a[80:81], v8 offset:128
    ds_read_b64_tr_b16 a[82:83], v8 offset:1920
    ds_read_b64_tr_b16 a[84:85], v9 offset:160
    ds_read_b64_tr_b16 a[86:87], v9 offset:1952
    ds_read_b64_tr_b16 a[88:89], v8 offset:192
    ds_read_b64_tr_b16 a[90:91], v8 offset:1984
    ds_read_b64_tr_b16 a[92:93], v9 offset:224
    ds_read_b64_tr_b16 a[94:95], v9 offset:2016
    ds_read_b64_tr_b16 a[96:97], v8 offset:256
    ds_read_b64_tr_b16 a[98:99], v8 offset:2048
    ds_read_b64_tr_b16 a[100:101], v9 offset:288
    ds_read_b64_tr_b16 a[102:103], v9 offset:2080
    ds_read_b64_tr_b16 a[104:105], v8 offset:320
    ds_read_b64_tr_b16 a[106:107], v8 offset:2112
    ds_read_b64_tr_b16 a[108:109], v9 offset:352
    ds_read_b64_tr_b16 a[110:111], v9 offset:2144
    s_waitcnt vmcnt(0)
.p2align 6
L_p1_n_loop:
    s_waitcnt vmcnt(19) lgkmcnt(0)
    v_mfma_f32_16x16x32_bf16 v[32:35], a[64:67], a[0:3], v[32:35]
    ds_read_b64_tr_b16 a[120:121], v8 offset:14336
    v_mfma_f32_16x16x32_bf16 v[36:39], a[64:67], a[4:7], v[36:39]
    ds_read_b64_tr_b16 a[122:123], v8 offset:16128
    v_mfma_f32_16x16x32_bf16 v[40:43], a[64:67], a[8:11], v[40:43]
    ds_read_b64_tr_b16 a[124:125], v9 offset:14368
    v_mfma_f32_16x16x32_bf16 v[44:47], a[64:67], a[12:15], v[44:47]
    ds_read_b64_tr_b16 a[126:127], v9 offset:16160
    v_mfma_f32_16x16x32_bf16 v[48:51], a[68:71], a[0:3], v[48:51]
    ds_read_b64_tr_b16 a[128:129], v8 offset:14400
    v_mfma_f32_16x16x32_bf16 v[52:55], a[68:71], a[4:7], v[52:55]
    ds_read_b64_tr_b16 a[130:131], v8 offset:16192
    v_mfma_f32_16x16x32_bf16 v[56:59], a[68:71], a[8:11], v[56:59]
    ds_read_b64_tr_b16 a[132:133], v9 offset:14432
    v_mfma_f32_16x16x32_bf16 v[60:63], a[68:71], a[12:15], v[60:63]
    ds_read_b64_tr_b16 a[134:135], v9 offset:16224
    v_mfma_f32_16x16x32_bf16 v[64:67], a[72:75], a[0:3], v[64:67]
    ds_read_b64_tr_b16 a[136:137], v8 offset:14464
    v_mfma_f32_16x16x32_bf16 v[68:71], a[72:75], a[4:7], v[68:71]
    ds_read_b64_tr_b16 a[138:139], v8 offset:16256
    v_mfma_f32_16x16x32_bf16 v[72:75], a[72:75], a[8:11], v[72:75]
    ds_read_b64_tr_b16 a[140:141], v9 offset:14496
    buffer_load_dwordx4 a[48:51], v0, s[12:15], s25 offen offset:1536 sc1
    v_mfma_f32_16x16x32_bf16 v[76:79], a[72:75], a[12:15], v[76:79]
    ds_read_b64_tr_b16 a[142:143], v9 offset:16288
    v_mfma_f32_16x16x32_bf16 v[80:83], a[76:79], a[0:3], v[80:83]
    ds_read_b64_tr_b16 a[144:145], v8 offset:14528
    v_mfma_f32_16x16x32_bf16 v[84:87], a[76:79], a[4:7], v[84:87]
    ds_read_b64_tr_b16 a[146:147], v8 offset:16320
    v_mfma_f32_16x16x32_bf16 v[88:91], a[76:79], a[8:11], v[88:91]
    ds_read_b64_tr_b16 a[148:149], v9 offset:14560
    buffer_load_dwordx4 a[52:55], v0, s[12:15], s26 offen offset:1536 sc1
    v_mfma_f32_16x16x32_bf16 v[92:95], a[76:79], a[12:15], v[92:95]
    ds_read_b64_tr_b16 a[150:151], v9 offset:16352
    v_mfma_f32_16x16x32_bf16 v[96:99], a[80:83], a[0:3], v[96:99]
    ds_read_b64_tr_b16 a[152:153], v8 offset:14592
    v_mfma_f32_16x16x32_bf16 v[100:103], a[80:83], a[4:7], v[100:103]
    ds_read_b64_tr_b16 a[154:155], v8 offset:16384
    v_mfma_f32_16x16x32_bf16 v[104:107], a[80:83], a[8:11], v[104:107]
    ds_read_b64_tr_b16 a[156:157], v9 offset:14624
    buffer_load_dwordx4 a[56:59], v0, s[12:15], s27 offen offset:1536 sc1
    v_mfma_f32_16x16x32_bf16 v[108:111], a[80:83], a[12:15], v[108:111]
    ds_read_b64_tr_b16 a[158:159], v9 offset:16416
    v_mfma_f32_16x16x32_bf16 v[112:115], a[84:87], a[0:3], v[112:115]
    ds_read_b64_tr_b16 a[160:161], v8 offset:14656
    v_mfma_f32_16x16x32_bf16 v[116:119], a[84:87], a[4:7], v[116:119]
    ds_read_b64_tr_b16 a[162:163], v8 offset:16448
    v_mfma_f32_16x16x32_bf16 v[120:123], a[84:87], a[8:11], v[120:123]
    ds_read_b64_tr_b16 a[164:165], v9 offset:14688
    buffer_load_dwordx4 a[60:63], v0, s[12:15], s28 offen offset:1536 sc1
    v_mfma_f32_16x16x32_bf16 v[124:127], a[84:87], a[12:15], v[124:127]
    ds_read_b64_tr_b16 a[166:167], v9 offset:16480
    v_mfma_f32_16x16x32_bf16 v[128:131], a[88:91], a[0:3], v[128:131]
    v_mfma_f32_16x16x32_bf16 v[132:135], a[88:91], a[4:7], v[132:135]
    v_mfma_f32_16x16x32_bf16 v[136:139], a[88:91], a[8:11], v[136:139]
    s_add_u32 s34, s38, 4096
    s_mov_b32 m0, s34
    s_nop 0
    buffer_load_dwordx4 v5, s[8:11], s24 offen offset:0 lds
    v_mfma_f32_16x16x32_bf16 v[140:143], a[88:91], a[12:15], v[140:143]
    v_mfma_f32_16x16x32_bf16 v[144:147], a[92:95], a[0:3], v[144:147]
    v_mfma_f32_16x16x32_bf16 v[148:151], a[92:95], a[4:7], v[148:151]
    v_mfma_f32_16x16x32_bf16 v[152:155], a[92:95], a[8:11], v[152:155]
    buffer_load_dwordx4 v6, s[8:11], s24 offen offset:1024 lds
    v_mfma_f32_16x16x32_bf16 v[156:159], a[92:95], a[12:15], v[156:159]
    v_mfma_f32_16x16x32_bf16 v[160:163], a[96:99], a[0:3], v[160:163]
    v_mfma_f32_16x16x32_bf16 v[164:167], a[96:99], a[4:7], v[164:167]
    v_mfma_f32_16x16x32_bf16 v[168:171], a[96:99], a[8:11], v[168:171]
    buffer_load_dwordx4 v7, s[8:11], s24 offen offset:2048 lds
    v_mfma_f32_16x16x32_bf16 v[172:175], a[96:99], a[12:15], v[172:175]
    v_mfma_f32_16x16x32_bf16 v[176:179], a[100:103], a[0:3], v[176:179]
    v_mfma_f32_16x16x32_bf16 v[180:183], a[100:103], a[4:7], v[180:183]
    v_mfma_f32_16x16x32_bf16 v[184:187], a[100:103], a[8:11], v[184:187]
    v_mfma_f32_16x16x32_bf16 v[188:191], a[100:103], a[12:15], v[188:191]
    v_mfma_f32_16x16x32_bf16 v[192:195], a[104:107], a[0:3], v[192:195]
    v_mfma_f32_16x16x32_bf16 v[196:199], a[104:107], a[4:7], v[196:199]
    v_mfma_f32_16x16x32_bf16 v[200:203], a[104:107], a[8:11], v[200:203]
    v_mfma_f32_16x16x32_bf16 v[204:207], a[104:107], a[12:15], v[204:207]
    v_mfma_f32_16x16x32_bf16 v[208:211], a[108:111], a[0:3], v[208:211]
    v_mfma_f32_16x16x32_bf16 v[212:215], a[108:111], a[4:7], v[212:215]
    v_mfma_f32_16x16x32_bf16 v[216:219], a[108:111], a[8:11], v[216:219]
    v_mfma_f32_16x16x32_bf16 v[220:223], a[108:111], a[12:15], v[220:223]
    s_waitcnt vmcnt(15) lgkmcnt(0)
    s_barrier
    v_mfma_f32_16x16x32_bf16 v[32:35], a[120:123], a[16:19], v[32:35]
    ds_read_b64_tr_b16 a[64:65], v8 offset:32768
    v_mfma_f32_16x16x32_bf16 v[36:39], a[120:123], a[20:23], v[36:39]
    ds_read_b64_tr_b16 a[66:67], v8 offset:34560
    v_mfma_f32_16x16x32_bf16 v[40:43], a[120:123], a[24:27], v[40:43]
    ds_read_b64_tr_b16 a[68:69], v9 offset:32800
    s_add_u32 s25, s25, 2048
    v_mfma_f32_16x16x32_bf16 v[44:47], a[120:123], a[28:31], v[44:47]
    ds_read_b64_tr_b16 a[70:71], v9 offset:34592
    s_add_u32 s26, s26, 2048
    v_mfma_f32_16x16x32_bf16 v[48:51], a[124:127], a[16:19], v[48:51]
    ds_read_b64_tr_b16 a[72:73], v8 offset:32832
    s_add_u32 s27, s27, 2048
    v_mfma_f32_16x16x32_bf16 v[52:55], a[124:127], a[20:23], v[52:55]
    ds_read_b64_tr_b16 a[74:75], v8 offset:34624
    s_add_u32 s28, s28, 2048
    v_mfma_f32_16x16x32_bf16 v[56:59], a[124:127], a[24:27], v[56:59]
    ds_read_b64_tr_b16 a[76:77], v9 offset:32864
    s_cmp_eq_u32 s29, 1
    v_mfma_f32_16x16x32_bf16 v[60:63], a[124:127], a[28:31], v[60:63]
    ds_read_b64_tr_b16 a[78:79], v9 offset:34656
    s_cselect_b32 s14, 0, s14
    v_mfma_f32_16x16x32_bf16 v[64:67], a[128:131], a[16:19], v[64:67]
    ds_read_b64_tr_b16 a[80:81], v8 offset:32896
    v_mfma_f32_16x16x32_bf16 v[68:71], a[128:131], a[20:23], v[68:71]
    ds_read_b64_tr_b16 a[82:83], v8 offset:34688
    v_mfma_f32_16x16x32_bf16 v[72:75], a[128:131], a[24:27], v[72:75]
    ds_read_b64_tr_b16 a[84:85], v9 offset:32928
    buffer_load_dwordx4 a[0:3], v0, s[12:15], s25 offen offset:0 sc1
    v_mfma_f32_16x16x32_bf16 v[76:79], a[128:131], a[28:31], v[76:79]
    ds_read_b64_tr_b16 a[86:87], v9 offset:34720
    v_mfma_f32_16x16x32_bf16 v[80:83], a[132:135], a[16:19], v[80:83]
    ds_read_b64_tr_b16 a[88:89], v8 offset:32960
    v_mfma_f32_16x16x32_bf16 v[84:87], a[132:135], a[20:23], v[84:87]
    ds_read_b64_tr_b16 a[90:91], v8 offset:34752
    v_mfma_f32_16x16x32_bf16 v[88:91], a[132:135], a[24:27], v[88:91]
    ds_read_b64_tr_b16 a[92:93], v9 offset:32992
    buffer_load_dwordx4 a[4:7], v0, s[12:15], s26 offen offset:0 sc1
    v_mfma_f32_16x16x32_bf16 v[92:95], a[132:135], a[28:31], v[92:95]
    ds_read_b64_tr_b16 a[94:95], v9 offset:34784
    v_mfma_f32_16x16x32_bf16 v[96:99], a[136:139], a[16:19], v[96:99]
    ds_read_b64_tr_b16 a[96:97], v8 offset:33024
    v_mfma_f32_16x16x32_bf16 v[100:103], a[136:139], a[20:23], v[100:103]
    ds_read_b64_tr_b16 a[98:99], v8 offset:34816
    v_mfma_f32_16x16x32_bf16 v[104:107], a[136:139], a[24:27], v[104:107]
    ds_read_b64_tr_b16 a[100:101], v9 offset:33056
    buffer_load_dwordx4 a[8:11], v0, s[12:15], s27 offen offset:0 sc1
    v_mfma_f32_16x16x32_bf16 v[108:111], a[136:139], a[28:31], v[108:111]
    ds_read_b64_tr_b16 a[102:103], v9 offset:34848
    v_mfma_f32_16x16x32_bf16 v[112:115], a[140:143], a[16:19], v[112:115]
    ds_read_b64_tr_b16 a[104:105], v8 offset:33088
    v_mfma_f32_16x16x32_bf16 v[116:119], a[140:143], a[20:23], v[116:119]
    ds_read_b64_tr_b16 a[106:107], v8 offset:34880
    v_mfma_f32_16x16x32_bf16 v[120:123], a[140:143], a[24:27], v[120:123]
    ds_read_b64_tr_b16 a[108:109], v9 offset:33120
    buffer_load_dwordx4 a[12:15], v0, s[12:15], s28 offen offset:0 sc1
    v_mfma_f32_16x16x32_bf16 v[124:127], a[140:143], a[28:31], v[124:127]
    ds_read_b64_tr_b16 a[110:111], v9 offset:34912
    v_mfma_f32_16x16x32_bf16 v[128:131], a[144:147], a[16:19], v[128:131]
    v_mfma_f32_16x16x32_bf16 v[132:135], a[144:147], a[20:23], v[132:135]
    v_mfma_f32_16x16x32_bf16 v[136:139], a[144:147], a[24:27], v[136:139]
    s_add_u32 s24, s24, s43
    s_add_u32 s38, s38, 32768
    s_and_b32 s38, s38, 131071
    s_mov_b32 m0, s38
    s_nop 0
    buffer_load_dwordx4 v1, s[8:11], s24 offen offset:0 lds
    v_mfma_f32_16x16x32_bf16 v[140:143], a[144:147], a[28:31], v[140:143]
    v_mfma_f32_16x16x32_bf16 v[144:147], a[148:151], a[16:19], v[144:147]
    v_mfma_f32_16x16x32_bf16 v[148:151], a[148:151], a[20:23], v[148:151]
    v_mfma_f32_16x16x32_bf16 v[152:155], a[148:151], a[24:27], v[152:155]
    buffer_load_dwordx4 v2, s[8:11], s24 offen offset:1024 lds
    v_mfma_f32_16x16x32_bf16 v[156:159], a[148:151], a[28:31], v[156:159]
    v_mfma_f32_16x16x32_bf16 v[160:163], a[152:155], a[16:19], v[160:163]
    v_mfma_f32_16x16x32_bf16 v[164:167], a[152:155], a[20:23], v[164:167]
    v_mfma_f32_16x16x32_bf16 v[168:171], a[152:155], a[24:27], v[168:171]
    buffer_load_dwordx4 v3, s[8:11], s24 offen offset:2048 lds
    v_mfma_f32_16x16x32_bf16 v[172:175], a[152:155], a[28:31], v[172:175]
    v_mfma_f32_16x16x32_bf16 v[176:179], a[156:159], a[16:19], v[176:179]
    v_mfma_f32_16x16x32_bf16 v[180:183], a[156:159], a[20:23], v[180:183]
    v_mfma_f32_16x16x32_bf16 v[184:187], a[156:159], a[24:27], v[184:187]
    buffer_load_dwordx4 v4, s[8:11], s24 offen offset:3072 lds
    v_mfma_f32_16x16x32_bf16 v[188:191], a[156:159], a[28:31], v[188:191]
    v_mfma_f32_16x16x32_bf16 v[192:195], a[160:163], a[16:19], v[192:195]
    v_mfma_f32_16x16x32_bf16 v[196:199], a[160:163], a[20:23], v[196:199]
    v_mfma_f32_16x16x32_bf16 v[200:203], a[160:163], a[24:27], v[200:203]
    v_mfma_f32_16x16x32_bf16 v[204:207], a[160:163], a[28:31], v[204:207]
    v_mfma_f32_16x16x32_bf16 v[208:211], a[164:167], a[16:19], v[208:211]
    v_mfma_f32_16x16x32_bf16 v[212:215], a[164:167], a[20:23], v[212:215]
    v_mfma_f32_16x16x32_bf16 v[216:219], a[164:167], a[24:27], v[216:219]
    v_mfma_f32_16x16x32_bf16 v[220:223], a[164:167], a[28:31], v[220:223]
    s_waitcnt vmcnt(19) lgkmcnt(0)
    v_mfma_f32_16x16x32_bf16 v[32:35], a[64:67], a[32:35], v[32:35]
    ds_read_b64_tr_b16 a[120:121], v8 offset:47104
    v_mfma_f32_16x16x32_bf16 v[36:39], a[64:67], a[36:39], v[36:39]
    ds_read_b64_tr_b16 a[122:123], v8 offset:48896
    v_mfma_f32_16x16x32_bf16 v[40:43], a[64:67], a[40:43], v[40:43]
    ds_read_b64_tr_b16 a[124:125], v9 offset:47136
    v_mfma_f32_16x16x32_bf16 v[44:47], a[64:67], a[44:47], v[44:47]
    ds_read_b64_tr_b16 a[126:127], v9 offset:48928
    v_mfma_f32_16x16x32_bf16 v[48:51], a[68:71], a[32:35], v[48:51]
    ds_read_b64_tr_b16 a[128:129], v8 offset:47168
    v_mfma_f32_16x16x32_bf16 v[52:55], a[68:71], a[36:39], v[52:55]
    ds_read_b64_tr_b16 a[130:131], v8 offset:48960
    v_mfma_f32_16x16x32_bf16 v[56:59], a[68:71], a[40:43], v[56:59]
    ds_read_b64_tr_b16 a[132:133], v9 offset:47200
    v_mfma_f32_16x16x32_bf16 v[60:63], a[68:71], a[44:47], v[60:63]
    ds_read_b64_tr_b16 a[134:135], v9 offset:48992
    v_mfma_f32_16x16x32_bf16 v[64:67], a[72:75], a[32:35], v[64:67]
    ds_read_b64_tr_b16 a[136:137], v8 offset:47232
    v_mfma_f32_16x16x32_bf16 v[68:71], a[72:75], a[36:39], v[68:71]
    ds_read_b64_tr_b16 a[138:139], v8 offset:49024
    v_mfma_f32_16x16x32_bf16 v[72:75], a[72:75], a[40:43], v[72:75]
    ds_read_b64_tr_b16 a[140:141], v9 offset:47264
    buffer_load_dwordx4 a[16:19], v0, s[12:15], s25 offen offset:512 sc1
    v_mfma_f32_16x16x32_bf16 v[76:79], a[72:75], a[44:47], v[76:79]
    ds_read_b64_tr_b16 a[142:143], v9 offset:49056
    v_mfma_f32_16x16x32_bf16 v[80:83], a[76:79], a[32:35], v[80:83]
    ds_read_b64_tr_b16 a[144:145], v8 offset:47296
    v_mfma_f32_16x16x32_bf16 v[84:87], a[76:79], a[36:39], v[84:87]
    ds_read_b64_tr_b16 a[146:147], v8 offset:49088
    v_mfma_f32_16x16x32_bf16 v[88:91], a[76:79], a[40:43], v[88:91]
    ds_read_b64_tr_b16 a[148:149], v9 offset:47328
    buffer_load_dwordx4 a[20:23], v0, s[12:15], s26 offen offset:512 sc1
    v_mfma_f32_16x16x32_bf16 v[92:95], a[76:79], a[44:47], v[92:95]
    ds_read_b64_tr_b16 a[150:151], v9 offset:49120
    v_mfma_f32_16x16x32_bf16 v[96:99], a[80:83], a[32:35], v[96:99]
    ds_read_b64_tr_b16 a[152:153], v8 offset:47360
    v_mfma_f32_16x16x32_bf16 v[100:103], a[80:83], a[36:39], v[100:103]
    ds_read_b64_tr_b16 a[154:155], v8 offset:49152
    v_mfma_f32_16x16x32_bf16 v[104:107], a[80:83], a[40:43], v[104:107]
    ds_read_b64_tr_b16 a[156:157], v9 offset:47392
    buffer_load_dwordx4 a[24:27], v0, s[12:15], s27 offen offset:512 sc1
    v_mfma_f32_16x16x32_bf16 v[108:111], a[80:83], a[44:47], v[108:111]
    ds_read_b64_tr_b16 a[158:159], v9 offset:49184
    v_mfma_f32_16x16x32_bf16 v[112:115], a[84:87], a[32:35], v[112:115]
    ds_read_b64_tr_b16 a[160:161], v8 offset:47424
    v_mfma_f32_16x16x32_bf16 v[116:119], a[84:87], a[36:39], v[116:119]
    ds_read_b64_tr_b16 a[162:163], v8 offset:49216
    v_mfma_f32_16x16x32_bf16 v[120:123], a[84:87], a[40:43], v[120:123]
    ds_read_b64_tr_b16 a[164:165], v9 offset:47456
    buffer_load_dwordx4 a[28:31], v0, s[12:15], s28 offen offset:512 sc1
    v_mfma_f32_16x16x32_bf16 v[124:127], a[84:87], a[44:47], v[124:127]
    ds_read_b64_tr_b16 a[166:167], v9 offset:49248
    v_mfma_f32_16x16x32_bf16 v[128:131], a[88:91], a[32:35], v[128:131]
    v_mfma_f32_16x16x32_bf16 v[132:135], a[88:91], a[36:39], v[132:135]
    v_mfma_f32_16x16x32_bf16 v[136:139], a[88:91], a[40:43], v[136:139]
    s_add_u32 s34, s38, 4096
    s_mov_b32 m0, s34
    s_nop 0
    buffer_load_dwordx4 v5, s[8:11], s24 offen offset:0 lds
    v_mfma_f32_16x16x32_bf16 v[140:143], a[88:91], a[44:47], v[140:143]
    v_mfma_f32_16x16x32_bf16 v[144:147], a[92:95], a[32:35], v[144:147]
    v_mfma_f32_16x16x32_bf16 v[148:151], a[92:95], a[36:39], v[148:151]
    v_mfma_f32_16x16x32_bf16 v[152:155], a[92:95], a[40:43], v[152:155]
    buffer_load_dwordx4 v6, s[8:11], s24 offen offset:1024 lds
    v_mfma_f32_16x16x32_bf16 v[156:159], a[92:95], a[44:47], v[156:159]
    v_mfma_f32_16x16x32_bf16 v[160:163], a[96:99], a[32:35], v[160:163]
    v_mfma_f32_16x16x32_bf16 v[164:167], a[96:99], a[36:39], v[164:167]
    v_mfma_f32_16x16x32_bf16 v[168:171], a[96:99], a[40:43], v[168:171]
    buffer_load_dwordx4 v7, s[8:11], s24 offen offset:2048 lds
    v_mfma_f32_16x16x32_bf16 v[172:175], a[96:99], a[44:47], v[172:175]
    v_mfma_f32_16x16x32_bf16 v[176:179], a[100:103], a[32:35], v[176:179]
    v_mfma_f32_16x16x32_bf16 v[180:183], a[100:103], a[36:39], v[180:183]
    v_mfma_f32_16x16x32_bf16 v[184:187], a[100:103], a[40:43], v[184:187]
    v_mfma_f32_16x16x32_bf16 v[188:191], a[100:103], a[44:47], v[188:191]
    v_mfma_f32_16x16x32_bf16 v[192:195], a[104:107], a[32:35], v[192:195]
    v_mfma_f32_16x16x32_bf16 v[196:199], a[104:107], a[36:39], v[196:199]
    v_mfma_f32_16x16x32_bf16 v[200:203], a[104:107], a[40:43], v[200:203]
    v_mfma_f32_16x16x32_bf16 v[204:207], a[104:107], a[44:47], v[204:207]
    v_mfma_f32_16x16x32_bf16 v[208:211], a[108:111], a[32:35], v[208:211]
    v_mfma_f32_16x16x32_bf16 v[212:215], a[108:111], a[36:39], v[212:215]
    v_mfma_f32_16x16x32_bf16 v[216:219], a[108:111], a[40:43], v[216:219]
    v_mfma_f32_16x16x32_bf16 v[220:223], a[108:111], a[44:47], v[220:223]
    s_waitcnt vmcnt(15) lgkmcnt(0)
    s_barrier
    v_mfma_f32_16x16x32_bf16 v[32:35], a[120:123], a[48:51], v[32:35]
    v_xor_b32 v8, 0x10000, v8
    v_mfma_f32_16x16x32_bf16 v[36:39], a[120:123], a[52:55], v[36:39]
    v_xor_b32 v9, 0x10000, v9
    v_mfma_f32_16x16x32_bf16 v[40:43], a[120:123], a[56:59], v[40:43]
    ds_read_b64_tr_b16 a[64:65], v8 offset:0
    v_mfma_f32_16x16x32_bf16 v[44:47], a[120:123], a[60:63], v[44:47]
    ds_read_b64_tr_b16 a[66:67], v8 offset:1792
    v_mfma_f32_16x16x32_bf16 v[48:51], a[124:127], a[48:51], v[48:51]
    ds_read_b64_tr_b16 a[68:69], v9 offset:32
    v_mfma_f32_16x16x32_bf16 v[52:55], a[124:127], a[52:55], v[52:55]
    ds_read_b64_tr_b16 a[70:71], v9 offset:1824
    v_mfma_f32_16x16x32_bf16 v[56:59], a[124:127], a[56:59], v[56:59]
    ds_read_b64_tr_b16 a[72:73], v8 offset:64
    v_mfma_f32_16x16x32_bf16 v[60:63], a[124:127], a[60:63], v[60:63]
    ds_read_b64_tr_b16 a[74:75], v8 offset:1856
    v_mfma_f32_16x16x32_bf16 v[64:67], a[128:131], a[48:51], v[64:67]
    ds_read_b64_tr_b16 a[76:77], v9 offset:96
    v_mfma_f32_16x16x32_bf16 v[68:71], a[128:131], a[52:55], v[68:71]
    ds_read_b64_tr_b16 a[78:79], v9 offset:1888
    v_mfma_f32_16x16x32_bf16 v[72:75], a[128:131], a[56:59], v[72:75]
    ds_read_b64_tr_b16 a[80:81], v8 offset:128
    buffer_load_dwordx4 a[32:35], v0, s[12:15], s25 offen offset:1024 sc1
    v_mfma_f32_16x16x32_bf16 v[76:79], a[128:131], a[60:63], v[76:79]
    ds_read_b64_tr_b16 a[82:83], v8 offset:1920
    v_mfma_f32_16x16x32_bf16 v[80:83], a[132:135], a[48:51], v[80:83]
    ds_read_b64_tr_b16 a[84:85], v9 offset:160
    v_mfma_f32_16x16x32_bf16 v[84:87], a[132:135], a[52:55], v[84:87]
    ds_read_b64_tr_b16 a[86:87], v9 offset:1952
    v_mfma_f32_16x16x32_bf16 v[88:91], a[132:135], a[56:59], v[88:91]
    ds_read_b64_tr_b16 a[88:89], v8 offset:192
    buffer_load_dwordx4 a[36:39], v0, s[12:15], s26 offen offset:1024 sc1
    v_mfma_f32_16x16x32_bf16 v[92:95], a[132:135], a[60:63], v[92:95]
    ds_read_b64_tr_b16 a[90:91], v8 offset:1984
    v_mfma_f32_16x16x32_bf16 v[96:99], a[136:139], a[48:51], v[96:99]
    ds_read_b64_tr_b16 a[92:93], v9 offset:224
    v_mfma_f32_16x16x32_bf16 v[100:103], a[136:139], a[52:55], v[100:103]
    ds_read_b64_tr_b16 a[94:95], v9 offset:2016
    v_mfma_f32_16x16x32_bf16 v[104:107], a[136:139], a[56:59], v[104:107]
    ds_read_b64_tr_b16 a[96:97], v8 offset:256
    buffer_load_dwordx4 a[40:43], v0, s[12:15], s27 offen offset:1024 sc1
    v_mfma_f32_16x16x32_bf16 v[108:111], a[136:139], a[60:63], v[108:111]
    ds_read_b64_tr_b16 a[98:99], v8 offset:2048
    v_mfma_f32_16x16x32_bf16 v[112:115], a[140:143], a[48:51], v[112:115]
    ds_read_b64_tr_b16 a[100:101], v9 offset:288
    v_mfma_f32_16x16x32_bf16 v[116:119], a[140:143], a[52:55], v[116:119]
    ds_read_b64_tr_b16 a[102:103], v9 offset:2080
    v_mfma_f32_16x16x32_bf16 v[120:123], a[140:143], a[56:59], v[120:123]
    ds_read_b64_tr_b16 a[104:105], v8 offset:320
    buffer_load_dwordx4 a[44:47], v0, s[12:15], s28 offen offset:1024 sc1
    v_mfma_f32_16x16x32_bf16 v[124:127], a[140:143], a[60:63], v[124:127]
    ds_read_b64_tr_b16 a[106:107], v8 offset:2112
    v_mfma_f32_16x16x32_bf16 v[128:131], a[144:147], a[48:51], v[128:131]
    ds_read_b64_tr_b16 a[108:109], v9 offset:352
    v_mfma_f32_16x16x32_bf16 v[132:135], a[144:147], a[52:55], v[132:135]
    ds_read_b64_tr_b16 a[110:111], v9 offset:2144
    v_mfma_f32_16x16x32_bf16 v[136:139], a[144:147], a[56:59], v[136:139]
    s_add_u32 s24, s24, s43
    s_add_u32 s38, s38, 32768
    s_and_b32 s38, s38, 131071
    s_mov_b32 m0, s38
    s_nop 0
    buffer_load_dwordx4 v1, s[8:11], s24 offen offset:0 lds
    v_mfma_f32_16x16x32_bf16 v[140:143], a[144:147], a[60:63], v[140:143]
    v_mfma_f32_16x16x32_bf16 v[144:147], a[148:151], a[48:51], v[144:147]
    v_mfma_f32_16x16x32_bf16 v[148:151], a[148:151], a[52:55], v[148:151]
    v_mfma_f32_16x16x32_bf16 v[152:155], a[148:151], a[56:59], v[152:155]
    buffer_load_dwordx4 v2, s[8:11], s24 offen offset:1024 lds
    v_mfma_f32_16x16x32_bf16 v[156:159], a[148:151], a[60:63], v[156:159]
    v_mfma_f32_16x16x32_bf16 v[160:163], a[152:155], a[48:51], v[160:163]
    v_mfma_f32_16x16x32_bf16 v[164:167], a[152:155], a[52:55], v[164:167]
    v_mfma_f32_16x16x32_bf16 v[168:171], a[152:155], a[56:59], v[168:171]
    buffer_load_dwordx4 v3, s[8:11], s24 offen offset:2048 lds
    v_mfma_f32_16x16x32_bf16 v[172:175], a[152:155], a[60:63], v[172:175]
    v_mfma_f32_16x16x32_bf16 v[176:179], a[156:159], a[48:51], v[176:179]
    v_mfma_f32_16x16x32_bf16 v[180:183], a[156:159], a[52:55], v[180:183]
    v_mfma_f32_16x16x32_bf16 v[184:187], a[156:159], a[56:59], v[184:187]
    buffer_load_dwordx4 v4, s[8:11], s24 offen offset:3072 lds
    v_mfma_f32_16x16x32_bf16 v[188:191], a[156:159], a[60:63], v[188:191]
    v_mfma_f32_16x16x32_bf16 v[192:195], a[160:163], a[48:51], v[192:195]
    v_mfma_f32_16x16x32_bf16 v[196:199], a[160:163], a[52:55], v[196:199]
    v_mfma_f32_16x16x32_bf16 v[200:203], a[160:163], a[56:59], v[200:203]
    v_mfma_f32_16x16x32_bf16 v[204:207], a[160:163], a[60:63], v[204:207]
    v_mfma_f32_16x16x32_bf16 v[208:211], a[164:167], a[48:51], v[208:211]
    v_mfma_f32_16x16x32_bf16 v[212:215], a[164:167], a[52:55], v[212:215]
    v_mfma_f32_16x16x32_bf16 v[216:219], a[164:167], a[56:59], v[216:219]
    v_mfma_f32_16x16x32_bf16 v[220:223], a[164:167], a[60:63], v[220:223]
    s_sub_u32 s29, s29, 1
    s_cmp_lg_u32 s29, 0
    s_cbranch_scc1 L_p1_n_loop
    s_waitcnt vmcnt(0)
    s_barrier
    v_and_b32 v3, 15, v17
    v_lshrrev_b32 v4, 4, v17
    v_lshrrev_b32 v7, 1, v4
    v_lshlrev_b32 v7, 10, v7
    v_and_b32 v8, 1, v4
    v_lshl_add_u32 v7, v8, 9, v7
    s_add_u32 s4, s40, 4194304
    s_addc_u32 s5, s41, 0
    s_mov_b32 s16, s4
    s_and_b32 s17, s5, 0xffff
    s_mov_b32 s18, 13000704
    s_mov_b32 s19, 0x00020000
    s_add_u32 s4, s40, 17825792
    s_addc_u32 s5, s41, 0
    s_mov_b32 s20, s4
    s_and_b32 s21, s5, 0xffff
    s_mov_b32 s22, 524288
    s_mov_b32 s23, 0x00020000
    v_lshl_add_u32 v8, v3, 4, v7
    v_lshrrev_b32 v9, 3, v3
    v_lshlrev_b32 v9, 8, v9
    v_and_b32 v10, 7, v3
    v_lshl_add_u32 v9, v10, 4, v9
    v_add_u32 v9, v9, v7
    v_lshlrev_b32 v10, 2, v17
    v_and_b32 v11, 1, v4
    v_cmp_eq_u32 s[48:49], 1, v11
    v_cmp_le_u32 s[60:61], 2, v4
    s_add_u32 s34, s32, 0
    s_cmp_lt_u32 s34, 32
    s_cselect_b32 s44, 0x3e8293ee, 1.0
    s_cselect_b32 s46, 0, 1
    s_mov_b32 s45, s44
    s_mul_i32 s35, s34, 135424
    s_lshl_b32 s36, s39, 6
    s_add_u32 s35, s35, s36
    s_lshl_b32 s36, s34, 13
    s_lshl_b32 s37, s39, 2
    s_add_u32 s36, s36, s37
    s_cmp_eq_u32 s46, 1
    s_cselect_b64 vcc, -1, 0
    s_lshr_b32 s47, 256, s46
    s_add_u32 s47, s47, s35
    v_cndmask_b32 v11, v8, v9, vcc
    v_pk_mul_f32 v[32:33], v[32:33], s[44:45]
    v_pk_mul_f32 v[34:35], v[34:35], s[44:45]
    v_pk_mul_f32 v[48:49], v[48:49], s[44:45]
    v_pk_mul_f32 v[50:51], v[50:51], s[44:45]
    v_pk_mul_f32 v[36:37], v[36:37], s[44:45]
    v_pk_mul_f32 v[38:39], v[38:39], s[44:45]
    v_pk_mul_f32 v[52:53], v[52:53], s[44:45]
    v_pk_mul_f32 v[54:55], v[54:55], s[44:45]
    v_pk_mul_f32 v[40:41], v[40:41], s[44:45]
    v_pk_mul_f32 v[42:43], v[42:43], s[44:45]
    v_pk_mul_f32 v[56:57], v[56:57], s[44:45]
    v_pk_mul_f32 v[58:59], v[58:59], s[44:45]
    v_pk_mul_f32 v[44:45], v[44:45], s[44:45]
    v_pk_mul_f32 v[46:47], v[46:47], s[44:45]
    v_pk_mul_f32 v[60:61], v[60:61], s[44:45]
    v_pk_mul_f32 v[62:63], v[62:63], s[44:45]
    v_pk_mul_f32 v[24:25], v[32:33], v[32:33]
    v_pk_mul_f32 v[26:27], v[36:37], v[36:37]
    v_pk_mul_f32 v[28:29], v[40:41], v[40:41]
    v_pk_mul_f32 v[30:31], v[44:45], v[44:45]
    v_pk_fma_f32 v[24:25], v[34:35], v[34:35], v[24:25]
    v_pk_fma_f32 v[26:27], v[38:39], v[38:39], v[26:27]
    v_pk_fma_f32 v[28:29], v[42:43], v[42:43], v[28:29]
    v_pk_fma_f32 v[30:31], v[46:47], v[46:47], v[30:31]
    v_pk_fma_f32 v[24:25], v[48:49], v[48:49], v[24:25]
    v_pk_fma_f32 v[26:27], v[52:53], v[52:53], v[26:27]
    v_pk_fma_f32 v[28:29], v[56:57], v[56:57], v[28:29]
    v_pk_fma_f32 v[30:31], v[60:61], v[60:61], v[30:31]
    v_pk_fma_f32 v[24:25], v[50:51], v[50:51], v[24:25]
    v_pk_fma_f32 v[26:27], v[54:55], v[54:55], v[26:27]
    v_pk_fma_f32 v[28:29], v[58:59], v[58:59], v[28:29]
    v_pk_fma_f32 v[30:31], v[62:63], v[62:63], v[30:31]
    v_cvt_pk_bf16_f32 v32, v32, v33
    v_cvt_pk_bf16_f32 v33, v34, v35
    v_cvt_pk_bf16_f32 v34, v48, v49
    v_cvt_pk_bf16_f32 v35, v50, v51
    buffer_store_dwordx4 v[32:35], v11, s[16:19], s35 offen offset:0 sc1
    v_cvt_pk_bf16_f32 v36, v36, v37
    v_cvt_pk_bf16_f32 v37, v38, v39
    v_cvt_pk_bf16_f32 v38, v52, v53
    v_cvt_pk_bf16_f32 v39, v54, v55
    buffer_store_dwordx4 v[36:39], v11, s[16:19], s47 offen offset:0 sc1
    v_cvt_pk_bf16_f32 v40, v40, v41
    v_cvt_pk_bf16_f32 v41, v42, v43
    v_cvt_pk_bf16_f32 v42, v56, v57
    v_cvt_pk_bf16_f32 v43, v58, v59
    buffer_store_dwordx4 v[40:43], v11, s[16:19], s35 offen offset:2048 sc1
    v_cvt_pk_bf16_f32 v44, v44, v45
    v_cvt_pk_bf16_f32 v45, v46, v47
    v_cvt_pk_bf16_f32 v46, v60, v61
    v_cvt_pk_bf16_f32 v47, v62, v63
    buffer_store_dwordx4 v[44:47], v11, s[16:19], s47 offen offset:2048 sc1
    v_add_f32 v24, v24, v25
    v_add_f32 v26, v26, v27
    v_add_f32 v28, v28, v29
    v_add_f32 v30, v30, v31
    v_mov_b32 v20, v24
    v_mov_b32 v21, v26
    v_mov_b32 v22, v28
    v_mov_b32 v23, v30
    v_permlane32_swap_b32 v24, v20
    v_permlane32_swap_b32 v26, v21
    v_permlane32_swap_b32 v28, v22
    v_permlane32_swap_b32 v30, v23
    v_add_f32 v24, v24, v20
    v_add_f32 v26, v26, v21
    v_add_f32 v28, v28, v22
    v_add_f32 v30, v30, v23
    v_mov_b32 v20, v24
    v_mov_b32 v21, v26
    v_mov_b32 v22, v28
    v_mov_b32 v23, v30
    v_permlane16_swap_b32 v24, v20
    v_permlane16_swap_b32 v26, v21
    v_permlane16_swap_b32 v28, v22
    v_permlane16_swap_b32 v30, v23
    v_add_f32 v24, v24, v20
    v_add_f32 v26, v26, v21
    v_add_f32 v28, v28, v22
    v_add_f32 v30, v30, v23
    v_cndmask_b32 v24, v24, v26, s[48:49]
    v_cndmask_b32 v28, v28, v30, s[48:49]
    v_cndmask_b32 v24, v24, v28, s[60:61]
    buffer_store_dword v24, v10, s[20:23], s36 offen sc1
    s_add_u32 s34, s32, 1
    s_cmp_lt_u32 s34, 32
    s_cselect_b32 s44, 0x3e8293ee, 1.0
    s_cselect_b32 s46, 0, 1
    s_mov_b32 s45, s44
    s_mul_i32 s35, s34, 135424
    s_lshl_b32 s36, s39, 6
    s_add_u32 s35, s35, s36
    s_lshl_b32 s36, s34, 13
    s_lshl_b32 s37, s39, 2
    s_add_u32 s36, s36, s37
    s_cmp_eq_u32 s46, 1
    s_cselect_b64 vcc, -1, 0
    s_lshr_b32 s47, 256, s46
    s_add_u32 s47, s47, s35
    v_cndmask_b32 v11, v8, v9, vcc
    v_pk_mul_f32 v[64:65], v[64:65], s[44:45]
    v_pk_mul_f32 v[66:67], v[66:67], s[44:45]
    v_pk_mul_f32 v[80:81], v[80:81], s[44:45]
    v_pk_mul_f32 v[82:83], v[82:83], s[44:45]
    v_pk_mul_f32 v[68:69], v[68:69], s[44:45]
    v_pk_mul_f32 v[70:71], v[70:71], s[44:45]
    v_pk_mul_f32 v[84:85], v[84:85], s[44:45]
    v_pk_mul_f32 v[86:87], v[86:87], s[44:45]
    v_pk_mul_f32 v[72:73], v[72:73], s[44:45]
    v_pk_mul_f32 v[74:75], v[74:75], s[44:45]
    v_pk_mul_f32 v[88:89], v[88:89], s[44:45]
    v_pk_mul_f32 v[90:91], v[90:91], s[44:45]
    v_pk_mul_f32 v[76:77], v[76:77], s[44:45]
    v_pk_mul_f32 v[78:79], v[78:79], s[44:45]
    v_pk_mul_f32 v[92:93], v[92:93], s[44:45]
    v_pk_mul_f32 v[94:95], v[94:95], s[44:45]
    v_pk_mul_f32 v[24:25], v[64:65], v[64:65]
    v_pk_mul_f32 v[26:27], v[68:69], v[68:69]
    v_pk_mul_f32 v[28:29], v[72:73], v[72:73]
    v_pk_mul_f32 v[30:31], v[76:77], v[76:77]
    v_pk_fma_f32 v[24:25], v[66:67], v[66:67], v[24:25]
    v_pk_fma_f32 v[26:27], v[70:71], v[70:71], v[26:27]
    v_pk_fma_f32 v[28:29], v[74:75], v[74:75], v[28:29]
    v_pk_fma_f32 v[30:31], v[78:79], v[78:79], v[30:31]
    v_pk_fma_f32 v[24:25], v[80:81], v[80:81], v[24:25]
    v_pk_fma_f32 v[26:27], v[84:85], v[84:85], v[26:27]
    v_pk_fma_f32 v[28:29], v[88:89], v[88:89], v[28:29]
    v_pk_fma_f32 v[30:31], v[92:93], v[92:93], v[30:31]
    v_pk_fma_f32 v[24:25], v[82:83], v[82:83], v[24:25]
    v_pk_fma_f32 v[26:27], v[86:87], v[86:87], v[26:27]
    v_pk_fma_f32 v[28:29], v[90:91], v[90:91], v[28:29]
    v_pk_fma_f32 v[30:31], v[94:95], v[94:95], v[30:31]
    v_cvt_pk_bf16_f32 v64, v64, v65
    v_cvt_pk_bf16_f32 v65, v66, v67
    v_cvt_pk_bf16_f32 v66, v80, v81
    v_cvt_pk_bf16_f32 v67, v82, v83
    buffer_store_dwordx4 v[64:67], v11, s[16:19], s35 offen offset:0 sc1
    v_cvt_pk_bf16_f32 v68, v68, v69
    v_cvt_pk_bf16_f32 v69, v70, v71
    v_cvt_pk_bf16_f32 v70, v84, v85
    v_cvt_pk_bf16_f32 v71, v86, v87
    buffer_store_dwordx4 v[68:71], v11, s[16:19], s47 offen offset:0 sc1
    v_cvt_pk_bf16_f32 v72, v72, v73
    v_cvt_pk_bf16_f32 v73, v74, v75
    v_cvt_pk_bf16_f32 v74, v88, v89
    v_cvt_pk_bf16_f32 v75, v90, v91
    buffer_store_dwordx4 v[72:75], v11, s[16:19], s35 offen offset:2048 sc1
    v_cvt_pk_bf16_f32 v76, v76, v77
    v_cvt_pk_bf16_f32 v77, v78, v79
    v_cvt_pk_bf16_f32 v78, v92, v93
    v_cvt_pk_bf16_f32 v79, v94, v95
    buffer_store_dwordx4 v[76:79], v11, s[16:19], s47 offen offset:2048 sc1
    v_add_f32 v24, v24, v25
    v_add_f32 v26, v26, v27
    v_add_f32 v28, v28, v29
    v_add_f32 v30, v30, v31
    v_mov_b32 v20, v24
    v_mov_b32 v21, v26
    v_mov_b32 v22, v28
    v_mov_b32 v23, v30
    v_permlane32_swap_b32 v24, v20
    v_permlane32_swap_b32 v26, v21
    v_permlane32_swap_b32 v28, v22
    v_permlane32_swap_b32 v30, v23
    v_add_f32 v24, v24, v20
    v_add_f32 v26, v26, v21
    v_add_f32 v28, v28, v22
    v_add_f32 v30, v30, v23
    v_mov_b32 v20, v24
    v_mov_b32 v21, v26
    v_mov_b32 v22, v28
    v_mov_b32 v23, v30
    v_permlane16_swap_b32 v24, v20
    v_permlane16_swap_b32 v26, v21
    v_permlane16_swap_b32 v28, v22
    v_permlane16_swap_b32 v30, v23
    v_add_f32 v24, v24, v20
    v_add_f32 v26, v26, v21
    v_add_f32 v28, v28, v22
    v_add_f32 v30, v30, v23
    v_cndmask_b32 v24, v24, v26, s[48:49]
    v_cndmask_b32 v28, v28, v30, s[48:49]
    v_cndmask_b32 v24, v24, v28, s[60:61]
    buffer_store_dword v24, v10, s[20:23], s36 offen sc1
    s_add_u32 s34, s32, 2
    s_cmp_lt_u32 s34, 32
    s_cselect_b32 s44, 0x3e8293ee, 1.0
    s_cselect_b32 s46, 0, 1
    s_mov_b32 s45, s44
    s_mul_i32 s35, s34, 135424
    s_lshl_b32 s36, s39, 6
    s_add_u32 s35, s35, s36
    s_lshl_b32 s36, s34, 13
    s_lshl_b32 s37, s39, 2
    s_add_u32 s36, s36, s37
    s_cmp_eq_u32 s46, 1
    s_cselect_b64 vcc, -1, 0
    s_lshr_b32 s47, 256, s46
    s_add_u32 s47, s47, s35
    v_cndmask_b32 v11, v8, v9, vcc
    v_pk_mul_f32 v[96:97], v[96:97], s[44:45]
    v_pk_mul_f32 v[98:99], v[98:99], s[44:45]
    v_pk_mul_f32 v[112:113], v[112:113], s[44:45]
    v_pk_mul_f32 v[114:115], v[114:115], s[44:45]
    v_pk_mul_f32 v[100:101], v[100:101], s[44:45]
    v_pk_mul_f32 v[102:103], v[102:103], s[44:45]
    v_pk_mul_f32 v[116:117], v[116:117], s[44:45]
    v_pk_mul_f32 v[118:119], v[118:119], s[44:45]
    v_pk_mul_f32 v[104:105], v[104:105], s[44:45]
    v_pk_mul_f32 v[106:107], v[106:107], s[44:45]
    v_pk_mul_f32 v[120:121], v[120:121], s[44:45]
    v_pk_mul_f32 v[122:123], v[122:123], s[44:45]
    v_pk_mul_f32 v[108:109], v[108:109], s[44:45]
    v_pk_mul_f32 v[110:111], v[110:111], s[44:45]
    v_pk_mul_f32 v[124:125], v[124:125], s[44:45]
    v_pk_mul_f32 v[126:127], v[126:127], s[44:45]
    v_pk_mul_f32 v[24:25], v[96:97], v[96:97]
    v_pk_mul_f32 v[26:27], v[100:101], v[100:101]
    v_pk_mul_f32 v[28:29], v[104:105], v[104:105]
    v_pk_mul_f32 v[30:31], v[108:109], v[108:109]
    v_pk_fma_f32 v[24:25], v[98:99], v[98:99], v[24:25]
    v_pk_fma_f32 v[26:27], v[102:103], v[102:103], v[26:27]
    v_pk_fma_f32 v[28:29], v[106:107], v[106:107], v[28:29]
    v_pk_fma_f32 v[30:31], v[110:111], v[110:111], v[30:31]
    v_pk_fma_f32 v[24:25], v[112:113], v[112:113], v[24:25]
    v_pk_fma_f32 v[26:27], v[116:117], v[116:117], v[26:27]
    v_pk_fma_f32 v[28:29], v[120:121], v[120:121], v[28:29]
    v_pk_fma_f32 v[30:31], v[124:125], v[124:125], v[30:31]
    v_pk_fma_f32 v[24:25], v[114:115], v[114:115], v[24:25]
    v_pk_fma_f32 v[26:27], v[118:119], v[118:119], v[26:27]
    v_pk_fma_f32 v[28:29], v[122:123], v[122:123], v[28:29]
    v_pk_fma_f32 v[30:31], v[126:127], v[126:127], v[30:31]
    v_cvt_pk_bf16_f32 v96, v96, v97
    v_cvt_pk_bf16_f32 v97, v98, v99
    v_cvt_pk_bf16_f32 v98, v112, v113
    v_cvt_pk_bf16_f32 v99, v114, v115
    buffer_store_dwordx4 v[96:99], v11, s[16:19], s35 offen offset:0 sc1
    v_cvt_pk_bf16_f32 v100, v100, v101
    v_cvt_pk_bf16_f32 v101, v102, v103
    v_cvt_pk_bf16_f32 v102, v116, v117
    v_cvt_pk_bf16_f32 v103, v118, v119
    buffer_store_dwordx4 v[100:103], v11, s[16:19], s47 offen offset:0 sc1
    v_cvt_pk_bf16_f32 v104, v104, v105
    v_cvt_pk_bf16_f32 v105, v106, v107
    v_cvt_pk_bf16_f32 v106, v120, v121
    v_cvt_pk_bf16_f32 v107, v122, v123
    buffer_store_dwordx4 v[104:107], v11, s[16:19], s35 offen offset:2048 sc1
    v_cvt_pk_bf16_f32 v108, v108, v109
    v_cvt_pk_bf16_f32 v109, v110, v111
    v_cvt_pk_bf16_f32 v110, v124, v125
    v_cvt_pk_bf16_f32 v111, v126, v127
    buffer_store_dwordx4 v[108:111], v11, s[16:19], s47 offen offset:2048 sc1
    v_add_f32 v24, v24, v25
    v_add_f32 v26, v26, v27
    v_add_f32 v28, v28, v29
    v_add_f32 v30, v30, v31
    v_mov_b32 v20, v24
    v_mov_b32 v21, v26
    v_mov_b32 v22, v28
    v_mov_b32 v23, v30
    v_permlane32_swap_b32 v24, v20
    v_permlane32_swap_b32 v26, v21
    v_permlane32_swap_b32 v28, v22
    v_permlane32_swap_b32 v30, v23
    v_add_f32 v24, v24, v20
    v_add_f32 v26, v26, v21
    v_add_f32 v28, v28, v22
    v_add_f32 v30, v30, v23
    v_mov_b32 v20, v24
    v_mov_b32 v21, v26
    v_mov_b32 v22, v28
    v_mov_b32 v23, v30
    v_permlane16_swap_b32 v24, v20
    v_permlane16_swap_b32 v26, v21
    v_permlane16_swap_b32 v28, v22
    v_permlane16_swap_b32 v30, v23
    v_add_f32 v24, v24, v20
    v_add_f32 v26, v26, v21
    v_add_f32 v28, v28, v22
    v_add_f32 v30, v30, v23
    v_cndmask_b32 v24, v24, v26, s[48:49]
    v_cndmask_b32 v28, v28, v30, s[48:49]
    v_cndmask_b32 v24, v24, v28, s[60:61]
    buffer_store_dword v24, v10, s[20:23], s36 offen sc1
    s_add_u32 s34, s32, 3
    s_cmp_lt_u32 s34, 32
    s_cselect_b32 s44, 0x3e8293ee, 1.0
    s_cselect_b32 s46, 0, 1
    s_mov_b32 s45, s44
    s_mul_i32 s35, s34, 135424
    s_lshl_b32 s36, s39, 6
    s_add_u32 s35, s35, s36
    s_lshl_b32 s36, s34, 13
    s_lshl_b32 s37, s39, 2
    s_add_u32 s36, s36, s37
    s_cmp_eq_u32 s46, 1
    s_cselect_b64 vcc, -1, 0
    s_lshr_b32 s47, 256, s46
    s_add_u32 s47, s47, s35
    v_cndmask_b32 v11, v8, v9, vcc
    v_pk_mul_f32 v[128:129], v[128:129], s[44:45]
    v_pk_mul_f32 v[130:131], v[130:131], s[44:45]
    v_pk_mul_f32 v[144:145], v[144:145], s[44:45]
    v_pk_mul_f32 v[146:147], v[146:147], s[44:45]
    v_pk_mul_f32 v[132:133], v[132:133], s[44:45]
    v_pk_mul_f32 v[134:135], v[134:135], s[44:45]
    v_pk_mul_f32 v[148:149], v[148:149], s[44:45]
    v_pk_mul_f32 v[150:151], v[150:151], s[44:45]
    v_pk_mul_f32 v[136:137], v[136:137], s[44:45]
    v_pk_mul_f32 v[138:139], v[138:139], s[44:45]
    v_pk_mul_f32 v[152:153], v[152:153], s[44:45]
    v_pk_mul_f32 v[154:155], v[154:155], s[44:45]
    v_pk_mul_f32 v[140:141], v[140:141], s[44:45]
    v_pk_mul_f32 v[142:143], v[142:143], s[44:45]
    v_pk_mul_f32 v[156:157], v[156:157], s[44:45]
    v_pk_mul_f32 v[158:159], v[158:159], s[44:45]
    v_pk_mul_f32 v[24:25], v[128:129], v[128:129]
    v_pk_mul_f32 v[26:27], v[132:133], v[132:133]
    v_pk_mul_f32 v[28:29], v[136:137], v[136:137]
    v_pk_mul_f32 v[30:31], v[140:141], v[140:141]
    v_pk_fma_f32 v[24:25], v[130:131], v[130:131], v[24:25]
    v_pk_fma_f32 v[26:27], v[134:135], v[134:135], v[26:27]
    v_pk_fma_f32 v[28:29], v[138:139], v[138:139], v[28:29]
    v_pk_fma_f32 v[30:31], v[142:143], v[142:143], v[30:31]
    v_pk_fma_f32 v[24:25], v[144:145], v[144:145], v[24:25]
    v_pk_fma_f32 v[26:27], v[148:149], v[148:149], v[26:27]
    v_pk_fma_f32 v[28:29], v[152:153], v[152:153], v[28:29]
    v_pk_fma_f32 v[30:31], v[156:157], v[156:157], v[30:31]
    v_pk_fma_f32 v[24:25], v[146:147], v[146:147], v[24:25]
    v_pk_fma_f32 v[26:27], v[150:151], v[150:151], v[26:27]
    v_pk_fma_f32 v[28:29], v[154:155], v[154:155], v[28:29]
    v_pk_fma_f32 v[30:31], v[158:159], v[158:159], v[30:31]
    v_cvt_pk_bf16_f32 v128, v128, v129
    v_cvt_pk_bf16_f32 v129, v130, v131
    v_cvt_pk_bf16_f32 v130, v144, v145
    v_cvt_pk_bf16_f32 v131, v146, v147
    buffer_store_dwordx4 v[128:131], v11, s[16:19], s35 offen offset:0 sc1
    v_cvt_pk_bf16_f32 v132, v132, v133
    v_cvt_pk_bf16_f32 v133, v134, v135
    v_cvt_pk_bf16_f32 v134, v148, v149
    v_cvt_pk_bf16_f32 v135, v150, v151
    buffer_store_dwordx4 v[132:135], v11, s[16:19], s47 offen offset:0 sc1
    v_cvt_pk_bf16_f32 v136, v136, v137
    v_cvt_pk_bf16_f32 v137, v138, v139
    v_cvt_pk_bf16_f32 v138, v152, v153
    v_cvt_pk_bf16_f32 v139, v154, v155
    buffer_store_dwordx4 v[136:139], v11, s[16:19], s35 offen offset:2048 sc1
    v_cvt_pk_bf16_f32 v140, v140, v141
    v_cvt_pk_bf16_f32 v141, v142, v143
    v_cvt_pk_bf16_f32 v142, v156, v157
    v_cvt_pk_bf16_f32 v143, v158, v159
    buffer_store_dwordx4 v[140:143], v11, s[16:19], s47 offen offset:2048 sc1
    v_add_f32 v24, v24, v25
    v_add_f32 v26, v26, v27
    v_add_f32 v28, v28, v29
    v_add_f32 v30, v30, v31
    v_mov_b32 v20, v24
    v_mov_b32 v21, v26
    v_mov_b32 v22, v28
    v_mov_b32 v23, v30
    v_permlane32_swap_b32 v24, v20
    v_permlane32_swap_b32 v26, v21
    v_permlane32_swap_b32 v28, v22
    v_permlane32_swap_b32 v30, v23
    v_add_f32 v24, v24, v20
    v_add_f32 v26, v26, v21
    v_add_f32 v28, v28, v22
    v_add_f32 v30, v30, v23
    v_mov_b32 v20, v24
    v_mov_b32 v21, v26
    v_mov_b32 v22, v28
    v_mov_b32 v23, v30
    v_permlane16_swap_b32 v24, v20
    v_permlane16_swap_b32 v26, v21
    v_permlane16_swap_b32 v28, v22
    v_permlane16_swap_b32 v30, v23
    v_add_f32 v24, v24, v20
    v_add_f32 v26, v26, v21
    v_add_f32 v28, v28, v22
    v_add_f32 v30, v30, v23
    v_cndmask_b32 v24, v24, v26, s[48:49]
    v_cndmask_b32 v28, v28, v30, s[48:49]
    v_cndmask_b32 v24, v24, v28, s[60:61]
    buffer_store_dword v24, v10, s[20:23], s36 offen sc1
    s_add_u32 s34, s32, 4
    s_cmp_lt_u32 s34, 32
    s_cselect_b32 s44, 0x3e8293ee, 1.0
    s_cselect_b32 s46, 0, 1
    s_mov_b32 s45, s44
    s_mul_i32 s35, s34, 135424
    s_lshl_b32 s36, s39, 6
    s_add_u32 s35, s35, s36
    s_lshl_b32 s36, s34, 13
    s_lshl_b32 s37, s39, 2
    s_add_u32 s36, s36, s37
    s_cmp_eq_u32 s46, 1
    s_cselect_b64 vcc, -1, 0
    s_lshr_b32 s47, 256, s46
    s_add_u32 s47, s47, s35
    v_cndmask_b32 v11, v8, v9, vcc
    v_pk_mul_f32 v[160:161], v[160:161], s[44:45]
    v_pk_mul_f32 v[162:163], v[162:163], s[44:45]
    v_pk_mul_f32 v[176:177], v[176:177], s[44:45]
    v_pk_mul_f32 v[178:179], v[178:179], s[44:45]
    v_pk_mul_f32 v[164:165], v[164:165], s[44:45]
    v_pk_mul_f32 v[166:167], v[166:167], s[44:45]
    v_pk_mul_f32 v[180:181], v[180:181], s[44:45]
    v_pk_mul_f32 v[182:183], v[182:183], s[44:45]
    v_pk_mul_f32 v[168:169], v[168:169], s[44:45]
    v_pk_mul_f32 v[170:171], v[170:171], s[44:45]
    v_pk_mul_f32 v[184:185], v[184:185], s[44:45]
    v_pk_mul_f32 v[186:187], v[186:187], s[44:45]
    v_pk_mul_f32 v[172:173], v[172:173], s[44:45]
    v_pk_mul_f32 v[174:175], v[174:175], s[44:45]
    v_pk_mul_f32 v[188:189], v[188:189], s[44:45]
    v_pk_mul_f32 v[190:191], v[190:191], s[44:45]
    v_pk_mul_f32 v[24:25], v[160:161], v[160:161]
    v_pk_mul_f32 v[26:27], v[164:165], v[164:165]
    v_pk_mul_f32 v[28:29], v[168:169], v[168:169]
    v_pk_mul_f32 v[30:31], v[172:173], v[172:173]
    v_pk_fma_f32 v[24:25], v[162:163], v[162:163], v[24:25]
    v_pk_fma_f32 v[26:27], v[166:167], v[166:167], v[26:27]
    v_pk_fma_f32 v[28:29], v[170:171], v[170:171], v[28:29]
    v_pk_fma_f32 v[30:31], v[174:175], v[174:175], v[30:31]
    v_pk_fma_f32 v[24:25], v[176:177], v[176:177], v[24:25]
    v_pk_fma_f32 v[26:27], v[180:181], v[180:181], v[26:27]
    v_pk_fma_f32 v[28:29], v[184:185], v[184:185], v[28:29]
    v_pk_fma_f32 v[30:31], v[188:189], v[188:189], v[30:31]
    v_pk_fma_f32 v[24:25], v[178:179], v[178:179], v[24:25]
    v_pk_fma_f32 v[26:27], v[182:183], v[182:183], v[26:27]
    v_pk_fma_f32 v[28:29], v[186:187], v[186:187], v[28:29]
    v_pk_fma_f32 v[30:31], v[190:191], v[190:191], v[30:31]
    v_cvt_pk_bf16_f32 v160, v160, v161
    v_cvt_pk_bf16_f32 v161, v162, v163
    v_cvt_pk_bf16_f32 v162, v176, v177
    v_cvt_pk_bf16_f32 v163, v178, v179
    buffer_store_dwordx4 v[160:163], v11, s[16:19], s35 offen offset:0 sc1
    v_cvt_pk_bf16_f32 v164, v164, v165
    v_cvt_pk_bf16_f32 v165, v166, v167
    v_cvt_pk_bf16_f32 v166, v180, v181
    v_cvt_pk_bf16_f32 v167, v182, v183
    buffer_store_dwordx4 v[164:167], v11, s[16:19], s47 offen offset:0 sc1
    v_cvt_pk_bf16_f32 v168, v168, v169
    v_cvt_pk_bf16_f32 v169, v170, v171
    v_cvt_pk_bf16_f32 v170, v184, v185
    v_cvt_pk_bf16_f32 v171, v186, v187
    buffer_store_dwordx4 v[168:171], v11, s[16:19], s35 offen offset:2048 sc1
    v_cvt_pk_bf16_f32 v172, v172, v173
    v_cvt_pk_bf16_f32 v173, v174, v175
    v_cvt_pk_bf16_f32 v174, v188, v189
    v_cvt_pk_bf16_f32 v175, v190, v191
    buffer_store_dwordx4 v[172:175], v11, s[16:19], s47 offen offset:2048 sc1
    v_add_f32 v24, v24, v25
    v_add_f32 v26, v26, v27
    v_add_f32 v28, v28, v29
    v_add_f32 v30, v30, v31
    v_mov_b32 v20, v24
    v_mov_b32 v21, v26
    v_mov_b32 v22, v28
    v_mov_b32 v23, v30
    v_permlane32_swap_b32 v24, v20
    v_permlane32_swap_b32 v26, v21
    v_permlane32_swap_b32 v28, v22
    v_permlane32_swap_b32 v30, v23
    v_add_f32 v24, v24, v20
    v_add_f32 v26, v26, v21
    v_add_f32 v28, v28, v22
    v_add_f32 v30, v30, v23
    v_mov_b32 v20, v24
    v_mov_b32 v21, v26
    v_mov_b32 v22, v28
    v_mov_b32 v23, v30
    v_permlane16_swap_b32 v24, v20
    v_permlane16_swap_b32 v26, v21
    v_permlane16_swap_b32 v28, v22
    v_permlane16_swap_b32 v30, v23
    v_add_f32 v24, v24, v20
    v_add_f32 v26, v26, v21
    v_add_f32 v28, v28, v22
    v_add_f32 v30, v30, v23
    v_cndmask_b32 v24, v24, v26, s[48:49]
    v_cndmask_b32 v28, v28, v30, s[48:49]
    v_cndmask_b32 v24, v24, v28, s[60:61]
    buffer_store_dword v24, v10, s[20:23], s36 offen sc1
    s_add_u32 s34, s32, 5
    s_cmp_lt_u32 s34, 32
    s_cselect_b32 s44, 0x3e8293ee, 1.0
    s_cselect_b32 s46, 0, 1
    s_mov_b32 s45, s44
    s_mul_i32 s35, s34, 135424
    s_lshl_b32 s36, s39, 6
    s_add_u32 s35, s35, s36
    s_lshl_b32 s36, s34, 13
    s_lshl_b32 s37, s39, 2
    s_add_u32 s36, s36, s37
    s_cmp_eq_u32 s46, 1
    s_cselect_b64 vcc, -1, 0
    s_lshr_b32 s47, 256, s46
    s_add_u32 s47, s47, s35
    v_cndmask_b32 v11, v8, v9, vcc
    v_pk_mul_f32 v[192:193], v[192:193], s[44:45]
    v_pk_mul_f32 v[194:195], v[194:195], s[44:45]
    v_pk_mul_f32 v[208:209], v[208:209], s[44:45]
    v_pk_mul_f32 v[210:211], v[210:211], s[44:45]
    v_pk_mul_f32 v[196:197], v[196:197], s[44:45]
    v_pk_mul_f32 v[198:199], v[198:199], s[44:45]
    v_pk_mul_f32 v[212:213], v[212:213], s[44:45]
    v_pk_mul_f32 v[214:215], v[214:215], s[44:45]
    v_pk_mul_f32 v[200:201], v[200:201], s[44:45]
    v_pk_mul_f32 v[202:203], v[202:203], s[44:45]
    v_pk_mul_f32 v[216:217], v[216:217], s[44:45]
    v_pk_mul_f32 v[218:219], v[218:219], s[44:45]
    v_pk_mul_f32 v[204:205], v[204:205], s[44:45]
    v_pk_mul_f32 v[206:207], v[206:207], s[44:45]
    v_pk_mul_f32 v[220:221], v[220:221], s[44:45]
    v_pk_mul_f32 v[222:223], v[222:223], s[44:45]
    v_pk_mul_f32 v[24:25], v[192:193], v[192:193]
    v_pk_mul_f32 v[26:27], v[196:197], v[196:197]
    v_pk_mul_f32 v[28:29], v[200:201], v[200:201]
    v_pk_mul_f32 v[30:31], v[204:205], v[204:205]
    v_pk_fma_f32 v[24:25], v[194:195], v[194:195], v[24:25]
    v_pk_fma_f32 v[26:27], v[198:199], v[198:199], v[26:27]
    v_pk_fma_f32 v[28:29], v[202:203], v[202:203], v[28:29]
    v_pk_fma_f32 v[30:31], v[206:207], v[206:207], v[30:31]
    v_pk_fma_f32 v[24:25], v[208:209], v[208:209], v[24:25]
    v_pk_fma_f32 v[26:27], v[212:213], v[212:213], v[26:27]
    v_pk_fma_f32 v[28:29], v[216:217], v[216:217], v[28:29]
    v_pk_fma_f32 v[30:31], v[220:221], v[220:221], v[30:31]
    v_pk_fma_f32 v[24:25], v[210:211], v[210:211], v[24:25]
    v_pk_fma_f32 v[26:27], v[214:215], v[214:215], v[26:27]
    v_pk_fma_f32 v[28:29], v[218:219], v[218:219], v[28:29]
    v_pk_fma_f32 v[30:31], v[222:223], v[222:223], v[30:31]
    v_cvt_pk_bf16_f32 v192, v192, v193
    v_cvt_pk_bf16_f32 v193, v194, v195
    v_cvt_pk_bf16_f32 v194, v208, v209
    v_cvt_pk_bf16_f32 v195, v210, v211
    buffer_store_dwordx4 v[192:195], v11, s[16:19], s35 offen offset:0 sc1
    v_cvt_pk_bf16_f32 v196, v196, v197
    v_cvt_pk_bf16_f32 v197, v198, v199
    v_cvt_pk_bf16_f32 v198, v212, v213
    v_cvt_pk_bf16_f32 v199, v214, v215
    buffer_store_dwordx4 v[196:199], v11, s[16:19], s47 offen offset:0 sc1
    v_cvt_pk_bf16_f32 v200, v200, v201
    v_cvt_pk_bf16_f32 v201, v202, v203
    v_cvt_pk_bf16_f32 v202, v216, v217
    v_cvt_pk_bf16_f32 v203, v218, v219
    buffer_store_dwordx4 v[200:203], v11, s[16:19], s35 offen offset:2048 sc1
    v_cvt_pk_bf16_f32 v204, v204, v205
    v_cvt_pk_bf16_f32 v205, v206, v207
    v_cvt_pk_bf16_f32 v206, v220, v221
    v_cvt_pk_bf16_f32 v207, v222, v223
    buffer_store_dwordx4 v[204:207], v11, s[16:19], s47 offen offset:2048 sc1
    v_add_f32 v24, v24, v25
    v_add_f32 v26, v26, v27
    v_add_f32 v28, v28, v29
    v_add_f32 v30, v30, v31
    v_mov_b32 v20, v24
    v_mov_b32 v21, v26
    v_mov_b32 v22, v28
    v_mov_b32 v23, v30
    v_permlane32_swap_b32 v24, v20
    v_permlane32_swap_b32 v26, v21
    v_permlane32_swap_b32 v28, v22
    v_permlane32_swap_b32 v30, v23
    v_add_f32 v24, v24, v20
    v_add_f32 v26, v26, v21
    v_add_f32 v28, v28, v22
    v_add_f32 v30, v30, v23
    v_mov_b32 v20, v24
    v_mov_b32 v21, v26
    v_mov_b32 v22, v28
    v_mov_b32 v23, v30
    v_permlane16_swap_b32 v24, v20
    v_permlane16_swap_b32 v26, v21
    v_permlane16_swap_b32 v28, v22
    v_permlane16_swap_b32 v30, v23
    v_add_f32 v24, v24, v20
    v_add_f32 v26, v26, v21
    v_add_f32 v28, v28, v22
    v_add_f32 v30, v30, v23
    v_cndmask_b32 v24, v24, v26, s[48:49]
    v_cndmask_b32 v28, v28, v30, s[48:49]
    v_cndmask_b32 v24, v24, v28, s[60:61]
    buffer_store_dword v24, v10, s[20:23], s36 offen sc1
    s_branch L_p1_sigqkv
L_p1_mpath:
    ds_read_b64_tr_b16 a[64:65], v8 offset:0
    ds_read_b64_tr_b16 a[66:67], v8 offset:1792
    ds_read_b64_tr_b16 a[68:69], v9 offset:32
    ds_read_b64_tr_b16 a[70:71], v9 offset:1824
    ds_read_b64_tr_b16 a[72:73], v8 offset:64
    ds_read_b64_tr_b16 a[74:75], v8 offset:1856
    ds_read_b64_tr_b16 a[76:77], v9 offset:96
    ds_read_b64_tr_b16 a[78:79], v9 offset:1888
    ds_read_b64_tr_b16 a[80:81], v8 offset:128
    ds_read_b64_tr_b16 a[82:83], v8 offset:1920
    ds_read_b64_tr_b16 a[84:85], v9 offset:160
    ds_read_b64_tr_b16 a[86:87], v9 offset:1952
    ds_read_b64_tr_b16 a[88:89], v8 offset:192
    ds_read_b64_tr_b16 a[90:91], v8 offset:1984
    ds_read_b64_tr_b16 a[92:93], v9 offset:224
    ds_read_b64_tr_b16 a[94:95], v9 offset:2016
    ds_read_b64_tr_b16 a[96:97], v8 offset:256
    ds_read_b64_tr_b16 a[98:99], v8 offset:2048
    ds_read_b64_tr_b16 a[100:101], v9 offset:288
    ds_read_b64_tr_b16 a[102:103], v9 offset:2080
    ds_read_b64_tr_b16 a[104:105], v8 offset:320
    ds_read_b64_tr_b16 a[106:107], v8 offset:2112
    ds_read_b64_tr_b16 a[108:109], v9 offset:352
    ds_read_b64_tr_b16 a[110:111], v9 offset:2144
    s_waitcnt vmcnt(0)
.p2align 6
L_p1_m_loop:
    s_waitcnt vmcnt(19) lgkmcnt(0)
    v_mfma_f32_16x16x32_bf16 v[32:35], a[64:67], a[0:3], v[32:35]
    ds_read_b64_tr_b16 a[120:121], v8 offset:14336
    v_mfma_f32_16x16x32_bf16 v[36:39], a[64:67], a[4:7], v[36:39]
    ds_read_b64_tr_b16 a[122:123], v8 offset:16128
    v_mfma_f32_16x16x32_bf16 v[40:43], a[64:67], a[8:11], v[40:43]
    ds_read_b64_tr_b16 a[124:125], v9 offset:14368
    v_mfma_f32_16x16x32_bf16 v[44:47], a[64:67], a[12:15], v[44:47]
    ds_read_b64_tr_b16 a[126:127], v9 offset:16160
    v_mfma_f32_16x16x32_bf16 v[48:51], a[68:71], a[0:3], v[48:51]
    ds_read_b64_tr_b16 a[128:129], v8 offset:14400
    v_mfma_f32_16x16x32_bf16 v[52:55], a[68:71], a[4:7], v[52:55]
    ds_read_b64_tr_b16 a[130:131], v8 offset:16192
    v_mfma_f32_16x16x32_bf16 v[56:59], a[68:71], a[8:11], v[56:59]
    ds_read_b64_tr_b16 a[132:133], v9 offset:14432
    v_mfma_f32_16x16x32_bf16 v[60:63], a[68:71], a[12:15], v[60:63]
    ds_read_b64_tr_b16 a[134:135], v9 offset:16224
    v_mfma_f32_16x16x32_bf16 v[64:67], a[72:75], a[0:3], v[64:67]
    ds_read_b64_tr_b16 a[136:137], v8 offset:14464
    v_mfma_f32_16x16x32_bf16 v[68:71], a[72:75], a[4:7], v[68:71]
    ds_read_b64_tr_b16 a[138:139], v8 offset:16256
    v_mfma_f32_16x16x32_bf16 v[72:75], a[72:75], a[8:11], v[72:75]
    ds_read_b64_tr_b16 a[140:141], v9 offset:14496
    buffer_load_dwordx4 a[48:51], v0, s[12:15], s25 offen offset:1536 sc1
    v_mfma_f32_16x16x32_bf16 v[76:79], a[72:75], a[12:15], v[76:79]
    ds_read_b64_tr_b16 a[142:143], v9 offset:16288
    v_mfma_f32_16x16x32_bf16 v[80:83], a[76:79], a[0:3], v[80:83]
    ds_read_b64_tr_b16 a[144:145], v8 offset:14528
    v_mfma_f32_16x16x32_bf16 v[84:87], a[76:79], a[4:7], v[84:87]
    ds_read_b64_tr_b16 a[146:147], v8 offset:16320
    v_mfma_f32_16x16x32_bf16 v[88:91], a[76:79], a[8:11], v[88:91]
    ds_read_b64_tr_b16 a[148:149], v9 offset:14560
    buffer_load_dwordx4 a[52:55], v0, s[12:15], s26 offen offset:1536 sc1
    v_mfma_f32_16x16x32_bf16 v[92:95], a[76:79], a[12:15], v[92:95]
    ds_read_b64_tr_b16 a[150:151], v9 offset:16352
    v_mfma_f32_16x16x32_bf16 v[96:99], a[80:83], a[0:3], v[96:99]
    ds_read_b64_tr_b16 a[152:153], v8 offset:14592
    v_mfma_f32_16x16x32_bf16 v[100:103], a[80:83], a[4:7], v[100:103]
    ds_read_b64_tr_b16 a[154:155], v8 offset:16384
    v_mfma_f32_16x16x32_bf16 v[104:107], a[80:83], a[8:11], v[104:107]
    ds_read_b64_tr_b16 a[156:157], v9 offset:14624
    buffer_load_dwordx4 a[56:59], v0, s[12:15], s27 offen offset:1536 sc1
    v_mfma_f32_16x16x32_bf16 v[108:111], a[80:83], a[12:15], v[108:111]
    ds_read_b64_tr_b16 a[158:159], v9 offset:16416
    v_mfma_f32_16x16x32_bf16 v[112:115], a[84:87], a[0:3], v[112:115]
    ds_read_b64_tr_b16 a[160:161], v8 offset:14656
    v_mfma_f32_16x16x32_bf16 v[116:119], a[84:87], a[4:7], v[116:119]
    ds_read_b64_tr_b16 a[162:163], v8 offset:16448
    v_mfma_f32_16x16x32_bf16 v[120:123], a[84:87], a[8:11], v[120:123]
    ds_read_b64_tr_b16 a[164:165], v9 offset:14688
    buffer_load_dwordx4 a[60:63], v0, s[12:15], s28 offen offset:1536 sc1
    v_mfma_f32_16x16x32_bf16 v[124:127], a[84:87], a[12:15], v[124:127]
    ds_read_b64_tr_b16 a[166:167], v9 offset:16480
    v_mfma_f32_16x16x32_bf16 v[128:131], a[88:91], a[0:3], v[128:131]
    v_mfma_f32_16x16x32_bf16 v[132:135], a[88:91], a[4:7], v[132:135]
    v_mfma_f32_16x16x32_bf16 v[136:139], a[88:91], a[8:11], v[136:139]
    s_add_u32 s34, s38, 4096
    s_mov_b32 m0, s34
    s_nop 0
    buffer_load_dwordx4 v5, s[8:11], s24 offen offset:0 lds
    v_mfma_f32_16x16x32_bf16 v[140:143], a[88:91], a[12:15], v[140:143]
    v_mfma_f32_16x16x32_bf16 v[144:147], a[92:95], a[0:3], v[144:147]
    v_mfma_f32_16x16x32_bf16 v[148:151], a[92:95], a[4:7], v[148:151]
    v_mfma_f32_16x16x32_bf16 v[152:155], a[92:95], a[8:11], v[152:155]
    buffer_load_dwordx4 v6, s[8:11], s24 offen offset:1024 lds
    v_mfma_f32_16x16x32_bf16 v[156:159], a[92:95], a[12:15], v[156:159]
    v_mfma_f32_16x16x32_bf16 v[160:163], a[0:3], a[96:99], v[160:163]
    v_mfma_f32_16x16x32_bf16 v[164:167], a[4:7], a[96:99], v[164:167]
    v_mfma_f32_16x16x32_bf16 v[168:171], a[8:11], a[96:99], v[168:171]
    buffer_load_dwordx4 v7, s[8:11], s24 offen offset:2048 lds
    v_mfma_f32_16x16x32_bf16 v[172:175], a[12:15], a[96:99], v[172:175]
    v_mfma_f32_16x16x32_bf16 v[176:179], a[0:3], a[100:103], v[176:179]
    v_mfma_f32_16x16x32_bf16 v[180:183], a[4:7], a[100:103], v[180:183]
    v_mfma_f32_16x16x32_bf16 v[184:187], a[8:11], a[100:103], v[184:187]
    v_mfma_f32_16x16x32_bf16 v[188:191], a[12:15], a[100:103], v[188:191]
    v_mfma_f32_16x16x32_bf16 v[192:195], a[0:3], a[104:107], v[192:195]
    v_mfma_f32_16x16x32_bf16 v[196:199], a[4:7], a[104:107], v[196:199]
    v_mfma_f32_16x16x32_bf16 v[200:203], a[8:11], a[104:107], v[200:203]
    v_mfma_f32_16x16x32_bf16 v[204:207], a[12:15], a[104:107], v[204:207]
    v_mfma_f32_16x16x32_bf16 v[208:211], a[0:3], a[108:111], v[208:211]
    v_mfma_f32_16x16x32_bf16 v[212:215], a[4:7], a[108:111], v[212:215]
    v_mfma_f32_16x16x32_bf16 v[216:219], a[8:11], a[108:111], v[216:219]
    v_mfma_f32_16x16x32_bf16 v[220:223], a[12:15], a[108:111], v[220:223]
    s_waitcnt vmcnt(15) lgkmcnt(0)
    s_barrier
    v_mfma_f32_16x16x32_bf16 v[32:35], a[120:123], a[16:19], v[32:35]
    ds_read_b64_tr_b16 a[64:65], v8 offset:32768
    v_mfma_f32_16x16x32_bf16 v[36:39], a[120:123], a[20:23], v[36:39]
    ds_read_b64_tr_b16 a[66:67], v8 offset:34560
    v_mfma_f32_16x16x32_bf16 v[40:43], a[120:123], a[24:27], v[40:43]
    ds_read_b64_tr_b16 a[68:69], v9 offset:32800
    s_add_u32 s25, s25, 2048
    v_mfma_f32_16x16x32_bf16 v[44:47], a[120:123], a[28:31], v[44:47]
    ds_read_b64_tr_b16 a[70:71], v9 offset:34592
    s_add_u32 s26, s26, 2048
    v_mfma_f32_16x16x32_bf16 v[48:51], a[124:127], a[16:19], v[48:51]
    ds_read_b64_tr_b16 a[72:73], v8 offset:32832
    s_add_u32 s27, s27, 2048
    v_mfma_f32_16x16x32_bf16 v[52:55], a[124:127], a[20:23], v[52:55]
    ds_read_b64_tr_b16 a[74:75], v8 offset:34624
    s_add_u32 s28, s28, 2048
    v_mfma_f32_16x16x32_bf16 v[56:59], a[124:127], a[24:27], v[56:59]
    ds_read_b64_tr_b16 a[76:77], v9 offset:32864
    s_cmp_eq_u32 s29, 1
    v_mfma_f32_16x16x32_bf16 v[60:63], a[124:127], a[28:31], v[60:63]
    ds_read_b64_tr_b16 a[78:79], v9 offset:34656
    s_cselect_b32 s14, 0, s14
    v_mfma_f32_16x16x32_bf16 v[64:67], a[128:131], a[16:19], v[64:67]
    ds_read_b64_tr_b16 a[80:81], v8 offset:32896
    v_mfma_f32_16x16x32_bf16 v[68:71], a[128:131], a[20:23], v[68:71]
    ds_read_b64_tr_b16 a[82:83], v8 offset:34688
    v_mfma_f32_16x16x32_bf16 v[72:75], a[128:131], a[24:27], v[72:75]
    ds_read_b64_tr_b16 a[84:85], v9 offset:32928
    buffer_load_dwordx4 a[0:3], v0, s[12:15], s25 offen offset:0 sc1
    v_mfma_f32_16x16x32_bf16 v[76:79], a[128:131], a[28:31], v[76:79]
    ds_read_b64_tr_b16 a[86:87], v9 offset:34720
    v_mfma_f32_16x16x32_bf16 v[80:83], a[132:135], a[16:19], v[80:83]
    ds_read_b64_tr_b16 a[88:89], v8 offset:32960
    v_mfma_f32_16x16x32_bf16 v[84:87], a[132:135], a[20:23], v[84:87]
    ds_read_b64_tr_b16 a[90:91], v8 offset:34752
    v_mfma_f32_16x16x32_bf16 v[88:91], a[132:135], a[24:27], v[88:91]
    ds_read_b64_tr_b16 a[92:93], v9 offset:32992
    buffer_load_dwordx4 a[4:7], v0, s[12:15], s26 offen offset:0 sc1
    v_mfma_f32_16x16x32_bf16 v[92:95], a[132:135], a[28:31], v[92:95]
    ds_read_b64_tr_b16 a[94:95], v9 offset:34784
    v_mfma_f32_16x16x32_bf16 v[96:99], a[136:139], a[16:19], v[96:99]
    ds_read_b64_tr_b16 a[96:97], v8 offset:33024
    v_mfma_f32_16x16x32_bf16 v[100:103], a[136:139], a[20:23], v[100:103]
    ds_read_b64_tr_b16 a[98:99], v8 offset:34816
    v_mfma_f32_16x16x32_bf16 v[104:107], a[136:139], a[24:27], v[104:107]
    ds_read_b64_tr_b16 a[100:101], v9 offset:33056
    buffer_load_dwordx4 a[8:11], v0, s[12:15], s27 offen offset:0 sc1
    v_mfma_f32_16x16x32_bf16 v[108:111], a[136:139], a[28:31], v[108:111]
    ds_read_b64_tr_b16 a[102:103], v9 offset:34848
    v_mfma_f32_16x16x32_bf16 v[112:115], a[140:143], a[16:19], v[112:115]
    ds_read_b64_tr_b16 a[104:105], v8 offset:33088
    v_mfma_f32_16x16x32_bf16 v[116:119], a[140:143], a[20:23], v[116:119]
    ds_read_b64_tr_b16 a[106:107], v8 offset:34880
    v_mfma_f32_16x16x32_bf16 v[120:123], a[140:143], a[24:27], v[120:123]
    ds_read_b64_tr_b16 a[108:109], v9 offset:33120
    buffer_load_dwordx4 a[12:15], v0, s[12:15], s28 offen offset:0 sc1
    v_mfma_f32_16x16x32_bf16 v[124:127], a[140:143], a[28:31], v[124:127]
    ds_read_b64_tr_b16 a[110:111], v9 offset:34912
    v_mfma_f32_16x16x32_bf16 v[128:131], a[144:147], a[16:19], v[128:131]
    v_mfma_f32_16x16x32_bf16 v[132:135], a[144:147], a[20:23], v[132:135]
    v_mfma_f32_16x16x32_bf16 v[136:139], a[144:147], a[24:27], v[136:139]
    s_add_u32 s24, s24, s43
    s_add_u32 s38, s38, 32768
    s_and_b32 s38, s38, 131071
    s_mov_b32 m0, s38
    s_nop 0
    buffer_load_dwordx4 v1, s[8:11], s24 offen offset:0 lds
    v_mfma_f32_16x16x32_bf16 v[140:143], a[144:147], a[28:31], v[140:143]
    v_mfma_f32_16x16x32_bf16 v[144:147], a[148:151], a[16:19], v[144:147]
    v_mfma_f32_16x16x32_bf16 v[148:151], a[148:151], a[20:23], v[148:151]
    v_mfma_f32_16x16x32_bf16 v[152:155], a[148:151], a[24:27], v[152:155]
    buffer_load_dwordx4 v2, s[8:11], s24 offen offset:1024 lds
    v_mfma_f32_16x16x32_bf16 v[156:159], a[148:151], a[28:31], v[156:159]
    v_mfma_f32_16x16x32_bf16 v[160:163], a[16:19], a[152:155], v[160:163]
    v_mfma_f32_16x16x32_bf16 v[164:167], a[20:23], a[152:155], v[164:167]
    v_mfma_f32_16x16x32_bf16 v[168:171], a[24:27], a[152:155], v[168:171]
    buffer_load_dwordx4 v3, s[8:11], s24 offen offset:2048 lds
    v_mfma_f32_16x16x32_bf16 v[172:175], a[28:31], a[152:155], v[172:175]
    v_mfma_f32_16x16x32_bf16 v[176:179], a[16:19], a[156:159], v[176:179]
    v_mfma_f32_16x16x32_bf16 v[180:183], a[20:23], a[156:159], v[180:183]
    v_mfma_f32_16x16x32_bf16 v[184:187], a[24:27], a[156:159], v[184:187]
    buffer_load_dwordx4 v4, s[8:11], s24 offen offset:3072 lds
    v_mfma_f32_16x16x32_bf16 v[188:191], a[28:31], a[156:159], v[188:191]
    v_mfma_f32_16x16x32_bf16 v[192:195], a[16:19], a[160:163], v[192:195]
    v_mfma_f32_16x16x32_bf16 v[196:199], a[20:23], a[160:163], v[196:199]
    v_mfma_f32_16x16x32_bf16 v[200:203], a[24:27], a[160:163], v[200:203]
    v_mfma_f32_16x16x32_bf16 v[204:207], a[28:31], a[160:163], v[204:207]
    v_mfma_f32_16x16x32_bf16 v[208:211], a[16:19], a[164:167], v[208:211]
    v_mfma_f32_16x16x32_bf16 v[212:215], a[20:23], a[164:167], v[212:215]
    v_mfma_f32_16x16x32_bf16 v[216:219], a[24:27], a[164:167], v[216:219]
    v_mfma_f32_16x16x32_bf16 v[220:223], a[28:31], a[164:167], v[220:223]
    s_waitcnt vmcnt(19) lgkmcnt(0)
    v_mfma_f32_16x16x32_bf16 v[32:35], a[64:67], a[32:35], v[32:35]
    ds_read_b64_tr_b16 a[120:121], v8 offset:47104
    v_mfma_f32_16x16x32_bf16 v[36:39], a[64:67], a[36:39], v[36:39]
    ds_read_b64_tr_b16 a[122:123], v8 offset:48896
    v_mfma_f32_16x16x32_bf16 v[40:43], a[64:67], a[40:43], v[40:43]
    ds_read_b64_tr_b16 a[124:125], v9 offset:47136
    v_mfma_f32_16x16x32_bf16 v[44:47], a[64:67], a[44:47], v[44:47]
    ds_read_b64_tr_b16 a[126:127], v9 offset:48928
    v_mfma_f32_16x16x32_bf16 v[48:51], a[68:71], a[32:35], v[48:51]
    ds_read_b64_tr_b16 a[128:129], v8 offset:47168
    v_mfma_f32_16x16x32_bf16 v[52:55], a[68:71], a[36:39], v[52:55]
    ds_read_b64_tr_b16 a[130:131], v8 offset:48960
    v_mfma_f32_16x16x32_bf16 v[56:59], a[68:71], a[40:43], v[56:59]
    ds_read_b64_tr_b16 a[132:133], v9 offset:47200
    v_mfma_f32_16x16x32_bf16 v[60:63], a[68:71], a[44:47], v[60:63]
    ds_read_b64_tr_b16 a[134:135], v9 offset:48992
    v_mfma_f32_16x16x32_bf16 v[64:67], a[72:75], a[32:35], v[64:67]
    ds_read_b64_tr_b16 a[136:137], v8 offset:47232
    v_mfma_f32_16x16x32_bf16 v[68:71], a[72:75], a[36:39], v[68:71]
    ds_read_b64_tr_b16 a[138:139], v8 offset:49024
    v_mfma_f32_16x16x32_bf16 v[72:75], a[72:75], a[40:43], v[72:75]
    ds_read_b64_tr_b16 a[140:141], v9 offset:47264
    buffer_load_dwordx4 a[16:19], v0, s[12:15], s25 offen offset:512 sc1
    v_mfma_f32_16x16x32_bf16 v[76:79], a[72:75], a[44:47], v[76:79]
    ds_read_b64_tr_b16 a[142:143], v9 offset:49056
    v_mfma_f32_16x16x32_bf16 v[80:83], a[76:79], a[32:35], v[80:83]
    ds_read_b64_tr_b16 a[144:145], v8 offset:47296
    v_mfma_f32_16x16x32_bf16 v[84:87], a[76:79], a[36:39], v[84:87]
    ds_read_b64_tr_b16 a[146:147], v8 offset:49088
    v_mfma_f32_16x16x32_bf16 v[88:91], a[76:79], a[40:43], v[88:91]
    ds_read_b64_tr_b16 a[148:149], v9 offset:47328
    buffer_load_dwordx4 a[20:23], v0, s[12:15], s26 offen offset:512 sc1
    v_mfma_f32_16x16x32_bf16 v[92:95], a[76:79], a[44:47], v[92:95]
    ds_read_b64_tr_b16 a[150:151], v9 offset:49120
    v_mfma_f32_16x16x32_bf16 v[96:99], a[80:83], a[32:35], v[96:99]
    ds_read_b64_tr_b16 a[152:153], v8 offset:47360
    v_mfma_f32_16x16x32_bf16 v[100:103], a[80:83], a[36:39], v[100:103]
    ds_read_b64_tr_b16 a[154:155], v8 offset:49152
    v_mfma_f32_16x16x32_bf16 v[104:107], a[80:83], a[40:43], v[104:107]
    ds_read_b64_tr_b16 a[156:157], v9 offset:47392
    buffer_load_dwordx4 a[24:27], v0, s[12:15], s27 offen offset:512 sc1
    v_mfma_f32_16x16x32_bf16 v[108:111], a[80:83], a[44:47], v[108:111]
    ds_read_b64_tr_b16 a[158:159], v9 offset:49184
    v_mfma_f32_16x16x32_bf16 v[112:115], a[84:87], a[32:35], v[112:115]
    ds_read_b64_tr_b16 a[160:161], v8 offset:47424
    v_mfma_f32_16x16x32_bf16 v[116:119], a[84:87], a[36:39], v[116:119]
    ds_read_b64_tr_b16 a[162:163], v8 offset:49216
    v_mfma_f32_16x16x32_bf16 v[120:123], a[84:87], a[40:43], v[120:123]
    ds_read_b64_tr_b16 a[164:165], v9 offset:47456
    buffer_load_dwordx4 a[28:31], v0, s[12:15], s28 offen offset:512 sc1
    v_mfma_f32_16x16x32_bf16 v[124:127], a[84:87], a[44:47], v[124:127]
    ds_read_b64_tr_b16 a[166:167], v9 offset:49248
    v_mfma_f32_16x16x32_bf16 v[128:131], a[88:91], a[32:35], v[128:131]
    v_mfma_f32_16x16x32_bf16 v[132:135], a[88:91], a[36:39], v[132:135]
    v_mfma_f32_16x16x32_bf16 v[136:139], a[88:91], a[40:43], v[136:139]
    s_add_u32 s34, s38, 4096
    s_mov_b32 m0, s34
    s_nop 0
    buffer_load_dwordx4 v5, s[8:11], s24 offen offset:0 lds
    v_mfma_f32_16x16x32_bf16 v[140:143], a[88:91], a[44:47], v[140:143]
    v_mfma_f32_16x16x32_bf16 v[144:147], a[92:95], a[32:35], v[144:147]
    v_mfma_f32_16x16x32_bf16 v[148:151], a[92:95], a[36:39], v[148:151]
    v_mfma_f32_16x16x32_bf16 v[152:155], a[92:95], a[40:43], v[152:155]
    buffer_load_dwordx4 v6, s[8:11], s24 offen offset:1024 lds
    v_mfma_f32_16x16x32_bf16 v[156:159], a[92:95], a[44:47], v[156:159]
    v_mfma_f32_16x16x32_bf16 v[160:163], a[32:35], a[96:99], v[160:163]
    v_mfma_f32_16x16x32_bf16 v[164:167], a[36:39], a[96:99], v[164:167]
    v_mfma_f32_16x16x32_bf16 v[168:171], a[40:43], a[96:99], v[168:171]
    buffer_load_dwordx4 v7, s[8:11], s24 offen offset:2048 lds
    v_mfma_f32_16x16x32_bf16 v[172:175], a[44:47], a[96:99], v[172:175]
    v_mfma_f32_16x16x32_bf16 v[176:179], a[32:35], a[100:103], v[176:179]
    v_mfma_f32_16x16x32_bf16 v[180:183], a[36:39], a[100:103], v[180:183]
    v_mfma_f32_16x16x32_bf16 v[184:187], a[40:43], a[100:103], v[184:187]
    v_mfma_f32_16x16x32_bf16 v[188:191], a[44:47], a[100:103], v[188:191]
    v_mfma_f32_16x16x32_bf16 v[192:195], a[32:35], a[104:107], v[192:195]
    v_mfma_f32_16x16x32_bf16 v[196:199], a[36:39], a[104:107], v[196:199]
    v_mfma_f32_16x16x32_bf16 v[200:203], a[40:43], a[104:107], v[200:203]
    v_mfma_f32_16x16x32_bf16 v[204:207], a[44:47], a[104:107], v[204:207]
    v_mfma_f32_16x16x32_bf16 v[208:211], a[32:35], a[108:111], v[208:211]
    v_mfma_f32_16x16x32_bf16 v[212:215], a[36:39], a[108:111], v[212:215]
    v_mfma_f32_16x16x32_bf16 v[216:219], a[40:43], a[108:111], v[216:219]
    v_mfma_f32_16x16x32_bf16 v[220:223], a[44:47], a[108:111], v[220:223]
    s_waitcnt vmcnt(15) lgkmcnt(0)
    s_barrier
    v_mfma_f32_16x16x32_bf16 v[32:35], a[120:123], a[48:51], v[32:35]
    v_xor_b32 v8, 0x10000, v8
    v_mfma_f32_16x16x32_bf16 v[36:39], a[120:123], a[52:55], v[36:39]
    v_xor_b32 v9, 0x10000, v9
    v_mfma_f32_16x16x32_bf16 v[40:43], a[120:123], a[56:59], v[40:43]
    ds_read_b64_tr_b16 a[64:65], v8 offset:0
    v_mfma_f32_16x16x32_bf16 v[44:47], a[120:123], a[60:63], v[44:47]
    ds_read_b64_tr_b16 a[66:67], v8 offset:1792
    v_mfma_f32_16x16x32_bf16 v[48:51], a[124:127], a[48:51], v[48:51]
    ds_read_b64_tr_b16 a[68:69], v9 offset:32
    v_mfma_f32_16x16x32_bf16 v[52:55], a[124:127], a[52:55], v[52:55]
    ds_read_b64_tr_b16 a[70:71], v9 offset:1824
    v_mfma_f32_16x16x32_bf16 v[56:59], a[124:127], a[56:59], v[56:59]
    ds_read_b64_tr_b16 a[72:73], v8 offset:64
    v_mfma_f32_16x16x32_bf16 v[60:63], a[124:127], a[60:63], v[60:63]
    ds_read_b64_tr_b16 a[74:75], v8 offset:1856
    v_mfma_f32_16x16x32_bf16 v[64:67], a[128:131], a[48:51], v[64:67]
    ds_read_b64_tr_b16 a[76:77], v9 offset:96
    v_mfma_f32_16x16x32_bf16 v[68:71], a[128:131], a[52:55], v[68:71]
    ds_read_b64_tr_b16 a[78:79], v9 offset:1888
    v_mfma_f32_16x16x32_bf16 v[72:75], a[128:131], a[56:59], v[72:75]
    ds_read_b64_tr_b16 a[80:81], v8 offset:128
    buffer_load_dwordx4 a[32:35], v0, s[12:15], s25 offen offset:1024 sc1
    v_mfma_f32_16x16x32_bf16 v[76:79], a[128:131], a[60:63], v[76:79]
    ds_read_b64_tr_b16 a[82:83], v8 offset:1920
    v_mfma_f32_16x16x32_bf16 v[80:83], a[132:135], a[48:51], v[80:83]
    ds_read_b64_tr_b16 a[84:85], v9 offset:160
    v_mfma_f32_16x16x32_bf16 v[84:87], a[132:135], a[52:55], v[84:87]
    ds_read_b64_tr_b16 a[86:87], v9 offset:1952
    v_mfma_f32_16x16x32_bf16 v[88:91], a[132:135], a[56:59], v[88:91]
    ds_read_b64_tr_b16 a[88:89], v8 offset:192
    buffer_load_dwordx4 a[36:39], v0, s[12:15], s26 offen offset:1024 sc1
    v_mfma_f32_16x16x32_bf16 v[92:95], a[132:135], a[60:63], v[92:95]
    ds_read_b64_tr_b16 a[90:91], v8 offset:1984
    v_mfma_f32_16x16x32_bf16 v[96:99], a[136:139], a[48:51], v[96:99]
    ds_read_b64_tr_b16 a[92:93], v9 offset:224
    v_mfma_f32_16x16x32_bf16 v[100:103], a[136:139], a[52:55], v[100:103]
    ds_read_b64_tr_b16 a[94:95], v9 offset:2016
    v_mfma_f32_16x16x32_bf16 v[104:107], a[136:139], a[56:59], v[104:107]
    ds_read_b64_tr_b16 a[96:97], v8 offset:256
    buffer_load_dwordx4 a[40:43], v0, s[12:15], s27 offen offset:1024 sc1
    v_mfma_f32_16x16x32_bf16 v[108:111], a[136:139], a[60:63], v[108:111]
    ds_read_b64_tr_b16 a[98:99], v8 offset:2048
    v_mfma_f32_16x16x32_bf16 v[112:115], a[140:143], a[48:51], v[112:115]
    ds_read_b64_tr_b16 a[100:101], v9 offset:288
    v_mfma_f32_16x16x32_bf16 v[116:119], a[140:143], a[52:55], v[116:119]
    ds_read_b64_tr_b16 a[102:103], v9 offset:2080
    v_mfma_f32_16x16x32_bf16 v[120:123], a[140:143], a[56:59], v[120:123]
    ds_read_b64_tr_b16 a[104:105], v8 offset:320
    buffer_load_dwordx4 a[44:47], v0, s[12:15], s28 offen offset:1024 sc1
    v_mfma_f32_16x16x32_bf16 v[124:127], a[140:143], a[60:63], v[124:127]
    ds_read_b64_tr_b16 a[106:107], v8 offset:2112
    v_mfma_f32_16x16x32_bf16 v[128:131], a[144:147], a[48:51], v[128:131]
    ds_read_b64_tr_b16 a[108:109], v9 offset:352
    v_mfma_f32_16x16x32_bf16 v[132:135], a[144:147], a[52:55], v[132:135]
    ds_read_b64_tr_b16 a[110:111], v9 offset:2144
    v_mfma_f32_16x16x32_bf16 v[136:139], a[144:147], a[56:59], v[136:139]
    s_add_u32 s24, s24, s43
    s_add_u32 s38, s38, 32768
    s_and_b32 s38, s38, 131071
    s_mov_b32 m0, s38
    s_nop 0
    buffer_load_dwordx4 v1, s[8:11], s24 offen offset:0 lds
    v_mfma_f32_16x16x32_bf16 v[140:143], a[144:147], a[60:63], v[140:143]
    v_mfma_f32_16x16x32_bf16 v[144:147], a[148:151], a[48:51], v[144:147]
    v_mfma_f32_16x16x32_bf16 v[148:151], a[148:151], a[52:55], v[148:151]
    v_mfma_f32_16x16x32_bf16 v[152:155], a[148:151], a[56:59], v[152:155]
    buffer_load_dwordx4 v2, s[8:11], s24 offen offset:1024 lds
    v_mfma_f32_16x16x32_bf16 v[156:159], a[148:151], a[60:63], v[156:159]
    v_mfma_f32_16x16x32_bf16 v[160:163], a[48:51], a[152:155], v[160:163]
    v_mfma_f32_16x16x32_bf16 v[164:167], a[52:55], a[152:155], v[164:167]
    v_mfma_f32_16x16x32_bf16 v[168:171], a[56:59], a[152:155], v[168:171]
    buffer_load_dwordx4 v3, s[8:11], s24 offen offset:2048 lds
    v_mfma_f32_16x16x32_bf16 v[172:175], a[60:63], a[152:155], v[172:175]
    v_mfma_f32_16x16x32_bf16 v[176:179], a[48:51], a[156:159], v[176:179]
    v_mfma_f32_16x16x32_bf16 v[180:183], a[52:55], a[156:159], v[180:183]
    v_mfma_f32_16x16x32_bf16 v[184:187], a[56:59], a[156:159], v[184:187]
    buffer_load_dwordx4 v4, s[8:11], s24 offen offset:3072 lds
    v_mfma_f32_16x16x32_bf16 v[188:191], a[60:63], a[156:159], v[188:191]
    v_mfma_f32_16x16x32_bf16 v[192:195], a[48:51], a[160:163], v[192:195]
    v_mfma_f32_16x16x32_bf16 v[196:199], a[52:55], a[160:163], v[196:199]
    v_mfma_f32_16x16x32_bf16 v[200:203], a[56:59], a[160:163], v[200:203]
    v_mfma_f32_16x16x32_bf16 v[204:207], a[60:63], a[160:163], v[204:207]
    v_mfma_f32_16x16x32_bf16 v[208:211], a[48:51], a[164:167], v[208:211]
    v_mfma_f32_16x16x32_bf16 v[212:215], a[52:55], a[164:167], v[212:215]
    v_mfma_f32_16x16x32_bf16 v[216:219], a[56:59], a[164:167], v[216:219]
    v_mfma_f32_16x16x32_bf16 v[220:223], a[60:63], a[164:167], v[220:223]
    s_sub_u32 s29, s29, 1
    s_cmp_lg_u32 s29, 0
    s_cbranch_scc1 L_p1_m_loop
    s_waitcnt vmcnt(0)
    s_barrier
    v_and_b32 v3, 15, v17
    v_lshrrev_b32 v4, 4, v17
    v_lshrrev_b32 v7, 1, v4
    v_lshlrev_b32 v7, 10, v7
    v_and_b32 v8, 1, v4
    v_lshl_add_u32 v7, v8, 9, v7
    s_add_u32 s4, s40, 4194304
    s_addc_u32 s5, s41, 0
    s_mov_b32 s16, s4
    s_and_b32 s17, s5, 0xffff
    s_mov_b32 s18, 13000704
    s_mov_b32 s19, 0x00020000
    v_lshl_add_u32 v6, v3, 4, v7
    s_mul_i32 s37, s32, 135424
    s_lshl_b32 s47, s39, 6
    s_add_u32 s37, s37, s47
    v_cvt_pk_bf16_f32 v160, v160, v161
    v_cvt_pk_bf16_f32 v161, v162, v163
    v_cvt_pk_bf16_f32 v162, v164, v165
    v_cvt_pk_bf16_f32 v163, v166, v167
    s_add_u32 s47, s37, 541696
    buffer_store_dwordx4 v[160:163], v6, s[16:19], s47 offen offset:0 sc1
    v_cvt_pk_bf16_f32 v176, v176, v177
    v_cvt_pk_bf16_f32 v177, v178, v179
    v_cvt_pk_bf16_f32 v178, v180, v181
    v_cvt_pk_bf16_f32 v179, v182, v183
    s_add_u32 s47, s37, 541696
    buffer_store_dwordx4 v[176:179], v6, s[16:19], s47 offen offset:256 sc1
    v_cvt_pk_bf16_f32 v192, v192, v193
    v_cvt_pk_bf16_f32 v193, v194, v195
    v_cvt_pk_bf16_f32 v194, v196, v197
    v_cvt_pk_bf16_f32 v195, v198, v199
    s_add_u32 s47, s37, 677120
    buffer_store_dwordx4 v[192:195], v6, s[16:19], s47 offen offset:0 sc1
    v_cvt_pk_bf16_f32 v208, v208, v209
    v_cvt_pk_bf16_f32 v209, v210, v211
    v_cvt_pk_bf16_f32 v210, v212, v213
    v_cvt_pk_bf16_f32 v211, v214, v215
    s_add_u32 s47, s37, 677120
    buffer_store_dwordx4 v[208:211], v6, s[16:19], s47 offen offset:256 sc1
    v_cvt_pk_bf16_f32 v168, v168, v169
    v_cvt_pk_bf16_f32 v169, v170, v171
    v_cvt_pk_bf16_f32 v170, v172, v173
    v_cvt_pk_bf16_f32 v171, v174, v175
    s_add_u32 s47, s37, 543744
    buffer_store_dwordx4 v[168:171], v6, s[16:19], s47 offen offset:0 sc1
    v_cvt_pk_bf16_f32 v184, v184, v185
    v_cvt_pk_bf16_f32 v185, v186, v187
    v_cvt_pk_bf16_f32 v186, v188, v189
    v_cvt_pk_bf16_f32 v187, v190, v191
    s_add_u32 s47, s37, 543744
    buffer_store_dwordx4 v[184:187], v6, s[16:19], s47 offen offset:256 sc1
    v_cvt_pk_bf16_f32 v200, v200, v201
    v_cvt_pk_bf16_f32 v201, v202, v203
    v_cvt_pk_bf16_f32 v202, v204, v205
    v_cvt_pk_bf16_f32 v203, v206, v207
    s_add_u32 s47, s37, 679168
    buffer_store_dwordx4 v[200:203], v6, s[16:19], s47 offen offset:0 sc1
    v_cvt_pk_bf16_f32 v216, v216, v217
    v_cvt_pk_bf16_f32 v217, v218, v219
    v_cvt_pk_bf16_f32 v218, v220, v221
    v_cvt_pk_bf16_f32 v219, v222, v223
    s_add_u32 s47, s37, 679168
    buffer_store_dwordx4 v[216:219], v6, s[16:19], s47 offen offset:256 sc1
    s_add_u32 s4, s40, 17825792
    s_addc_u32 s5, s41, 0
    s_mov_b32 s20, s4
    s_and_b32 s21, s5, 0xffff
    s_mov_b32 s22, 524288
    s_mov_b32 s23, 0x00020000
    v_lshl_add_u32 v8, v3, 4, v7
    v_lshrrev_b32 v9, 3, v3
    v_lshlrev_b32 v9, 8, v9
    v_and_b32 v10, 7, v3
    v_lshl_add_u32 v9, v10, 4, v9
    v_add_u32 v9, v9, v7
    v_lshlrev_b32 v10, 2, v17
    v_and_b32 v11, 1, v4
    v_cmp_eq_u32 s[48:49], 1, v11
    v_cmp_le_u32 s[60:61], 2, v4
    s_add_u32 s34, s32, 0
    s_cmp_lt_u32 s34, 32
    s_cselect_b32 s44, 0x3e8293ee, 1.0
    s_cselect_b32 s46, 0, 1
    s_mov_b32 s45, s44
    s_mul_i32 s35, s34, 135424
    s_lshl_b32 s36, s39, 6
    s_add_u32 s35, s35, s36
    s_lshl_b32 s36, s34, 13
    s_lshl_b32 s37, s39, 2
    s_add_u32 s36, s36, s37
    s_cmp_eq_u32 s46, 1
    s_cselect_b64 vcc, -1, 0
    s_lshr_b32 s47, 256, s46
    s_add_u32 s47, s47, s35
    v_cndmask_b32 v11, v8, v9, vcc
    v_pk_mul_f32 v[32:33], v[32:33], s[44:45]
    v_pk_mul_f32 v[34:35], v[34:35], s[44:45]
    v_pk_mul_f32 v[48:49], v[48:49], s[44:45]
    v_pk_mul_f32 v[50:51], v[50:51], s[44:45]
    v_pk_mul_f32 v[36:37], v[36:37], s[44:45]
    v_pk_mul_f32 v[38:39], v[38:39], s[44:45]
    v_pk_mul_f32 v[52:53], v[52:53], s[44:45]
    v_pk_mul_f32 v[54:55], v[54:55], s[44:45]
    v_pk_mul_f32 v[40:41], v[40:41], s[44:45]
    v_pk_mul_f32 v[42:43], v[42:43], s[44:45]
    v_pk_mul_f32 v[56:57], v[56:57], s[44:45]
    v_pk_mul_f32 v[58:59], v[58:59], s[44:45]
    v_pk_mul_f32 v[44:45], v[44:45], s[44:45]
    v_pk_mul_f32 v[46:47], v[46:47], s[44:45]
    v_pk_mul_f32 v[60:61], v[60:61], s[44:45]
    v_pk_mul_f32 v[62:63], v[62:63], s[44:45]
    v_pk_mul_f32 v[24:25], v[32:33], v[32:33]
    v_pk_mul_f32 v[26:27], v[36:37], v[36:37]
    v_pk_mul_f32 v[28:29], v[40:41], v[40:41]
    v_pk_mul_f32 v[30:31], v[44:45], v[44:45]
    v_pk_fma_f32 v[24:25], v[34:35], v[34:35], v[24:25]
    v_pk_fma_f32 v[26:27], v[38:39], v[38:39], v[26:27]
    v_pk_fma_f32 v[28:29], v[42:43], v[42:43], v[28:29]
    v_pk_fma_f32 v[30:31], v[46:47], v[46:47], v[30:31]
    v_pk_fma_f32 v[24:25], v[48:49], v[48:49], v[24:25]
    v_pk_fma_f32 v[26:27], v[52:53], v[52:53], v[26:27]
    v_pk_fma_f32 v[28:29], v[56:57], v[56:57], v[28:29]
    v_pk_fma_f32 v[30:31], v[60:61], v[60:61], v[30:31]
    v_pk_fma_f32 v[24:25], v[50:51], v[50:51], v[24:25]
    v_pk_fma_f32 v[26:27], v[54:55], v[54:55], v[26:27]
    v_pk_fma_f32 v[28:29], v[58:59], v[58:59], v[28:29]
    v_pk_fma_f32 v[30:31], v[62:63], v[62:63], v[30:31]
    v_cvt_pk_bf16_f32 v32, v32, v33
    v_cvt_pk_bf16_f32 v33, v34, v35
    v_cvt_pk_bf16_f32 v34, v48, v49
    v_cvt_pk_bf16_f32 v35, v50, v51
    buffer_store_dwordx4 v[32:35], v11, s[16:19], s35 offen offset:0 sc1
    v_cvt_pk_bf16_f32 v36, v36, v37
    v_cvt_pk_bf16_f32 v37, v38, v39
    v_cvt_pk_bf16_f32 v38, v52, v53
    v_cvt_pk_bf16_f32 v39, v54, v55
    buffer_store_dwordx4 v[36:39], v11, s[16:19], s47 offen offset:0 sc1
    v_cvt_pk_bf16_f32 v40, v40, v41
    v_cvt_pk_bf16_f32 v41, v42, v43
    v_cvt_pk_bf16_f32 v42, v56, v57
    v_cvt_pk_bf16_f32 v43, v58, v59
    buffer_store_dwordx4 v[40:43], v11, s[16:19], s35 offen offset:2048 sc1
    v_cvt_pk_bf16_f32 v44, v44, v45
    v_cvt_pk_bf16_f32 v45, v46, v47
    v_cvt_pk_bf16_f32 v46, v60, v61
    v_cvt_pk_bf16_f32 v47, v62, v63
    buffer_store_dwordx4 v[44:47], v11, s[16:19], s47 offen offset:2048 sc1
    v_add_f32 v24, v24, v25
    v_add_f32 v26, v26, v27
    v_add_f32 v28, v28, v29
    v_add_f32 v30, v30, v31
    v_mov_b32 v20, v24
    v_mov_b32 v21, v26
    v_mov_b32 v22, v28
    v_mov_b32 v23, v30
    v_permlane32_swap_b32 v24, v20
    v_permlane32_swap_b32 v26, v21
    v_permlane32_swap_b32 v28, v22
    v_permlane32_swap_b32 v30, v23
    v_add_f32 v24, v24, v20
    v_add_f32 v26, v26, v21
    v_add_f32 v28, v28, v22
    v_add_f32 v30, v30, v23
    v_mov_b32 v20, v24
    v_mov_b32 v21, v26
    v_mov_b32 v22, v28
    v_mov_b32 v23, v30
    v_permlane16_swap_b32 v24, v20
    v_permlane16_swap_b32 v26, v21
    v_permlane16_swap_b32 v28, v22
    v_permlane16_swap_b32 v30, v23
    v_add_f32 v24, v24, v20
    v_add_f32 v26, v26, v21
    v_add_f32 v28, v28, v22
    v_add_f32 v30, v30, v23
    v_cndmask_b32 v24, v24, v26, s[48:49]
    v_cndmask_b32 v28, v28, v30, s[48:49]
    v_cndmask_b32 v24, v24, v28, s[60:61]
    buffer_store_dword v24, v10, s[20:23], s36 offen sc1
    s_add_u32 s34, s32, 1
    s_cmp_lt_u32 s34, 32
    s_cselect_b32 s44, 0x3e8293ee, 1.0
    s_cselect_b32 s46, 0, 1
    s_mov_b32 s45, s44
    s_mul_i32 s35, s34, 135424
    s_lshl_b32 s36, s39, 6
    s_add_u32 s35, s35, s36
    s_lshl_b32 s36, s34, 13
    s_lshl_b32 s37, s39, 2
    s_add_u32 s36, s36, s37
    s_cmp_eq_u32 s46, 1
    s_cselect_b64 vcc, -1, 0
    s_lshr_b32 s47, 256, s46
    s_add_u32 s47, s47, s35
    v_cndmask_b32 v11, v8, v9, vcc
    v_pk_mul_f32 v[64:65], v[64:65], s[44:45]
    v_pk_mul_f32 v[66:67], v[66:67], s[44:45]
    v_pk_mul_f32 v[80:81], v[80:81], s[44:45]
    v_pk_mul_f32 v[82:83], v[82:83], s[44:45]
    v_pk_mul_f32 v[68:69], v[68:69], s[44:45]
    v_pk_mul_f32 v[70:71], v[70:71], s[44:45]
    v_pk_mul_f32 v[84:85], v[84:85], s[44:45]
    v_pk_mul_f32 v[86:87], v[86:87], s[44:45]
    v_pk_mul_f32 v[72:73], v[72:73], s[44:45]
    v_pk_mul_f32 v[74:75], v[74:75], s[44:45]
    v_pk_mul_f32 v[88:89], v[88:89], s[44:45]
    v_pk_mul_f32 v[90:91], v[90:91], s[44:45]
    v_pk_mul_f32 v[76:77], v[76:77], s[44:45]
    v_pk_mul_f32 v[78:79], v[78:79], s[44:45]
    v_pk_mul_f32 v[92:93], v[92:93], s[44:45]
    v_pk_mul_f32 v[94:95], v[94:95], s[44:45]
    v_pk_mul_f32 v[24:25], v[64:65], v[64:65]
    v_pk_mul_f32 v[26:27], v[68:69], v[68:69]
    v_pk_mul_f32 v[28:29], v[72:73], v[72:73]
    v_pk_mul_f32 v[30:31], v[76:77], v[76:77]
    v_pk_fma_f32 v[24:25], v[66:67], v[66:67], v[24:25]
    v_pk_fma_f32 v[26:27], v[70:71], v[70:71], v[26:27]
    v_pk_fma_f32 v[28:29], v[74:75], v[74:75], v[28:29]
    v_pk_fma_f32 v[30:31], v[78:79], v[78:79], v[30:31]
    v_pk_fma_f32 v[24:25], v[80:81], v[80:81], v[24:25]
    v_pk_fma_f32 v[26:27], v[84:85], v[84:85], v[26:27]
    v_pk_fma_f32 v[28:29], v[88:89], v[88:89], v[28:29]
    v_pk_fma_f32 v[30:31], v[92:93], v[92:93], v[30:31]
    v_pk_fma_f32 v[24:25], v[82:83], v[82:83], v[24:25]
    v_pk_fma_f32 v[26:27], v[86:87], v[86:87], v[26:27]
    v_pk_fma_f32 v[28:29], v[90:91], v[90:91], v[28:29]
    v_pk_fma_f32 v[30:31], v[94:95], v[94:95], v[30:31]
    v_cvt_pk_bf16_f32 v64, v64, v65
    v_cvt_pk_bf16_f32 v65, v66, v67
    v_cvt_pk_bf16_f32 v66, v80, v81
    v_cvt_pk_bf16_f32 v67, v82, v83
    buffer_store_dwordx4 v[64:67], v11, s[16:19], s35 offen offset:0 sc1
    v_cvt_pk_bf16_f32 v68, v68, v69
    v_cvt_pk_bf16_f32 v69, v70, v71
    v_cvt_pk_bf16_f32 v70, v84, v85
    v_cvt_pk_bf16_f32 v71, v86, v87
    buffer_store_dwordx4 v[68:71], v11, s[16:19], s47 offen offset:0 sc1
    v_cvt_pk_bf16_f32 v72, v72, v73
    v_cvt_pk_bf16_f32 v73, v74, v75
    v_cvt_pk_bf16_f32 v74, v88, v89
    v_cvt_pk_bf16_f32 v75, v90, v91
    buffer_store_dwordx4 v[72:75], v11, s[16:19], s35 offen offset:2048 sc1
    v_cvt_pk_bf16_f32 v76, v76, v77
    v_cvt_pk_bf16_f32 v77, v78, v79
    v_cvt_pk_bf16_f32 v78, v92, v93
    v_cvt_pk_bf16_f32 v79, v94, v95
    buffer_store_dwordx4 v[76:79], v11, s[16:19], s47 offen offset:2048 sc1
    v_add_f32 v24, v24, v25
    v_add_f32 v26, v26, v27
    v_add_f32 v28, v28, v29
    v_add_f32 v30, v30, v31
    v_mov_b32 v20, v24
    v_mov_b32 v21, v26
    v_mov_b32 v22, v28
    v_mov_b32 v23, v30
    v_permlane32_swap_b32 v24, v20
    v_permlane32_swap_b32 v26, v21
    v_permlane32_swap_b32 v28, v22
    v_permlane32_swap_b32 v30, v23
    v_add_f32 v24, v24, v20
    v_add_f32 v26, v26, v21
    v_add_f32 v28, v28, v22
    v_add_f32 v30, v30, v23
    v_mov_b32 v20, v24
    v_mov_b32 v21, v26
    v_mov_b32 v22, v28
    v_mov_b32 v23, v30
    v_permlane16_swap_b32 v24, v20
    v_permlane16_swap_b32 v26, v21
    v_permlane16_swap_b32 v28, v22
    v_permlane16_swap_b32 v30, v23
    v_add_f32 v24, v24, v20
    v_add_f32 v26, v26, v21
    v_add_f32 v28, v28, v22
    v_add_f32 v30, v30, v23
    v_cndmask_b32 v24, v24, v26, s[48:49]
    v_cndmask_b32 v28, v28, v30, s[48:49]
    v_cndmask_b32 v24, v24, v28, s[60:61]
    buffer_store_dword v24, v10, s[20:23], s36 offen sc1
    s_add_u32 s34, s32, 2
    s_cmp_lt_u32 s34, 32
    s_cselect_b32 s44, 0x3e8293ee, 1.0
    s_cselect_b32 s46, 0, 1
    s_mov_b32 s45, s44
    s_mul_i32 s35, s34, 135424
    s_lshl_b32 s36, s39, 6
    s_add_u32 s35, s35, s36
    s_lshl_b32 s36, s34, 13
    s_lshl_b32 s37, s39, 2
    s_add_u32 s36, s36, s37
    s_cmp_eq_u32 s46, 1
    s_cselect_b64 vcc, -1, 0
    s_lshr_b32 s47, 256, s46
    s_add_u32 s47, s47, s35
    v_cndmask_b32 v11, v8, v9, vcc
    v_pk_mul_f32 v[96:97], v[96:97], s[44:45]
    v_pk_mul_f32 v[98:99], v[98:99], s[44:45]
    v_pk_mul_f32 v[112:113], v[112:113], s[44:45]
    v_pk_mul_f32 v[114:115], v[114:115], s[44:45]
    v_pk_mul_f32 v[100:101], v[100:101], s[44:45]
    v_pk_mul_f32 v[102:103], v[102:103], s[44:45]
    v_pk_mul_f32 v[116:117], v[116:117], s[44:45]
    v_pk_mul_f32 v[118:119], v[118:119], s[44:45]
    v_pk_mul_f32 v[104:105], v[104:105], s[44:45]
    v_pk_mul_f32 v[106:107], v[106:107], s[44:45]
    v_pk_mul_f32 v[120:121], v[120:121], s[44:45]
    v_pk_mul_f32 v[122:123], v[122:123], s[44:45]
    v_pk_mul_f32 v[108:109], v[108:109], s[44:45]
    v_pk_mul_f32 v[110:111], v[110:111], s[44:45]
    v_pk_mul_f32 v[124:125], v[124:125], s[44:45]
    v_pk_mul_f32 v[126:127], v[126:127], s[44:45]
    v_pk_mul_f32 v[24:25], v[96:97], v[96:97]
    v_pk_mul_f32 v[26:27], v[100:101], v[100:101]
    v_pk_mul_f32 v[28:29], v[104:105], v[104:105]
    v_pk_mul_f32 v[30:31], v[108:109], v[108:109]
    v_pk_fma_f32 v[24:25], v[98:99], v[98:99], v[24:25]
    v_pk_fma_f32 v[26:27], v[102:103], v[102:103], v[26:27]
    v_pk_fma_f32 v[28:29], v[106:107], v[106:107], v[28:29]
    v_pk_fma_f32 v[30:31], v[110:111], v[110:111], v[30:31]
    v_pk_fma_f32 v[24:25], v[112:113], v[112:113], v[24:25]
    v_pk_fma_f32 v[26:27], v[116:117], v[116:117], v[26:27]
    v_pk_fma_f32 v[28:29], v[120:121], v[120:121], v[28:29]
    v_pk_fma_f32 v[30:31], v[124:125], v[124:125], v[30:31]
    v_pk_fma_f32 v[24:25], v[114:115], v[114:115], v[24:25]
    v_pk_fma_f32 v[26:27], v[118:119], v[118:119], v[26:27]
    v_pk_fma_f32 v[28:29], v[122:123], v[122:123], v[28:29]
    v_pk_fma_f32 v[30:31], v[126:127], v[126:127], v[30:31]
    v_cvt_pk_bf16_f32 v96, v96, v97
    v_cvt_pk_bf16_f32 v97, v98, v99
    v_cvt_pk_bf16_f32 v98, v112, v113
    v_cvt_pk_bf16_f32 v99, v114, v115
    buffer_store_dwordx4 v[96:99], v11, s[16:19], s35 offen offset:0 sc1
    v_cvt_pk_bf16_f32 v100, v100, v101
    v_cvt_pk_bf16_f32 v101, v102, v103
    v_cvt_pk_bf16_f32 v102, v116, v117
    v_cvt_pk_bf16_f32 v103, v118, v119
    buffer_store_dwordx4 v[100:103], v11, s[16:19], s47 offen offset:0 sc1
    v_cvt_pk_bf16_f32 v104, v104, v105
    v_cvt_pk_bf16_f32 v105, v106, v107
    v_cvt_pk_bf16_f32 v106, v120, v121
    v_cvt_pk_bf16_f32 v107, v122, v123
    buffer_store_dwordx4 v[104:107], v11, s[16:19], s35 offen offset:2048 sc1
    v_cvt_pk_bf16_f32 v108, v108, v109
    v_cvt_pk_bf16_f32 v109, v110, v111
    v_cvt_pk_bf16_f32 v110, v124, v125
    v_cvt_pk_bf16_f32 v111, v126, v127
    buffer_store_dwordx4 v[108:111], v11, s[16:19], s47 offen offset:2048 sc1
    v_add_f32 v24, v24, v25
    v_add_f32 v26, v26, v27
    v_add_f32 v28, v28, v29
    v_add_f32 v30, v30, v31
    v_mov_b32 v20, v24
    v_mov_b32 v21, v26
    v_mov_b32 v22, v28
    v_mov_b32 v23, v30
    v_permlane32_swap_b32 v24, v20
    v_permlane32_swap_b32 v26, v21
    v_permlane32_swap_b32 v28, v22
    v_permlane32_swap_b32 v30, v23
    v_add_f32 v24, v24, v20
    v_add_f32 v26, v26, v21
    v_add_f32 v28, v28, v22
    v_add_f32 v30, v30, v23
    v_mov_b32 v20, v24
    v_mov_b32 v21, v26
    v_mov_b32 v22, v28
    v_mov_b32 v23, v30
    v_permlane16_swap_b32 v24, v20
    v_permlane16_swap_b32 v26, v21
    v_permlane16_swap_b32 v28, v22
    v_permlane16_swap_b32 v30, v23
    v_add_f32 v24, v24, v20
    v_add_f32 v26, v26, v21
    v_add_f32 v28, v28, v22
    v_add_f32 v30, v30, v23
    v_cndmask_b32 v24, v24, v26, s[48:49]
    v_cndmask_b32 v28, v28, v30, s[48:49]
    v_cndmask_b32 v24, v24, v28, s[60:61]
    buffer_store_dword v24, v10, s[20:23], s36 offen sc1
    s_add_u32 s34, s32, 3
    s_cmp_lt_u32 s34, 32
    s_cselect_b32 s44, 0x3e8293ee, 1.0
    s_cselect_b32 s46, 0, 1
    s_mov_b32 s45, s44
    s_mul_i32 s35, s34, 135424
    s_lshl_b32 s36, s39, 6
    s_add_u32 s35, s35, s36
    s_lshl_b32 s36, s34, 13
    s_lshl_b32 s37, s39, 2
    s_add_u32 s36, s36, s37
    s_cmp_eq_u32 s46, 1
    s_cselect_b64 vcc, -1, 0
    s_lshr_b32 s47, 256, s46
    s_add_u32 s47, s47, s35
    v_cndmask_b32 v11, v8, v9, vcc
    v_pk_mul_f32 v[128:129], v[128:129], s[44:45]
    v_pk_mul_f32 v[130:131], v[130:131], s[44:45]
    v_pk_mul_f32 v[144:145], v[144:145], s[44:45]
    v_pk_mul_f32 v[146:147], v[146:147], s[44:45]
    v_pk_mul_f32 v[132:133], v[132:133], s[44:45]
    v_pk_mul_f32 v[134:135], v[134:135], s[44:45]
    v_pk_mul_f32 v[148:149], v[148:149], s[44:45]
    v_pk_mul_f32 v[150:151], v[150:151], s[44:45]
    v_pk_mul_f32 v[136:137], v[136:137], s[44:45]
    v_pk_mul_f32 v[138:139], v[138:139], s[44:45]
    v_pk_mul_f32 v[152:153], v[152:153], s[44:45]
    v_pk_mul_f32 v[154:155], v[154:155], s[44:45]
    v_pk_mul_f32 v[140:141], v[140:141], s[44:45]
    v_pk_mul_f32 v[142:143], v[142:143], s[44:45]
    v_pk_mul_f32 v[156:157], v[156:157], s[44:45]
    v_pk_mul_f32 v[158:159], v[158:159], s[44:45]
    v_pk_mul_f32 v[24:25], v[128:129], v[128:129]
    v_pk_mul_f32 v[26:27], v[132:133], v[132:133]
    v_pk_mul_f32 v[28:29], v[136:137], v[136:137]
    v_pk_mul_f32 v[30:31], v[140:141], v[140:141]
    v_pk_fma_f32 v[24:25], v[130:131], v[130:131], v[24:25]
    v_pk_fma_f32 v[26:27], v[134:135], v[134:135], v[26:27]
    v_pk_fma_f32 v[28:29], v[138:139], v[138:139], v[28:29]
    v_pk_fma_f32 v[30:31], v[142:143], v[142:143], v[30:31]
    v_pk_fma_f32 v[24:25], v[144:145], v[144:145], v[24:25]
    v_pk_fma_f32 v[26:27], v[148:149], v[148:149], v[26:27]
    v_pk_fma_f32 v[28:29], v[152:153], v[152:153], v[28:29]
    v_pk_fma_f32 v[30:31], v[156:157], v[156:157], v[30:31]
    v_pk_fma_f32 v[24:25], v[146:147], v[146:147], v[24:25]
    v_pk_fma_f32 v[26:27], v[150:151], v[150:151], v[26:27]
    v_pk_fma_f32 v[28:29], v[154:155], v[154:155], v[28:29]
    v_pk_fma_f32 v[30:31], v[158:159], v[158:159], v[30:31]
    v_cvt_pk_bf16_f32 v128, v128, v129
    v_cvt_pk_bf16_f32 v129, v130, v131
    v_cvt_pk_bf16_f32 v130, v144, v145
    v_cvt_pk_bf16_f32 v131, v146, v147
    buffer_store_dwordx4 v[128:131], v11, s[16:19], s35 offen offset:0 sc1
    v_cvt_pk_bf16_f32 v132, v132, v133
    v_cvt_pk_bf16_f32 v133, v134, v135
    v_cvt_pk_bf16_f32 v134, v148, v149
    v_cvt_pk_bf16_f32 v135, v150, v151
    buffer_store_dwordx4 v[132:135], v11, s[16:19], s47 offen offset:0 sc1
    v_cvt_pk_bf16_f32 v136, v136, v137
    v_cvt_pk_bf16_f32 v137, v138, v139
    v_cvt_pk_bf16_f32 v138, v152, v153
    v_cvt_pk_bf16_f32 v139, v154, v155
    buffer_store_dwordx4 v[136:139], v11, s[16:19], s35 offen offset:2048 sc1
    v_cvt_pk_bf16_f32 v140, v140, v141
    v_cvt_pk_bf16_f32 v141, v142, v143
    v_cvt_pk_bf16_f32 v142, v156, v157
    v_cvt_pk_bf16_f32 v143, v158, v159
    buffer_store_dwordx4 v[140:143], v11, s[16:19], s47 offen offset:2048 sc1
    v_add_f32 v24, v24, v25
    v_add_f32 v26, v26, v27
    v_add_f32 v28, v28, v29
    v_add_f32 v30, v30, v31
    v_mov_b32 v20, v24
    v_mov_b32 v21, v26
    v_mov_b32 v22, v28
    v_mov_b32 v23, v30
    v_permlane32_swap_b32 v24, v20
    v_permlane32_swap_b32 v26, v21
    v_permlane32_swap_b32 v28, v22
    v_permlane32_swap_b32 v30, v23
    v_add_f32 v24, v24, v20
    v_add_f32 v26, v26, v21
    v_add_f32 v28, v28, v22
    v_add_f32 v30, v30, v23
    v_mov_b32 v20, v24
    v_mov_b32 v21, v26
    v_mov_b32 v22, v28
    v_mov_b32 v23, v30
    v_permlane16_swap_b32 v24, v20
    v_permlane16_swap_b32 v26, v21
    v_permlane16_swap_b32 v28, v22
    v_permlane16_swap_b32 v30, v23
    v_add_f32 v24, v24, v20
    v_add_f32 v26, v26, v21
    v_add_f32 v28, v28, v22
    v_add_f32 v30, v30, v23
    v_cndmask_b32 v24, v24, v26, s[48:49]
    v_cndmask_b32 v28, v28, v30, s[48:49]
    v_cndmask_b32 v24, v24, v28, s[60:61]
    buffer_store_dword v24, v10, s[20:23], s36 offen sc1
    s_branch L_p1_sigqkv
L_p1_vpath:
    ds_read_b64_tr_b16 a[64:65], v8 offset:0
    ds_read_b64_tr_b16 a[66:67], v8 offset:1792
    ds_read_b64_tr_b16 a[68:69], v9 offset:32
    ds_read_b64_tr_b16 a[70:71], v9 offset:1824
    ds_read_b64_tr_b16 a[72:73], v8 offset:64
    ds_read_b64_tr_b16 a[74:75], v8 offset:1856
    ds_read_b64_tr_b16 a[76:77], v9 offset:96
    ds_read_b64_tr_b16 a[78:79], v9 offset:1888
    ds_read_b64_tr_b16 a[80:81], v8 offset:128
    ds_read_b64_tr_b16 a[82:83], v8 offset:1920
    ds_read_b64_tr_b16 a[84:85], v9 offset:160
    ds_read_b64_tr_b16 a[86:87], v9 offset:1952
    ds_read_b64_tr_b16 a[88:89], v8 offset:192
    ds_read_b64_tr_b16 a[90:91], v8 offset:1984
    ds_read_b64_tr_b16 a[92:93], v9 offset:224
    ds_read_b64_tr_b16 a[94:95], v9 offset:2016
    ds_read_b64_tr_b16 a[96:97], v8 offset:256
    ds_read_b64_tr_b16 a[98:99], v8 offset:2048
    ds_read_b64_tr_b16 a[100:101], v9 offset:288
    ds_read_b64_tr_b16 a[102:103], v9 offset:2080
    ds_read_b64_tr_b16 a[104:105], v8 offset:320
    ds_read_b64_tr_b16 a[106:107], v8 offset:2112
    ds_read_b64_tr_b16 a[108:109], v9 offset:352
    ds_read_b64_tr_b16 a[110:111], v9 offset:2144
    s_waitcnt vmcnt(0)
.p2align 6
L_p1_v_loop:
    s_waitcnt vmcnt(19) lgkmcnt(0)
    v_mfma_f32_16x16x32_bf16 v[32:35], a[0:3], a[64:67], v[32:35]
    ds_read_b64_tr_b16 a[120:121], v8 offset:14336
    v_mfma_f32_16x16x32_bf16 v[36:39], a[4:7], a[64:67], v[36:39]
    ds_read_b64_tr_b16 a[122:123], v8 offset:16128
    v_mfma_f32_16x16x32_bf16 v[40:43], a[8:11], a[64:67], v[40:43]
    ds_read_b64_tr_b16 a[124:125], v9 offset:14368
    v_mfma_f32_16x16x32_bf16 v[44:47], a[12:15], a[64:67], v[44:47]
    ds_read_b64_tr_b16 a[126:127], v9 offset:16160
    v_mfma_f32_16x16x32_bf16 v[48:51], a[0:3], a[68:71], v[48:51]
    ds_read_b64_tr_b16 a[128:129], v8 offset:14400
    v_mfma_f32_16x16x32_bf16 v[52:55], a[4:7], a[68:71], v[52:55]
    ds_read_b64_tr_b16 a[130:131], v8 offset:16192
    v_mfma_f32_16x16x32_bf16 v[56:59], a[8:11], a[68:71], v[56:59]
    ds_read_b64_tr_b16 a[132:133], v9 offset:14432
    v_mfma_f32_16x16x32_bf16 v[60:63], a[12:15], a[68:71], v[60:63]
    ds_read_b64_tr_b16 a[134:135], v9 offset:16224
    v_mfma_f32_16x16x32_bf16 v[64:67], a[0:3], a[72:75], v[64:67]
    ds_read_b64_tr_b16 a[136:137], v8 offset:14464
    v_mfma_f32_16x16x32_bf16 v[68:71], a[4:7], a[72:75], v[68:71]
    ds_read_b64_tr_b16 a[138:139], v8 offset:16256
    v_mfma_f32_16x16x32_bf16 v[72:75], a[8:11], a[72:75], v[72:75]
    ds_read_b64_tr_b16 a[140:141], v9 offset:14496
    buffer_load_dwordx4 a[48:51], v0, s[12:15], s25 offen offset:1536 sc1
    v_mfma_f32_16x16x32_bf16 v[76:79], a[12:15], a[72:75], v[76:79]
    ds_read_b64_tr_b16 a[142:143], v9 offset:16288
    v_mfma_f32_16x16x32_bf16 v[80:83], a[0:3], a[76:79], v[80:83]
    ds_read_b64_tr_b16 a[144:145], v8 offset:14528
    v_mfma_f32_16x16x32_bf16 v[84:87], a[4:7], a[76:79], v[84:87]
    ds_read_b64_tr_b16 a[146:147], v8 offset:16320
    v_mfma_f32_16x16x32_bf16 v[88:91], a[8:11], a[76:79], v[88:91]
    ds_read_b64_tr_b16 a[148:149], v9 offset:14560
    buffer_load_dwordx4 a[52:55], v0, s[12:15], s26 offen offset:1536 sc1
    v_mfma_f32_16x16x32_bf16 v[92:95], a[12:15], a[76:79], v[92:95]
    ds_read_b64_tr_b16 a[150:151], v9 offset:16352
    v_mfma_f32_16x16x32_bf16 v[96:99], a[0:3], a[80:83], v[96:99]
    ds_read_b64_tr_b16 a[152:153], v8 offset:14592
    v_mfma_f32_16x16x32_bf16 v[100:103], a[4:7], a[80:83], v[100:103]
    ds_read_b64_tr_b16 a[154:155], v8 offset:16384
    v_mfma_f32_16x16x32_bf16 v[104:107], a[8:11], a[80:83], v[104:107]
    ds_read_b64_tr_b16 a[156:157], v9 offset:14624
    buffer_load_dwordx4 a[56:59], v0, s[12:15], s27 offen offset:1536 sc1
    v_mfma_f32_16x16x32_bf16 v[108:111], a[12:15], a[80:83], v[108:111]
    ds_read_b64_tr_b16 a[158:159], v9 offset:16416
    v_mfma_f32_16x16x32_bf16 v[112:115], a[0:3], a[84:87], v[112:115]
    ds_read_b64_tr_b16 a[160:161], v8 offset:14656
    v_mfma_f32_16x16x32_bf16 v[116:119], a[4:7], a[84:87], v[116:119]
    ds_read_b64_tr_b16 a[162:163], v8 offset:16448
    v_mfma_f32_16x16x32_bf16 v[120:123], a[8:11], a[84:87], v[120:123]
    ds_read_b64_tr_b16 a[164:165], v9 offset:14688
    buffer_load_dwordx4 a[60:63], v0, s[12:15], s28 offen offset:1536 sc1
    v_mfma_f32_16x16x32_bf16 v[124:127], a[12:15], a[84:87], v[124:127]
    ds_read_b64_tr_b16 a[166:167], v9 offset:16480
    v_mfma_f32_16x16x32_bf16 v[128:131], a[0:3], a[88:91], v[128:131]
    v_mfma_f32_16x16x32_bf16 v[132:135], a[4:7], a[88:91], v[132:135]
    v_mfma_f32_16x16x32_bf16 v[136:139], a[8:11], a[88:91], v[136:139]
    s_add_u32 s34, s38, 4096
    s_mov_b32 m0, s34
    s_nop 0
    buffer_load_dwordx4 v5, s[8:11], s24 offen offset:0 lds
    v_mfma_f32_16x16x32_bf16 v[140:143], a[12:15], a[88:91], v[140:143]
    v_mfma_f32_16x16x32_bf16 v[144:147], a[0:3], a[92:95], v[144:147]
    v_mfma_f32_16x16x32_bf16 v[148:151], a[4:7], a[92:95], v[148:151]
    v_mfma_f32_16x16x32_bf16 v[152:155], a[8:11], a[92:95], v[152:155]
    buffer_load_dwordx4 v6, s[8:11], s24 offen offset:1024 lds
    v_mfma_f32_16x16x32_bf16 v[156:159], a[12:15], a[92:95], v[156:159]
    v_mfma_f32_16x16x32_bf16 v[160:163], a[0:3], a[96:99], v[160:163]
    v_mfma_f32_16x16x32_bf16 v[164:167], a[4:7], a[96:99], v[164:167]
    v_mfma_f32_16x16x32_bf16 v[168:171], a[8:11], a[96:99], v[168:171]
    buffer_load_dwordx4 v7, s[8:11], s24 offen offset:2048 lds
    v_mfma_f32_16x16x32_bf16 v[172:175], a[12:15], a[96:99], v[172:175]
    v_mfma_f32_16x16x32_bf16 v[176:179], a[0:3], a[100:103], v[176:179]
    v_mfma_f32_16x16x32_bf16 v[180:183], a[4:7], a[100:103], v[180:183]
    v_mfma_f32_16x16x32_bf16 v[184:187], a[8:11], a[100:103], v[184:187]
    v_mfma_f32_16x16x32_bf16 v[188:191], a[12:15], a[100:103], v[188:191]
    v_mfma_f32_16x16x32_bf16 v[192:195], a[0:3], a[104:107], v[192:195]
    v_mfma_f32_16x16x32_bf16 v[196:199], a[4:7], a[104:107], v[196:199]
    v_mfma_f32_16x16x32_bf16 v[200:203], a[8:11], a[104:107], v[200:203]
    v_mfma_f32_16x16x32_bf16 v[204:207], a[12:15], a[104:107], v[204:207]
    v_mfma_f32_16x16x32_bf16 v[208:211], a[0:3], a[108:111], v[208:211]
    v_mfma_f32_16x16x32_bf16 v[212:215], a[4:7], a[108:111], v[212:215]
    v_mfma_f32_16x16x32_bf16 v[216:219], a[8:11], a[108:111], v[216:219]
    v_mfma_f32_16x16x32_bf16 v[220:223], a[12:15], a[108:111], v[220:223]
    s_waitcnt vmcnt(15) lgkmcnt(0)
    s_barrier
    v_mfma_f32_16x16x32_bf16 v[32:35], a[16:19], a[120:123], v[32:35]
    ds_read_b64_tr_b16 a[64:65], v8 offset:32768
    v_mfma_f32_16x16x32_bf16 v[36:39], a[20:23], a[120:123], v[36:39]
    ds_read_b64_tr_b16 a[66:67], v8 offset:34560
    v_mfma_f32_16x16x32_bf16 v[40:43], a[24:27], a[120:123], v[40:43]
    ds_read_b64_tr_b16 a[68:69], v9 offset:32800
    s_add_u32 s25, s25, 2048
    v_mfma_f32_16x16x32_bf16 v[44:47], a[28:31], a[120:123], v[44:47]
    ds_read_b64_tr_b16 a[70:71], v9 offset:34592
    s_add_u32 s26, s26, 2048
    v_mfma_f32_16x16x32_bf16 v[48:51], a[16:19], a[124:127], v[48:51]
    ds_read_b64_tr_b16 a[72:73], v8 offset:32832
    s_add_u32 s27, s27, 2048
    v_mfma_f32_16x16x32_bf16 v[52:55], a[20:23], a[124:127], v[52:55]
    ds_read_b64_tr_b16 a[74:75], v8 offset:34624
    s_add_u32 s28, s28, 2048
    v_mfma_f32_16x16x32_bf16 v[56:59], a[24:27], a[124:127], v[56:59]
    ds_read_b64_tr_b16 a[76:77], v9 offset:32864
    s_cmp_eq_u32 s29, 1
    v_mfma_f32_16x16x32_bf16 v[60:63], a[28:31], a[124:127], v[60:63]
    ds_read_b64_tr_b16 a[78:79], v9 offset:34656
    s_cselect_b32 s14, 0, s14
    v_mfma_f32_16x16x32_bf16 v[64:67], a[16:19], a[128:131], v[64:67]
    ds_read_b64_tr_b16 a[80:81], v8 offset:32896
    v_mfma_f32_16x16x32_bf16 v[68:71], a[20:23], a[128:131], v[68:71]
    ds_read_b64_tr_b16 a[82:83], v8 offset:34688
    v_mfma_f32_16x16x32_bf16 v[72:75], a[24:27], a[128:131], v[72:75]
    ds_read_b64_tr_b16 a[84:85], v9 offset:32928
    buffer_load_dwordx4 a[0:3], v0, s[12:15], s25 offen offset:0 sc1
    v_mfma_f32_16x16x32_bf16 v[76:79], a[28:31], a[128:131], v[76:79]
    ds_read_b64_tr_b16 a[86:87], v9 offset:34720
    v_mfma_f32_16x16x32_bf16 v[80:83], a[16:19], a[132:135], v[80:83]
    ds_read_b64_tr_b16 a[88:89], v8 offset:32960
    v_mfma_f32_16x16x32_bf16 v[84:87], a[20:23], a[132:135], v[84:87]
    ds_read_b64_tr_b16 a[90:91], v8 offset:34752
    v_mfma_f32_16x16x32_bf16 v[88:91], a[24:27], a[132:135], v[88:91]
    ds_read_b64_tr_b16 a[92:93], v9 offset:32992
    buffer_load_dwordx4 a[4:7], v0, s[12:15], s26 offen offset:0 sc1
    v_mfma_f32_16x16x32_bf16 v[92:95], a[28:31], a[132:135], v[92:95]
    ds_read_b64_tr_b16 a[94:95], v9 offset:34784
    v_mfma_f32_16x16x32_bf16 v[96:99], a[16:19], a[136:139], v[96:99]
    ds_read_b64_tr_b16 a[96:97], v8 offset:33024
    v_mfma_f32_16x16x32_bf16 v[100:103], a[20:23], a[136:139], v[100:103]
    ds_read_b64_tr_b16 a[98:99], v8 offset:34816
    v_mfma_f32_16x16x32_bf16 v[104:107], a[24:27], a[136:139], v[104:107]
    ds_read_b64_tr_b16 a[100:101], v9 offset:33056
    buffer_load_dwordx4 a[8:11], v0, s[12:15], s27 offen offset:0 sc1
    v_mfma_f32_16x16x32_bf16 v[108:111], a[28:31], a[136:139], v[108:111]
    ds_read_b64_tr_b16 a[102:103], v9 offset:34848
    v_mfma_f32_16x16x32_bf16 v[112:115], a[16:19], a[140:143], v[112:115]
    ds_read_b64_tr_b16 a[104:105], v8 offset:33088
    v_mfma_f32_16x16x32_bf16 v[116:119], a[20:23], a[140:143], v[116:119]
    ds_read_b64_tr_b16 a[106:107], v8 offset:34880
    v_mfma_f32_16x16x32_bf16 v[120:123], a[24:27], a[140:143], v[120:123]
    ds_read_b64_tr_b16 a[108:109], v9 offset:33120
    buffer_load_dwordx4 a[12:15], v0, s[12:15], s28 offen offset:0 sc1
    v_mfma_f32_16x16x32_bf16 v[124:127], a[28:31], a[140:143], v[124:127]
    ds_read_b64_tr_b16 a[110:111], v9 offset:34912
    v_mfma_f32_16x16x32_bf16 v[128:131], a[16:19], a[144:147], v[128:131]
    v_mfma_f32_16x16x32_bf16 v[132:135], a[20:23], a[144:147], v[132:135]
    v_mfma_f32_16x16x32_bf16 v[136:139], a[24:27], a[144:147], v[136:139]
    s_add_u32 s24, s24, s43
    s_add_u32 s38, s38, 32768
    s_and_b32 s38, s38, 131071
    s_mov_b32 m0, s38
    s_nop 0
    buffer_load_dwordx4 v1, s[8:11], s24 offen offset:0 lds
    v_mfma_f32_16x16x32_bf16 v[140:143], a[28:31], a[144:147], v[140:143]
    v_mfma_f32_16x16x32_bf16 v[144:147], a[16:19], a[148:151], v[144:147]
    v_mfma_f32_16x16x32_bf16 v[148:151], a[20:23], a[148:151], v[148:151]
    v_mfma_f32_16x16x32_bf16 v[152:155], a[24:27], a[148:151], v[152:155]
    buffer_load_dwordx4 v2, s[8:11], s24 offen offset:1024 lds
    v_mfma_f32_16x16x32_bf16 v[156:159], a[28:31], a[148:151], v[156:159]
    v_mfma_f32_16x16x32_bf16 v[160:163], a[16:19], a[152:155], v[160:163]
    v_mfma_f32_16x16x32_bf16 v[164:167], a[20:23], a[152:155], v[164:167]
    v_mfma_f32_16x16x32_bf16 v[168:171], a[24:27], a[152:155], v[168:171]
    buffer_load_dwordx4 v3, s[8:11], s24 offen offset:2048 lds
    v_mfma_f32_16x16x32_bf16 v[172:175], a[28:31], a[152:155], v[172:175]
    v_mfma_f32_16x16x32_bf16 v[176:179], a[16:19], a[156:159], v[176:179]
    v_mfma_f32_16x16x32_bf16 v[180:183], a[20:23], a[156:159], v[180:183]
    v_mfma_f32_16x16x32_bf16 v[184:187], a[24:27], a[156:159], v[184:187]
    buffer_load_dwordx4 v4, s[8:11], s24 offen offset:3072 lds
    v_mfma_f32_16x16x32_bf16 v[188:191], a[28:31], a[156:159], v[188:191]
    v_mfma_f32_16x16x32_bf16 v[192:195], a[16:19], a[160:163], v[192:195]
    v_mfma_f32_16x16x32_bf16 v[196:199], a[20:23], a[160:163], v[196:199]
    v_mfma_f32_16x16x32_bf16 v[200:203], a[24:27], a[160:163], v[200:203]
    v_mfma_f32_16x16x32_bf16 v[204:207], a[28:31], a[160:163], v[204:207]
    v_mfma_f32_16x16x32_bf16 v[208:211], a[16:19], a[164:167], v[208:211]
    v_mfma_f32_16x16x32_bf16 v[212:215], a[20:23], a[164:167], v[212:215]
    v_mfma_f32_16x16x32_bf16 v[216:219], a[24:27], a[164:167], v[216:219]
    v_mfma_f32_16x16x32_bf16 v[220:223], a[28:31], a[164:167], v[220:223]
    s_waitcnt vmcnt(19) lgkmcnt(0)
    v_mfma_f32_16x16x32_bf16 v[32:35], a[32:35], a[64:67], v[32:35]
    ds_read_b64_tr_b16 a[120:121], v8 offset:47104
    v_mfma_f32_16x16x32_bf16 v[36:39], a[36:39], a[64:67], v[36:39]
    ds_read_b64_tr_b16 a[122:123], v8 offset:48896
    v_mfma_f32_16x16x32_bf16 v[40:43], a[40:43], a[64:67], v[40:43]
    ds_read_b64_tr_b16 a[124:125], v9 offset:47136
    v_mfma_f32_16x16x32_bf16 v[44:47], a[44:47], a[64:67], v[44:47]
    ds_read_b64_tr_b16 a[126:127], v9 offset:48928
    v_mfma_f32_16x16x32_bf16 v[48:51], a[32:35], a[68:71], v[48:51]
    ds_read_b64_tr_b16 a[128:129], v8 offset:47168
    v_mfma_f32_16x16x32_bf16 v[52:55], a[36:39], a[68:71], v[52:55]
    ds_read_b64_tr_b16 a[130:131], v8 offset:48960
    v_mfma_f32_16x16x32_bf16 v[56:59], a[40:43], a[68:71], v[56:59]
    ds_read_b64_tr_b16 a[132:133], v9 offset:47200
    v_mfma_f32_16x16x32_bf16 v[60:63], a[44:47], a[68:71], v[60:63]
    ds_read_b64_tr_b16 a[134:135], v9 offset:48992
    v_mfma_f32_16x16x32_bf16 v[64:67], a[32:35], a[72:75], v[64:67]
    ds_read_b64_tr_b16 a[136:137], v8 offset:47232
    v_mfma_f32_16x16x32_bf16 v[68:71], a[36:39], a[72:75], v[68:71]
    ds_read_b64_tr_b16 a[138:139], v8 offset:49024
    v_mfma_f32_16x16x32_bf16 v[72:75], a[40:43], a[72:75], v[72:75]
    ds_read_b64_tr_b16 a[140:141], v9 offset:47264
    buffer_load_dwordx4 a[16:19], v0, s[12:15], s25 offen offset:512 sc1
    v_mfma_f32_16x16x32_bf16 v[76:79], a[44:47], a[72:75], v[76:79]
    ds_read_b64_tr_b16 a[142:143], v9 offset:49056
    v_mfma_f32_16x16x32_bf16 v[80:83], a[32:35], a[76:79], v[80:83]
    ds_read_b64_tr_b16 a[144:145], v8 offset:47296
    v_mfma_f32_16x16x32_bf16 v[84:87], a[36:39], a[76:79], v[84:87]
    ds_read_b64_tr_b16 a[146:147], v8 offset:49088
    v_mfma_f32_16x16x32_bf16 v[88:91], a[40:43], a[76:79], v[88:91]
    ds_read_b64_tr_b16 a[148:149], v9 offset:47328
    buffer_load_dwordx4 a[20:23], v0, s[12:15], s26 offen offset:512 sc1
    v_mfma_f32_16x16x32_bf16 v[92:95], a[44:47], a[76:79], v[92:95]
    ds_read_b64_tr_b16 a[150:151], v9 offset:49120
    v_mfma_f32_16x16x32_bf16 v[96:99], a[32:35], a[80:83], v[96:99]
    ds_read_b64_tr_b16 a[152:153], v8 offset:47360
    v_mfma_f32_16x16x32_bf16 v[100:103], a[36:39], a[80:83], v[100:103]
    ds_read_b64_tr_b16 a[154:155], v8 offset:49152
    v_mfma_f32_16x16x32_bf16 v[104:107], a[40:43], a[80:83], v[104:107]
    ds_read_b64_tr_b16 a[156:157], v9 offset:47392
    buffer_load_dwordx4 a[24:27], v0, s[12:15], s27 offen offset:512 sc1
    v_mfma_f32_16x16x32_bf16 v[108:111], a[44:47], a[80:83], v[108:111]
    ds_read_b64_tr_b16 a[158:159], v9 offset:49184
    v_mfma_f32_16x16x32_bf16 v[112:115], a[32:35], a[84:87], v[112:115]
    ds_read_b64_tr_b16 a[160:161], v8 offset:47424
    v_mfma_f32_16x16x32_bf16 v[116:119], a[36:39], a[84:87], v[116:119]
    ds_read_b64_tr_b16 a[162:163], v8 offset:49216
    v_mfma_f32_16x16x32_bf16 v[120:123], a[40:43], a[84:87], v[120:123]
    ds_read_b64_tr_b16 a[164:165], v9 offset:47456
    buffer_load_dwordx4 a[28:31], v0, s[12:15], s28 offen offset:512 sc1
    v_mfma_f32_16x16x32_bf16 v[124:127], a[44:47], a[84:87], v[124:127]
    ds_read_b64_tr_b16 a[166:167], v9 offset:49248
    v_mfma_f32_16x16x32_bf16 v[128:131], a[32:35], a[88:91], v[128:131]
    v_mfma_f32_16x16x32_bf16 v[132:135], a[36:39], a[88:91], v[132:135]
    v_mfma_f32_16x16x32_bf16 v[136:139], a[40:43], a[88:91], v[136:139]
    s_add_u32 s34, s38, 4096
    s_mov_b32 m0, s34
    s_nop 0
    buffer_load_dwordx4 v5, s[8:11], s24 offen offset:0 lds
    v_mfma_f32_16x16x32_bf16 v[140:143], a[44:47], a[88:91], v[140:143]
    v_mfma_f32_16x16x32_bf16 v[144:147], a[32:35], a[92:95], v[144:147]
    v_mfma_f32_16x16x32_bf16 v[148:151], a[36:39], a[92:95], v[148:151]
    v_mfma_f32_16x16x32_bf16 v[152:155], a[40:43], a[92:95], v[152:155]
    buffer_load_dwordx4 v6, s[8:11], s24 offen offset:1024 lds
    v_mfma_f32_16x16x32_bf16 v[156:159], a[44:47], a[92:95], v[156:159]
    v_mfma_f32_16x16x32_bf16 v[160:163], a[32:35], a[96:99], v[160:163]
    v_mfma_f32_16x16x32_bf16 v[164:167], a[36:39], a[96:99], v[164:167]
    v_mfma_f32_16x16x32_bf16 v[168:171], a[40:43], a[96:99], v[168:171]
    buffer_load_dwordx4 v7, s[8:11], s24 offen offset:2048 lds
    v_mfma_f32_16x16x32_bf16 v[172:175], a[44:47], a[96:99], v[172:175]
    v_mfma_f32_16x16x32_bf16 v[176:179], a[32:35], a[100:103], v[176:179]
    v_mfma_f32_16x16x32_bf16 v[180:183], a[36:39], a[100:103], v[180:183]
    v_mfma_f32_16x16x32_bf16 v[184:187], a[40:43], a[100:103], v[184:187]
    v_mfma_f32_16x16x32_bf16 v[188:191], a[44:47], a[100:103], v[188:191]
    v_mfma_f32_16x16x32_bf16 v[192:195], a[32:35], a[104:107], v[192:195]
    v_mfma_f32_16x16x32_bf16 v[196:199], a[36:39], a[104:107], v[196:199]
    v_mfma_f32_16x16x32_bf16 v[200:203], a[40:43], a[104:107], v[200:203]
    v_mfma_f32_16x16x32_bf16 v[204:207], a[44:47], a[104:107], v[204:207]
    v_mfma_f32_16x16x32_bf16 v[208:211], a[32:35], a[108:111], v[208:211]
    v_mfma_f32_16x16x32_bf16 v[212:215], a[36:39], a[108:111], v[212:215]
    v_mfma_f32_16x16x32_bf16 v[216:219], a[40:43], a[108:111], v[216:219]
    v_mfma_f32_16x16x32_bf16 v[220:223], a[44:47], a[108:111], v[220:223]
    s_waitcnt vmcnt(15) lgkmcnt(0)
    s_barrier
    v_mfma_f32_16x16x32_bf16 v[32:35], a[48:51], a[120:123], v[32:35]
    v_xor_b32 v8, 0x10000, v8
    v_mfma_f32_16x16x32_bf16 v[36:39], a[52:55], a[120:123], v[36:39]
    v_xor_b32 v9, 0x10000, v9
    v_mfma_f32_16x16x32_bf16 v[40:43], a[56:59], a[120:123], v[40:43]
    ds_read_b64_tr_b16 a[64:65], v8 offset:0
    v_mfma_f32_16x16x32_bf16 v[44:47], a[60:63], a[120:123], v[44:47]
    ds_read_b64_tr_b16 a[66:67], v8 offset:1792
    v_mfma_f32_16x16x32_bf16 v[48:51], a[48:51], a[124:127], v[48:51]
    ds_read_b64_tr_b16 a[68:69], v9 offset:32
    v_mfma_f32_16x16x32_bf16 v[52:55], a[52:55], a[124:127], v[52:55]
    ds_read_b64_tr_b16 a[70:71], v9 offset:1824
    v_mfma_f32_16x16x32_bf16 v[56:59], a[56:59], a[124:127], v[56:59]
    ds_read_b64_tr_b16 a[72:73], v8 offset:64
    v_mfma_f32_16x16x32_bf16 v[60:63], a[60:63], a[124:127], v[60:63]
    ds_read_b64_tr_b16 a[74:75], v8 offset:1856
    v_mfma_f32_16x16x32_bf16 v[64:67], a[48:51], a[128:131], v[64:67]
    ds_read_b64_tr_b16 a[76:77], v9 offset:96
    v_mfma_f32_16x16x32_bf16 v[68:71], a[52:55], a[128:131], v[68:71]
    ds_read_b64_tr_b16 a[78:79], v9 offset:1888
    v_mfma_f32_16x16x32_bf16 v[72:75], a[56:59], a[128:131], v[72:75]
    ds_read_b64_tr_b16 a[80:81], v8 offset:128
    buffer_load_dwordx4 a[32:35], v0, s[12:15], s25 offen offset:1024 sc1
    v_mfma_f32_16x16x32_bf16 v[76:79], a[60:63], a[128:131], v[76:79]
    ds_read_b64_tr_b16 a[82:83], v8 offset:1920
    v_mfma_f32_16x16x32_bf16 v[80:83], a[48:51], a[132:135], v[80:83]
    ds_read_b64_tr_b16 a[84:85], v9 offset:160
    v_mfma_f32_16x16x32_bf16 v[84:87], a[52:55], a[132:135], v[84:87]
    ds_read_b64_tr_b16 a[86:87], v9 offset:1952
    v_mfma_f32_16x16x32_bf16 v[88:91], a[56:59], a[132:135], v[88:91]
    ds_read_b64_tr_b16 a[88:89], v8 offset:192
    buffer_load_dwordx4 a[36:39], v0, s[12:15], s26 offen offset:1024 sc1
    v_mfma_f32_16x16x32_bf16 v[92:95], a[60:63], a[132:135], v[92:95]
    ds_read_b64_tr_b16 a[90:91], v8 offset:1984
    v_mfma_f32_16x16x32_bf16 v[96:99], a[48:51], a[136:139], v[96:99]
    ds_read_b64_tr_b16 a[92:93], v9 offset:224
    v_mfma_f32_16x16x32_bf16 v[100:103], a[52:55], a[136:139], v[100:103]
    ds_read_b64_tr_b16 a[94:95], v9 offset:2016
    v_mfma_f32_16x16x32_bf16 v[104:107], a[56:59], a[136:139], v[104:107]
    ds_read_b64_tr_b16 a[96:97], v8 offset:256
    buffer_load_dwordx4 a[40:43], v0, s[12:15], s27 offen offset:1024 sc1
    v_mfma_f32_16x16x32_bf16 v[108:111], a[60:63], a[136:139], v[108:111]
    ds_read_b64_tr_b16 a[98:99], v8 offset:2048
    v_mfma_f32_16x16x32_bf16 v[112:115], a[48:51], a[140:143], v[112:115]
    ds_read_b64_tr_b16 a[100:101], v9 offset:288
    v_mfma_f32_16x16x32_bf16 v[116:119], a[52:55], a[140:143], v[116:119]
    ds_read_b64_tr_b16 a[102:103], v9 offset:2080
    v_mfma_f32_16x16x32_bf16 v[120:123], a[56:59], a[140:143], v[120:123]
    ds_read_b64_tr_b16 a[104:105], v8 offset:320
    buffer_load_dwordx4 a[44:47], v0, s[12:15], s28 offen offset:1024 sc1
    v_mfma_f32_16x16x32_bf16 v[124:127], a[60:63], a[140:143], v[124:127]
    ds_read_b64_tr_b16 a[106:107], v8 offset:2112
    v_mfma_f32_16x16x32_bf16 v[128:131], a[48:51], a[144:147], v[128:131]
    ds_read_b64_tr_b16 a[108:109], v9 offset:352
    v_mfma_f32_16x16x32_bf16 v[132:135], a[52:55], a[144:147], v[132:135]
    ds_read_b64_tr_b16 a[110:111], v9 offset:2144
    v_mfma_f32_16x16x32_bf16 v[136:139], a[56:59], a[144:147], v[136:139]
    s_add_u32 s24, s24, s43
    s_add_u32 s38, s38, 32768
    s_and_b32 s38, s38, 131071
    s_mov_b32 m0, s38
    s_nop 0
    buffer_load_dwordx4 v1, s[8:11], s24 offen offset:0 lds
    v_mfma_f32_16x16x32_bf16 v[140:143], a[60:63], a[144:147], v[140:143]
    v_mfma_f32_16x16x32_bf16 v[144:147], a[48:51], a[148:151], v[144:147]
    v_mfma_f32_16x16x32_bf16 v[148:151], a[52:55], a[148:151], v[148:151]
    v_mfma_f32_16x16x32_bf16 v[152:155], a[56:59], a[148:151], v[152:155]
    buffer_load_dwordx4 v2, s[8:11], s24 offen offset:1024 lds
    v_mfma_f32_16x16x32_bf16 v[156:159], a[60:63], a[148:151], v[156:159]
    v_mfma_f32_16x16x32_bf16 v[160:163], a[48:51], a[152:155], v[160:163]
    v_mfma_f32_16x16x32_bf16 v[164:167], a[52:55], a[152:155], v[164:167]
    v_mfma_f32_16x16x32_bf16 v[168:171], a[56:59], a[152:155], v[168:171]
    buffer_load_dwordx4 v3, s[8:11], s24 offen offset:2048 lds
    v_mfma_f32_16x16x32_bf16 v[172:175], a[60:63], a[152:155], v[172:175]
    v_mfma_f32_16x16x32_bf16 v[176:179], a[48:51], a[156:159], v[176:179]
    v_mfma_f32_16x16x32_bf16 v[180:183], a[52:55], a[156:159], v[180:183]
    v_mfma_f32_16x16x32_bf16 v[184:187], a[56:59], a[156:159], v[184:187]
    buffer_load_dwordx4 v4, s[8:11], s24 offen offset:3072 lds
    v_mfma_f32_16x16x32_bf16 v[188:191], a[60:63], a[156:159], v[188:191]
    v_mfma_f32_16x16x32_bf16 v[192:195], a[48:51], a[160:163], v[192:195]
    v_mfma_f32_16x16x32_bf16 v[196:199], a[52:55], a[160:163], v[196:199]
    v_mfma_f32_16x16x32_bf16 v[200:203], a[56:59], a[160:163], v[200:203]
    v_mfma_f32_16x16x32_bf16 v[204:207], a[60:63], a[160:163], v[204:207]
    v_mfma_f32_16x16x32_bf16 v[208:211], a[48:51], a[164:167], v[208:211]
    v_mfma_f32_16x16x32_bf16 v[212:215], a[52:55], a[164:167], v[212:215]
    v_mfma_f32_16x16x32_bf16 v[216:219], a[56:59], a[164:167], v[216:219]
    v_mfma_f32_16x16x32_bf16 v[220:223], a[60:63], a[164:167], v[220:223]
    s_sub_u32 s29, s29, 1
    s_cmp_lg_u32 s29, 0
    s_cbranch_scc1 L_p1_v_loop
    s_waitcnt vmcnt(0)
    s_barrier
    v_and_b32 v3, 15, v17
    v_lshrrev_b32 v4, 4, v17
    v_lshrrev_b32 v7, 1, v4
    v_lshlrev_b32 v7, 10, v7
    v_and_b32 v8, 1, v4
    v_lshl_add_u32 v7, v8, 9, v7
    s_add_u32 s4, s40, 4194304
    s_addc_u32 s5, s41, 0
    s_mov_b32 s16, s4
    s_and_b32 s17, s5, 0xffff
    s_mov_b32 s18, 13000704
    s_mov_b32 s19, 0x00020000
    v_lshl_add_u32 v6, v3, 4, v7
    s_mul_i32 s37, s32, 135424
    s_lshl_b32 s47, s39, 6
    s_add_u32 s37, s37, s47
    v_cvt_pk_bf16_f32 v32, v32, v33
    v_cvt_pk_bf16_f32 v33, v34, v35
    v_cvt_pk_bf16_f32 v34, v36, v37
    v_cvt_pk_bf16_f32 v35, v38, v39
    s_add_u32 s47, s37, 0
    buffer_store_dwordx4 v[32:35], v6, s[16:19], s47 offen offset:0 sc1
    v_cvt_pk_bf16_f32 v48, v48, v49
    v_cvt_pk_bf16_f32 v49, v50, v51
    v_cvt_pk_bf16_f32 v50, v52, v53
    v_cvt_pk_bf16_f32 v51, v54, v55
    s_add_u32 s47, s37, 0
    buffer_store_dwordx4 v[48:51], v6, s[16:19], s47 offen offset:256 sc1
    v_cvt_pk_bf16_f32 v64, v64, v65
    v_cvt_pk_bf16_f32 v65, v66, v67
    v_cvt_pk_bf16_f32 v66, v68, v69
    v_cvt_pk_bf16_f32 v67, v70, v71
    s_add_u32 s47, s37, 135424
    buffer_store_dwordx4 v[64:67], v6, s[16:19], s47 offen offset:0 sc1
    v_cvt_pk_bf16_f32 v80, v80, v81
    v_cvt_pk_bf16_f32 v81, v82, v83
    v_cvt_pk_bf16_f32 v82, v84, v85
    v_cvt_pk_bf16_f32 v83, v86, v87
    s_add_u32 s47, s37, 135424
    buffer_store_dwordx4 v[80:83], v6, s[16:19], s47 offen offset:256 sc1
    v_cvt_pk_bf16_f32 v96, v96, v97
    v_cvt_pk_bf16_f32 v97, v98, v99
    v_cvt_pk_bf16_f32 v98, v100, v101
    v_cvt_pk_bf16_f32 v99, v102, v103
    s_add_u32 s47, s37, 270848
    buffer_store_dwordx4 v[96:99], v6, s[16:19], s47 offen offset:0 sc1
    v_cvt_pk_bf16_f32 v112, v112, v113
    v_cvt_pk_bf16_f32 v113, v114, v115
    v_cvt_pk_bf16_f32 v114, v116, v117
    v_cvt_pk_bf16_f32 v115, v118, v119
    s_add_u32 s47, s37, 270848
    buffer_store_dwordx4 v[112:115], v6, s[16:19], s47 offen offset:256 sc1
    v_cvt_pk_bf16_f32 v128, v128, v129
    v_cvt_pk_bf16_f32 v129, v130, v131
    v_cvt_pk_bf16_f32 v130, v132, v133
    v_cvt_pk_bf16_f32 v131, v134, v135
    s_add_u32 s47, s37, 406272
    buffer_store_dwordx4 v[128:131], v6, s[16:19], s47 offen offset:0 sc1
    v_cvt_pk_bf16_f32 v144, v144, v145
    v_cvt_pk_bf16_f32 v145, v146, v147
    v_cvt_pk_bf16_f32 v146, v148, v149
    v_cvt_pk_bf16_f32 v147, v150, v151
    s_add_u32 s47, s37, 406272
    buffer_store_dwordx4 v[144:147], v6, s[16:19], s47 offen offset:256 sc1
    v_cvt_pk_bf16_f32 v160, v160, v161
    v_cvt_pk_bf16_f32 v161, v162, v163
    v_cvt_pk_bf16_f32 v162, v164, v165
    v_cvt_pk_bf16_f32 v163, v166, v167
    s_add_u32 s47, s37, 541696
    buffer_store_dwordx4 v[160:163], v6, s[16:19], s47 offen offset:0 sc1
    v_cvt_pk_bf16_f32 v176, v176, v177
    v_cvt_pk_bf16_f32 v177, v178, v179
    v_cvt_pk_bf16_f32 v178, v180, v181
    v_cvt_pk_bf16_f32 v179, v182, v183
    s_add_u32 s47, s37, 541696
    buffer_store_dwordx4 v[176:179], v6, s[16:19], s47 offen offset:256 sc1
    v_cvt_pk_bf16_f32 v192, v192, v193
    v_cvt_pk_bf16_f32 v193, v194, v195
    v_cvt_pk_bf16_f32 v194, v196, v197
    v_cvt_pk_bf16_f32 v195, v198, v199
    s_add_u32 s47, s37, 677120
    buffer_store_dwordx4 v[192:195], v6, s[16:19], s47 offen offset:0 sc1
    v_cvt_pk_bf16_f32 v208, v208, v209
    v_cvt_pk_bf16_f32 v209, v210, v211
    v_cvt_pk_bf16_f32 v210, v212, v213
    v_cvt_pk_bf16_f32 v211, v214, v215
    s_add_u32 s47, s37, 677120
    buffer_store_dwordx4 v[208:211], v6, s[16:19], s47 offen offset:256 sc1
    v_cvt_pk_bf16_f32 v40, v40, v41
    v_cvt_pk_bf16_f32 v41, v42, v43
    v_cvt_pk_bf16_f32 v42, v44, v45
    v_cvt_pk_bf16_f32 v43, v46, v47
    s_add_u32 s47, s37, 2048
    buffer_store_dwordx4 v[40:43], v6, s[16:19], s47 offen offset:0 sc1
    v_cvt_pk_bf16_f32 v56, v56, v57
    v_cvt_pk_bf16_f32 v57, v58, v59
    v_cvt_pk_bf16_f32 v58, v60, v61
    v_cvt_pk_bf16_f32 v59, v62, v63
    s_add_u32 s47, s37, 2048
    buffer_store_dwordx4 v[56:59], v6, s[16:19], s47 offen offset:256 sc1
    v_cvt_pk_bf16_f32 v72, v72, v73
    v_cvt_pk_bf16_f32 v73, v74, v75
    v_cvt_pk_bf16_f32 v74, v76, v77
    v_cvt_pk_bf16_f32 v75, v78, v79
    s_add_u32 s47, s37, 137472
    buffer_store_dwordx4 v[72:75], v6, s[16:19], s47 offen offset:0 sc1
    v_cvt_pk_bf16_f32 v88, v88, v89
    v_cvt_pk_bf16_f32 v89, v90, v91
    v_cvt_pk_bf16_f32 v90, v92, v93
    v_cvt_pk_bf16_f32 v91, v94, v95
    s_add_u32 s47, s37, 137472
    buffer_store_dwordx4 v[88:91], v6, s[16:19], s47 offen offset:256 sc1
    v_cvt_pk_bf16_f32 v104, v104, v105
    v_cvt_pk_bf16_f32 v105, v106, v107
    v_cvt_pk_bf16_f32 v106, v108, v109
    v_cvt_pk_bf16_f32 v107, v110, v111
    s_add_u32 s47, s37, 272896
    buffer_store_dwordx4 v[104:107], v6, s[16:19], s47 offen offset:0 sc1
    v_cvt_pk_bf16_f32 v120, v120, v121
    v_cvt_pk_bf16_f32 v121, v122, v123
    v_cvt_pk_bf16_f32 v122, v124, v125
    v_cvt_pk_bf16_f32 v123, v126, v127
    s_add_u32 s47, s37, 272896
    buffer_store_dwordx4 v[120:123], v6, s[16:19], s47 offen offset:256 sc1
    v_cvt_pk_bf16_f32 v136, v136, v137
    v_cvt_pk_bf16_f32 v137, v138, v139
    v_cvt_pk_bf16_f32 v138, v140, v141
    v_cvt_pk_bf16_f32 v139, v142, v143
    s_add_u32 s47, s37, 408320
    buffer_store_dwordx4 v[136:139], v6, s[16:19], s47 offen offset:0 sc1
    v_cvt_pk_bf16_f32 v152, v152, v153
    v_cvt_pk_bf16_f32 v153, v154, v155
    v_cvt_pk_bf16_f32 v154, v156, v157
    v_cvt_pk_bf16_f32 v155, v158, v159
    s_add_u32 s47, s37, 408320
    buffer_store_dwordx4 v[152:155], v6, s[16:19], s47 offen offset:256 sc1
    v_cvt_pk_bf16_f32 v168, v168, v169
    v_cvt_pk_bf16_f32 v169, v170, v171
    v_cvt_pk_bf16_f32 v170, v172, v173
    v_cvt_pk_bf16_f32 v171, v174, v175
    s_add_u32 s47, s37, 543744
    buffer_store_dwordx4 v[168:171], v6, s[16:19], s47 offen offset:0 sc1
    v_cvt_pk_bf16_f32 v184, v184, v185
    v_cvt_pk_bf16_f32 v185, v186, v187
    v_cvt_pk_bf16_f32 v186, v188, v189
    v_cvt_pk_bf16_f32 v187, v190, v191
    s_add_u32 s47, s37, 543744
    buffer_store_dwordx4 v[184:187], v6, s[16:19], s47 offen offset:256 sc1
    v_cvt_pk_bf16_f32 v200, v200, v201
    v_cvt_pk_bf16_f32 v201, v202, v203
    v_cvt_pk_bf16_f32 v202, v204, v205
    v_cvt_pk_bf16_f32 v203, v206, v207
    s_add_u32 s47, s37, 679168
    buffer_store_dwordx4 v[200:203], v6, s[16:19], s47 offen offset:0 sc1
    v_cvt_pk_bf16_f32 v216, v216, v217
    v_cvt_pk_bf16_f32 v217, v218, v219
    v_cvt_pk_bf16_f32 v218, v220, v221
    v_cvt_pk_bf16_f32 v219, v222, v223
    s_add_u32 s47, s37, 679168
    buffer_store_dwordx4 v[216:219], v6, s[16:19], s47 offen offset:256 sc1
    s_branch L_p1_sigqkv
L_p1_hpath:
    ds_read_b64_tr_b16 a[64:65], v8 offset:0
    ds_read_b64_tr_b16 a[66:67], v8 offset:1792
    ds_read_b64_tr_b16 a[68:69], v9 offset:32
    ds_read_b64_tr_b16 a[70:71], v9 offset:1824
    ds_read_b64_tr_b16 a[72:73], v8 offset:64
    ds_read_b64_tr_b16 a[74:75], v8 offset:1856
    ds_read_b64_tr_b16 a[76:77], v9 offset:96
    ds_read_b64_tr_b16 a[78:79], v9 offset:1888
    ds_read_b64_tr_b16 a[80:81], v8 offset:128
    ds_read_b64_tr_b16 a[82:83], v8 offset:1920
    ds_read_b64_tr_b16 a[84:85], v9 offset:160
    ds_read_b64_tr_b16 a[86:87], v9 offset:1952
    ds_read_b64_tr_b16 a[88:89], v8 offset:192
    ds_read_b64_tr_b16 a[90:91], v8 offset:1984
    ds_read_b64_tr_b16 a[92:93], v9 offset:224
    ds_read_b64_tr_b16 a[94:95], v9 offset:2016
    ds_read_b64_tr_b16 a[96:97], v8 offset:256
    ds_read_b64_tr_b16 a[98:99], v8 offset:2048
    ds_read_b64_tr_b16 a[100:101], v9 offset:288
    ds_read_b64_tr_b16 a[102:103], v9 offset:2080
    ds_read_b64_tr_b16 a[104:105], v8 offset:320
    ds_read_b64_tr_b16 a[106:107], v8 offset:2112
    ds_read_b64_tr_b16 a[108:109], v9 offset:352
    ds_read_b64_tr_b16 a[110:111], v9 offset:2144
    ds_read_b64_tr_b16 a[112:113], v8 offset:384
    ds_read_b64_tr_b16 a[114:115], v8 offset:2176
    ds_read_b64_tr_b16 a[116:117], v9 offset:416
    ds_read_b64_tr_b16 a[118:119], v9 offset:2208
    s_waitcnt vmcnt(0)
.p2align 6
L_p1_h_loop:
    s_waitcnt vmcnt(19) lgkmcnt(0)
    v_mfma_f32_16x16x32_bf16 v[32:35], a[64:67], a[0:3], v[32:35]
    ds_read_b64_tr_b16 a[120:121], v8 offset:14336
    v_mfma_f32_16x16x32_bf16 v[36:39], a[64:67], a[4:7], v[36:39]
    ds_read_b64_tr_b16 a[122:123], v8 offset:16128
    v_mfma_f32_16x16x32_bf16 v[40:43], a[64:67], a[8:11], v[40:43]
    ds_read_b64_tr_b16 a[124:125], v9 offset:14368
    v_mfma_f32_16x16x32_bf16 v[44:47], a[64:67], a[12:15], v[44:47]
    ds_read_b64_tr_b16 a[126:127], v9 offset:16160
    v_mfma_f32_16x16x32_bf16 v[48:51], a[68:71], a[0:3], v[48:51]
    ds_read_b64_tr_b16 a[128:129], v8 offset:14400
    v_mfma_f32_16x16x32_bf16 v[52:55], a[68:71], a[4:7], v[52:55]
    ds_read_b64_tr_b16 a[130:131], v8 offset:16192
    v_mfma_f32_16x16x32_bf16 v[56:59], a[68:71], a[8:11], v[56:59]
    ds_read_b64_tr_b16 a[132:133], v9 offset:14432
    v_mfma_f32_16x16x32_bf16 v[60:63], a[68:71], a[12:15], v[60:63]
    ds_read_b64_tr_b16 a[134:135], v9 offset:16224
    v_mfma_f32_16x16x32_bf16 v[64:67], a[72:75], a[0:3], v[64:67]
    ds_read_b64_tr_b16 a[136:137], v8 offset:14464
    v_mfma_f32_16x16x32_bf16 v[68:71], a[72:75], a[4:7], v[68:71]
    ds_read_b64_tr_b16 a[138:139], v8 offset:16256
    v_mfma_f32_16x16x32_bf16 v[72:75], a[72:75], a[8:11], v[72:75]
    ds_read_b64_tr_b16 a[140:141], v9 offset:14496
    buffer_load_dwordx4 a[48:51], v0, s[12:15], s25 offen offset:1536 sc1
    v_mfma_f32_16x16x32_bf16 v[76:79], a[72:75], a[12:15], v[76:79]
    ds_read_b64_tr_b16 a[142:143], v9 offset:16288
    v_mfma_f32_16x16x32_bf16 v[80:83], a[76:79], a[0:3], v[80:83]
    ds_read_b64_tr_b16 a[144:145], v8 offset:14528
    v_mfma_f32_16x16x32_bf16 v[84:87], a[76:79], a[4:7], v[84:87]
    ds_read_b64_tr_b16 a[146:147], v8 offset:16320
    v_mfma_f32_16x16x32_bf16 v[88:91], a[76:79], a[8:11], v[88:91]
    ds_read_b64_tr_b16 a[148:149], v9 offset:14560
    v_mfma_f32_16x16x32_bf16 v[92:95], a[76:79], a[12:15], v[92:95]
    ds_read_b64_tr_b16 a[150:151], v9 offset:16352
    buffer_load_dwordx4 a[52:55], v0, s[12:15], s26 offen offset:1536 sc1
    v_mfma_f32_16x16x32_bf16 v[96:99], a[80:83], a[0:3], v[96:99]
    ds_read_b64_tr_b16 a[152:153], v8 offset:14592
    v_mfma_f32_16x16x32_bf16 v[100:103], a[80:83], a[4:7], v[100:103]
    ds_read_b64_tr_b16 a[154:155], v8 offset:16384
    v_mfma_f32_16x16x32_bf16 v[104:107], a[80:83], a[8:11], v[104:107]
    ds_read_b64_tr_b16 a[156:157], v9 offset:14624
    v_mfma_f32_16x16x32_bf16 v[108:111], a[80:83], a[12:15], v[108:111]
    ds_read_b64_tr_b16 a[158:159], v9 offset:16416
    v_mfma_f32_16x16x32_bf16 v[112:115], a[84:87], a[0:3], v[112:115]
    ds_read_b64_tr_b16 a[160:161], v8 offset:14656
    buffer_load_dwordx4 a[56:59], v0, s[12:15], s27 offen offset:1536 sc1
    v_mfma_f32_16x16x32_bf16 v[116:119], a[84:87], a[4:7], v[116:119]
    ds_read_b64_tr_b16 a[162:163], v8 offset:16448
    v_mfma_f32_16x16x32_bf16 v[120:123], a[84:87], a[8:11], v[120:123]
    ds_read_b64_tr_b16 a[164:165], v9 offset:14688
    v_mfma_f32_16x16x32_bf16 v[124:127], a[84:87], a[12:15], v[124:127]
    ds_read_b64_tr_b16 a[166:167], v9 offset:16480
    v_mfma_f32_16x16x32_bf16 v[128:131], a[88:91], a[0:3], v[128:131]
    ds_read_b64_tr_b16 a[168:169], v8 offset:14720
    v_mfma_f32_16x16x32_bf16 v[132:135], a[88:91], a[4:7], v[132:135]
    ds_read_b64_tr_b16 a[170:171], v8 offset:16512
    buffer_load_dwordx4 a[60:63], v0, s[12:15], s28 offen offset:1536 sc1
    v_mfma_f32_16x16x32_bf16 v[136:139], a[88:91], a[8:11], v[136:139]
    ds_read_b64_tr_b16 a[172:173], v9 offset:14752
    v_mfma_f32_16x16x32_bf16 v[140:143], a[88:91], a[12:15], v[140:143]
    ds_read_b64_tr_b16 a[174:175], v9 offset:16544
    v_mfma_f32_16x16x32_bf16 v[144:147], a[92:95], a[0:3], v[144:147]
    v_mfma_f32_16x16x32_bf16 v[148:151], a[92:95], a[4:7], v[148:151]
    v_mfma_f32_16x16x32_bf16 v[152:155], a[92:95], a[8:11], v[152:155]
    s_add_u32 s34, s38, 4096
    s_mov_b32 m0, s34
    s_nop 0
    buffer_load_dwordx4 v5, s[8:11], s24 offen offset:0 lds
    v_mfma_f32_16x16x32_bf16 v[156:159], a[92:95], a[12:15], v[156:159]
    v_mfma_f32_16x16x32_bf16 v[160:163], a[96:99], a[0:3], v[160:163]
    v_mfma_f32_16x16x32_bf16 v[164:167], a[96:99], a[4:7], v[164:167]
    v_mfma_f32_16x16x32_bf16 v[168:171], a[96:99], a[8:11], v[168:171]
    v_mfma_f32_16x16x32_bf16 v[172:175], a[96:99], a[12:15], v[172:175]
    buffer_load_dwordx4 v6, s[8:11], s24 offen offset:1024 lds
    v_mfma_f32_16x16x32_bf16 v[176:179], a[100:103], a[0:3], v[176:179]
    v_mfma_f32_16x16x32_bf16 v[180:183], a[100:103], a[4:7], v[180:183]
    v_mfma_f32_16x16x32_bf16 v[184:187], a[100:103], a[8:11], v[184:187]
    v_mfma_f32_16x16x32_bf16 v[188:191], a[100:103], a[12:15], v[188:191]
    v_mfma_f32_16x16x32_bf16 v[192:195], a[104:107], a[0:3], v[192:195]
    buffer_load_dwordx4 v7, s[8:11], s24 offen offset:2048 lds
    v_mfma_f32_16x16x32_bf16 v[196:199], a[104:107], a[4:7], v[196:199]
    v_mfma_f32_16x16x32_bf16 v[200:203], a[104:107], a[8:11], v[200:203]
    v_mfma_f32_16x16x32_bf16 v[204:207], a[104:107], a[12:15], v[204:207]
    v_mfma_f32_16x16x32_bf16 v[208:211], a[108:111], a[0:3], v[208:211]
    v_mfma_f32_16x16x32_bf16 v[212:215], a[108:111], a[4:7], v[212:215]
    v_mfma_f32_16x16x32_bf16 v[216:219], a[108:111], a[8:11], v[216:219]
    v_mfma_f32_16x16x32_bf16 v[220:223], a[108:111], a[12:15], v[220:223]
    v_mfma_f32_16x16x32_bf16 v[224:227], a[112:115], a[0:3], v[224:227]
    v_mfma_f32_16x16x32_bf16 v[228:231], a[112:115], a[4:7], v[228:231]
    v_mfma_f32_16x16x32_bf16 v[232:235], a[112:115], a[8:11], v[232:235]
    v_mfma_f32_16x16x32_bf16 v[236:239], a[112:115], a[12:15], v[236:239]
    v_mfma_f32_16x16x32_bf16 v[240:243], a[116:119], a[0:3], v[240:243]
    v_mfma_f32_16x16x32_bf16 v[244:247], a[116:119], a[4:7], v[244:247]
    v_mfma_f32_16x16x32_bf16 v[248:251], a[116:119], a[8:11], v[248:251]
    v_mfma_f32_16x16x32_bf16 v[252:255], a[116:119], a[12:15], v[252:255]
    s_waitcnt vmcnt(15) lgkmcnt(0)
    s_barrier
    v_mfma_f32_16x16x32_bf16 v[32:35], a[120:123], a[16:19], v[32:35]
    ds_read_b64_tr_b16 a[64:65], v8 offset:32768
    v_mfma_f32_16x16x32_bf16 v[36:39], a[120:123], a[20:23], v[36:39]
    ds_read_b64_tr_b16 a[66:67], v8 offset:34560
    v_mfma_f32_16x16x32_bf16 v[40:43], a[120:123], a[24:27], v[40:43]
    ds_read_b64_tr_b16 a[68:69], v9 offset:32800
    s_add_u32 s25, s25, 2048
    v_mfma_f32_16x16x32_bf16 v[44:47], a[120:123], a[28:31], v[44:47]
    ds_read_b64_tr_b16 a[70:71], v9 offset:34592
    s_add_u32 s26, s26, 2048
    v_mfma_f32_16x16x32_bf16 v[48:51], a[124:127], a[16:19], v[48:51]
    ds_read_b64_tr_b16 a[72:73], v8 offset:32832
    s_add_u32 s27, s27, 2048
    v_mfma_f32_16x16x32_bf16 v[52:55], a[124:127], a[20:23], v[52:55]
    ds_read_b64_tr_b16 a[74:75], v8 offset:34624
    s_add_u32 s28, s28, 2048
    v_mfma_f32_16x16x32_bf16 v[56:59], a[124:127], a[24:27], v[56:59]
    ds_read_b64_tr_b16 a[76:77], v9 offset:32864
    s_cmp_eq_u32 s29, 1
    v_mfma_f32_16x16x32_bf16 v[60:63], a[124:127], a[28:31], v[60:63]
    ds_read_b64_tr_b16 a[78:79], v9 offset:34656
    s_cselect_b32 s14, 0, s14
    v_mfma_f32_16x16x32_bf16 v[64:67], a[128:131], a[16:19], v[64:67]
    ds_read_b64_tr_b16 a[80:81], v8 offset:32896
    v_mfma_f32_16x16x32_bf16 v[68:71], a[128:131], a[20:23], v[68:71]
    ds_read_b64_tr_b16 a[82:83], v8 offset:34688
    v_mfma_f32_16x16x32_bf16 v[72:75], a[128:131], a[24:27], v[72:75]
    ds_read_b64_tr_b16 a[84:85], v9 offset:32928
    buffer_load_dwordx4 a[0:3], v0, s[12:15], s25 offen offset:0 sc1
    v_mfma_f32_16x16x32_bf16 v[76:79], a[128:131], a[28:31], v[76:79]
    ds_read_b64_tr_b16 a[86:87], v9 offset:34720
    v_mfma_f32_16x16x32_bf16 v[80:83], a[132:135], a[16:19], v[80:83]
    ds_read_b64_tr_b16 a[88:89], v8 offset:32960
    v_mfma_f32_16x16x32_bf16 v[84:87], a[132:135], a[20:23], v[84:87]
    ds_read_b64_tr_b16 a[90:91], v8 offset:34752
    v_mfma_f32_16x16x32_bf16 v[88:91], a[132:135], a[24:27], v[88:91]
    ds_read_b64_tr_b16 a[92:93], v9 offset:32992
    v_mfma_f32_16x16x32_bf16 v[92:95], a[132:135], a[28:31], v[92:95]
    ds_read_b64_tr_b16 a[94:95], v9 offset:34784
    buffer_load_dwordx4 a[4:7], v0, s[12:15], s26 offen offset:0 sc1
    v_mfma_f32_16x16x32_bf16 v[96:99], a[136:139], a[16:19], v[96:99]
    ds_read_b64_tr_b16 a[96:97], v8 offset:33024
    v_mfma_f32_16x16x32_bf16 v[100:103], a[136:139], a[20:23], v[100:103]
    ds_read_b64_tr_b16 a[98:99], v8 offset:34816
    v_mfma_f32_16x16x32_bf16 v[104:107], a[136:139], a[24:27], v[104:107]
    ds_read_b64_tr_b16 a[100:101], v9 offset:33056
    v_mfma_f32_16x16x32_bf16 v[108:111], a[136:139], a[28:31], v[108:111]
    ds_read_b64_tr_b16 a[102:103], v9 offset:34848
    v_mfma_f32_16x16x32_bf16 v[112:115], a[140:143], a[16:19], v[112:115]
    ds_read_b64_tr_b16 a[104:105], v8 offset:33088
    buffer_load_dwordx4 a[8:11], v0, s[12:15], s27 offen offset:0 sc1
    v_mfma_f32_16x16x32_bf16 v[116:119], a[140:143], a[20:23], v[116:119]
    ds_read_b64_tr_b16 a[106:107], v8 offset:34880
    v_mfma_f32_16x16x32_bf16 v[120:123], a[140:143], a[24:27], v[120:123]
    ds_read_b64_tr_b16 a[108:109], v9 offset:33120
    v_mfma_f32_16x16x32_bf16 v[124:127], a[140:143], a[28:31], v[124:127]
    ds_read_b64_tr_b16 a[110:111], v9 offset:34912
    v_mfma_f32_16x16x32_bf16 v[128:131], a[144:147], a[16:19], v[128:131]
    ds_read_b64_tr_b16 a[112:113], v8 offset:33152
    v_mfma_f32_16x16x32_bf16 v[132:135], a[144:147], a[20:23], v[132:135]
    ds_read_b64_tr_b16 a[114:115], v8 offset:34944
    buffer_load_dwordx4 a[12:15], v0, s[12:15], s28 offen offset:0 sc1
    v_mfma_f32_16x16x32_bf16 v[136:139], a[144:147], a[24:27], v[136:139]
    ds_read_b64_tr_b16 a[116:117], v9 offset:33184
    v_mfma_f32_16x16x32_bf16 v[140:143], a[144:147], a[28:31], v[140:143]
    ds_read_b64_tr_b16 a[118:119], v9 offset:34976
    v_mfma_f32_16x16x32_bf16 v[144:147], a[148:151], a[16:19], v[144:147]
    v_mfma_f32_16x16x32_bf16 v[148:151], a[148:151], a[20:23], v[148:151]
    v_mfma_f32_16x16x32_bf16 v[152:155], a[148:151], a[24:27], v[152:155]
    s_add_u32 s24, s24, s43
    s_add_u32 s38, s38, 32768
    s_and_b32 s38, s38, 131071
    s_mov_b32 m0, s38
    s_nop 0
    buffer_load_dwordx4 v1, s[8:11], s24 offen offset:0 lds
    v_mfma_f32_16x16x32_bf16 v[156:159], a[148:151], a[28:31], v[156:159]
    v_mfma_f32_16x16x32_bf16 v[160:163], a[152:155], a[16:19], v[160:163]
    v_mfma_f32_16x16x32_bf16 v[164:167], a[152:155], a[20:23], v[164:167]
    v_mfma_f32_16x16x32_bf16 v[168:171], a[152:155], a[24:27], v[168:171]
    v_mfma_f32_16x16x32_bf16 v[172:175], a[152:155], a[28:31], v[172:175]
    buffer_load_dwordx4 v2, s[8:11], s24 offen offset:1024 lds
    v_mfma_f32_16x16x32_bf16 v[176:179], a[156:159], a[16:19], v[176:179]
    v_mfma_f32_16x16x32_bf16 v[180:183], a[156:159], a[20:23], v[180:183]
    v_mfma_f32_16x16x32_bf16 v[184:187], a[156:159], a[24:27], v[184:187]
    v_mfma_f32_16x16x32_bf16 v[188:191], a[156:159], a[28:31], v[188:191]
    v_mfma_f32_16x16x32_bf16 v[192:195], a[160:163], a[16:19], v[192:195]
    buffer_load_dwordx4 v3, s[8:11], s24 offen offset:2048 lds
    v_mfma_f32_16x16x32_bf16 v[196:199], a[160:163], a[20:23], v[196:199]
    v_mfma_f32_16x16x32_bf16 v[200:203], a[160:163], a[24:27], v[200:203]
    v_mfma_f32_16x16x32_bf16 v[204:207], a[160:163], a[28:31], v[204:207]
    v_mfma_f32_16x16x32_bf16 v[208:211], a[164:167], a[16:19], v[208:211]
    v_mfma_f32_16x16x32_bf16 v[212:215], a[164:167], a[20:23], v[212:215]
    buffer_load_dwordx4 v4, s[8:11], s24 offen offset:3072 lds
    v_mfma_f32_16x16x32_bf16 v[216:219], a[164:167], a[24:27], v[216:219]
    v_mfma_f32_16x16x32_bf16 v[220:223], a[164:167], a[28:31], v[220:223]
    v_mfma_f32_16x16x32_bf16 v[224:227], a[168:171], a[16:19], v[224:227]
    v_mfma_f32_16x16x32_bf16 v[228:231], a[168:171], a[20:23], v[228:231]
    v_mfma_f32_16x16x32_bf16 v[232:235], a[168:171], a[24:27], v[232:235]
    v_mfma_f32_16x16x32_bf16 v[236:239], a[168:171], a[28:31], v[236:239]
    v_mfma_f32_16x16x32_bf16 v[240:243], a[172:175], a[16:19], v[240:243]
    v_mfma_f32_16x16x32_bf16 v[244:247], a[172:175], a[20:23], v[244:247]
    v_mfma_f32_16x16x32_bf16 v[248:251], a[172:175], a[24:27], v[248:251]
    v_mfma_f32_16x16x32_bf16 v[252:255], a[172:175], a[28:31], v[252:255]
    s_waitcnt vmcnt(19) lgkmcnt(0)
    v_mfma_f32_16x16x32_bf16 v[32:35], a[64:67], a[32:35], v[32:35]
    ds_read_b64_tr_b16 a[120:121], v8 offset:47104
    v_mfma_f32_16x16x32_bf16 v[36:39], a[64:67], a[36:39], v[36:39]
    ds_read_b64_tr_b16 a[122:123], v8 offset:48896
    v_mfma_f32_16x16x32_bf16 v[40:43], a[64:67], a[40:43], v[40:43]
    ds_read_b64_tr_b16 a[124:125], v9 offset:47136
    v_mfma_f32_16x16x32_bf16 v[44:47], a[64:67], a[44:47], v[44:47]
    ds_read_b64_tr_b16 a[126:127], v9 offset:48928
    v_mfma_f32_16x16x32_bf16 v[48:51], a[68:71], a[32:35], v[48:51]
    ds_read_b64_tr_b16 a[128:129], v8 offset:47168
    v_mfma_f32_16x16x32_bf16 v[52:55], a[68:71], a[36:39], v[52:55]
    ds_read_b64_tr_b16 a[130:131], v8 offset:48960
    v_mfma_f32_16x16x32_bf16 v[56:59], a[68:71], a[40:43], v[56:59]
    ds_read_b64_tr_b16 a[132:133], v9 offset:47200
    v_mfma_f32_16x16x32_bf16 v[60:63], a[68:71], a[44:47], v[60:63]
    ds_read_b64_tr_b16 a[134:135], v9 offset:48992
    v_mfma_f32_16x16x32_bf16 v[64:67], a[72:75], a[32:35], v[64:67]
    ds_read_b64_tr_b16 a[136:137], v8 offset:47232
    v_mfma_f32_16x16x32_bf16 v[68:71], a[72:75], a[36:39], v[68:71]
    ds_read_b64_tr_b16 a[138:139], v8 offset:49024
    v_mfma_f32_16x16x32_bf16 v[72:75], a[72:75], a[40:43], v[72:75]
    ds_read_b64_tr_b16 a[140:141], v9 offset:47264
    buffer_load_dwordx4 a[16:19], v0, s[12:15], s25 offen offset:512 sc1
    v_mfma_f32_16x16x32_bf16 v[76:79], a[72:75], a[44:47], v[76:79]
    ds_read_b64_tr_b16 a[142:143], v9 offset:49056
    v_mfma_f32_16x16x32_bf16 v[80:83], a[76:79], a[32:35], v[80:83]
    ds_read_b64_tr_b16 a[144:145], v8 offset:47296
    v_mfma_f32_16x16x32_bf16 v[84:87], a[76:79], a[36:39], v[84:87]
    ds_read_b64_tr_b16 a[146:147], v8 offset:49088
    v_mfma_f32_16x16x32_bf16 v[88:91], a[76:79], a[40:43], v[88:91]
    ds_read_b64_tr_b16 a[148:149], v9 offset:47328
    v_mfma_f32_16x16x32_bf16 v[92:95], a[76:79], a[44:47], v[92:95]
    ds_read_b64_tr_b16 a[150:151], v9 offset:49120
    buffer_load_dwordx4 a[20:23], v0, s[12:15], s26 offen offset:512 sc1
    v_mfma_f32_16x16x32_bf16 v[96:99], a[80:83], a[32:35], v[96:99]
    ds_read_b64_tr_b16 a[152:153], v8 offset:47360
    v_mfma_f32_16x16x32_bf16 v[100:103], a[80:83], a[36:39], v[100:103]
    ds_read_b64_tr_b16 a[154:155], v8 offset:49152
    v_mfma_f32_16x16x32_bf16 v[104:107], a[80:83], a[40:43], v[104:107]
    ds_read_b64_tr_b16 a[156:157], v9 offset:47392
    v_mfma_f32_16x16x32_bf16 v[108:111], a[80:83], a[44:47], v[108:111]
    ds_read_b64_tr_b16 a[158:159], v9 offset:49184
    v_mfma_f32_16x16x32_bf16 v[112:115], a[84:87], a[32:35], v[112:115]
    ds_read_b64_tr_b16 a[160:161], v8 offset:47424
    buffer_load_dwordx4 a[24:27], v0, s[12:15], s27 offen offset:512 sc1
    v_mfma_f32_16x16x32_bf16 v[116:119], a[84:87], a[36:39], v[116:119]
    ds_read_b64_tr_b16 a[162:163], v8 offset:49216
    v_mfma_f32_16x16x32_bf16 v[120:123], a[84:87], a[40:43], v[120:123]
    ds_read_b64_tr_b16 a[164:165], v9 offset:47456
    v_mfma_f32_16x16x32_bf16 v[124:127], a[84:87], a[44:47], v[124:127]
    ds_read_b64_tr_b16 a[166:167], v9 offset:49248
    v_mfma_f32_16x16x32_bf16 v[128:131], a[88:91], a[32:35], v[128:131]
    ds_read_b64_tr_b16 a[168:169], v8 offset:47488
    v_mfma_f32_16x16x32_bf16 v[132:135], a[88:91], a[36:39], v[132:135]
    ds_read_b64_tr_b16 a[170:171], v8 offset:49280
    buffer_load_dwordx4 a[28:31], v0, s[12:15], s28 offen offset:512 sc1
    v_mfma_f32_16x16x32_bf16 v[136:139], a[88:91], a[40:43], v[136:139]
    ds_read_b64_tr_b16 a[172:173], v9 offset:47520
    v_mfma_f32_16x16x32_bf16 v[140:143], a[88:91], a[44:47], v[140:143]
    ds_read_b64_tr_b16 a[174:175], v9 offset:49312
    v_mfma_f32_16x16x32_bf16 v[144:147], a[92:95], a[32:35], v[144:147]
    v_mfma_f32_16x16x32_bf16 v[148:151], a[92:95], a[36:39], v[148:151]
    v_mfma_f32_16x16x32_bf16 v[152:155], a[92:95], a[40:43], v[152:155]
    s_add_u32 s34, s38, 4096
    s_mov_b32 m0, s34
    s_nop 0
    buffer_load_dwordx4 v5, s[8:11], s24 offen offset:0 lds
    v_mfma_f32_16x16x32_bf16 v[156:159], a[92:95], a[44:47], v[156:159]
    v_mfma_f32_16x16x32_bf16 v[160:163], a[96:99], a[32:35], v[160:163]
    v_mfma_f32_16x16x32_bf16 v[164:167], a[96:99], a[36:39], v[164:167]
    v_mfma_f32_16x16x32_bf16 v[168:171], a[96:99], a[40:43], v[168:171]
    v_mfma_f32_16x16x32_bf16 v[172:175], a[96:99], a[44:47], v[172:175]
    buffer_load_dwordx4 v6, s[8:11], s24 offen offset:1024 lds
    v_mfma_f32_16x16x32_bf16 v[176:179], a[100:103], a[32:35], v[176:179]
    v_mfma_f32_16x16x32_bf16 v[180:183], a[100:103], a[36:39], v[180:183]
    v_mfma_f32_16x16x32_bf16 v[184:187], a[100:103], a[40:43], v[184:187]
    v_mfma_f32_16x16x32_bf16 v[188:191], a[100:103], a[44:47], v[188:191]
    v_mfma_f32_16x16x32_bf16 v[192:195], a[104:107], a[32:35], v[192:195]
    buffer_load_dwordx4 v7, s[8:11], s24 offen offset:2048 lds
    v_mfma_f32_16x16x32_bf16 v[196:199], a[104:107], a[36:39], v[196:199]
    v_mfma_f32_16x16x32_bf16 v[200:203], a[104:107], a[40:43], v[200:203]
    v_mfma_f32_16x16x32_bf16 v[204:207], a[104:107], a[44:47], v[204:207]
    v_mfma_f32_16x16x32_bf16 v[208:211], a[108:111], a[32:35], v[208:211]
    v_mfma_f32_16x16x32_bf16 v[212:215], a[108:111], a[36:39], v[212:215]
    v_mfma_f32_16x16x32_bf16 v[216:219], a[108:111], a[40:43], v[216:219]
    v_mfma_f32_16x16x32_bf16 v[220:223], a[108:111], a[44:47], v[220:223]
    v_mfma_f32_16x16x32_bf16 v[224:227], a[112:115], a[32:35], v[224:227]
    v_mfma_f32_16x16x32_bf16 v[228:231], a[112:115], a[36:39], v[228:231]
    v_mfma_f32_16x16x32_bf16 v[232:235], a[112:115], a[40:43], v[232:235]
    v_mfma_f32_16x16x32_bf16 v[236:239], a[112:115], a[44:47], v[236:239]
    v_mfma_f32_16x16x32_bf16 v[240:243], a[116:119], a[32:35], v[240:243]
    v_mfma_f32_16x16x32_bf16 v[244:247], a[116:119], a[36:39], v[244:247]
    v_mfma_f32_16x16x32_bf16 v[248:251], a[116:119], a[40:43], v[248:251]
    v_mfma_f32_16x16x32_bf16 v[252:255], a[116:119], a[44:47], v[252:255]
    s_waitcnt vmcnt(15) lgkmcnt(0)
    s_barrier
    v_mfma_f32_16x16x32_bf16 v[32:35], a[120:123], a[48:51], v[32:35]
    v_xor_b32 v8, 0x10000, v8
    v_mfma_f32_16x16x32_bf16 v[36:39], a[120:123], a[52:55], v[36:39]
    v_xor_b32 v9, 0x10000, v9
    v_mfma_f32_16x16x32_bf16 v[40:43], a[120:123], a[56:59], v[40:43]
    ds_read_b64_tr_b16 a[64:65], v8 offset:0
    v_mfma_f32_16x16x32_bf16 v[44:47], a[120:123], a[60:63], v[44:47]
    ds_read_b64_tr_b16 a[66:67], v8 offset:1792
    v_mfma_f32_16x16x32_bf16 v[48:51], a[124:127], a[48:51], v[48:51]
    ds_read_b64_tr_b16 a[68:69], v9 offset:32
    v_mfma_f32_16x16x32_bf16 v[52:55], a[124:127], a[52:55], v[52:55]
    ds_read_b64_tr_b16 a[70:71], v9 offset:1824
    v_mfma_f32_16x16x32_bf16 v[56:59], a[124:127], a[56:59], v[56:59]
    ds_read_b64_tr_b16 a[72:73], v8 offset:64
    v_mfma_f32_16x16x32_bf16 v[60:63], a[124:127], a[60:63], v[60:63]
    ds_read_b64_tr_b16 a[74:75], v8 offset:1856
    v_mfma_f32_16x16x32_bf16 v[64:67], a[128:131], a[48:51], v[64:67]
    ds_read_b64_tr_b16 a[76:77], v9 offset:96
    v_mfma_f32_16x16x32_bf16 v[68:71], a[128:131], a[52:55], v[68:71]
    ds_read_b64_tr_b16 a[78:79], v9 offset:1888
    v_mfma_f32_16x16x32_bf16 v[72:75], a[128:131], a[56:59], v[72:75]
    ds_read_b64_tr_b16 a[80:81], v8 offset:128
    buffer_load_dwordx4 a[32:35], v0, s[12:15], s25 offen offset:1024 sc1
    v_mfma_f32_16x16x32_bf16 v[76:79], a[128:131], a[60:63], v[76:79]
    ds_read_b64_tr_b16 a[82:83], v8 offset:1920
    v_mfma_f32_16x16x32_bf16 v[80:83], a[132:135], a[48:51], v[80:83]
    ds_read_b64_tr_b16 a[84:85], v9 offset:160
    v_mfma_f32_16x16x32_bf16 v[84:87], a[132:135], a[52:55], v[84:87]
    ds_read_b64_tr_b16 a[86:87], v9 offset:1952
    v_mfma_f32_16x16x32_bf16 v[88:91], a[132:135], a[56:59], v[88:91]
    ds_read_b64_tr_b16 a[88:89], v8 offset:192
    v_mfma_f32_16x16x32_bf16 v[92:95], a[132:135], a[60:63], v[92:95]
    ds_read_b64_tr_b16 a[90:91], v8 offset:1984
    buffer_load_dwordx4 a[36:39], v0, s[12:15], s26 offen offset:1024 sc1
    v_mfma_f32_16x16x32_bf16 v[96:99], a[136:139], a[48:51], v[96:99]
    ds_read_b64_tr_b16 a[92:93], v9 offset:224
    v_mfma_f32_16x16x32_bf16 v[100:103], a[136:139], a[52:55], v[100:103]
    ds_read_b64_tr_b16 a[94:95], v9 offset:2016
    v_mfma_f32_16x16x32_bf16 v[104:107], a[136:139], a[56:59], v[104:107]
    ds_read_b64_tr_b16 a[96:97], v8 offset:256
    v_mfma_f32_16x16x32_bf16 v[108:111], a[136:139], a[60:63], v[108:111]
    ds_read_b64_tr_b16 a[98:99], v8 offset:2048
    v_mfma_f32_16x16x32_bf16 v[112:115], a[140:143], a[48:51], v[112:115]
    ds_read_b64_tr_b16 a[100:101], v9 offset:288
    buffer_load_dwordx4 a[40:43], v0, s[12:15], s27 offen offset:1024 sc1
    v_mfma_f32_16x16x32_bf16 v[116:119], a[140:143], a[52:55], v[116:119]
    ds_read_b64_tr_b16 a[102:103], v9 offset:2080
    v_mfma_f32_16x16x32_bf16 v[120:123], a[140:143], a[56:59], v[120:123]
    ds_read_b64_tr_b16 a[104:105], v8 offset:320
    v_mfma_f32_16x16x32_bf16 v[124:127], a[140:143], a[60:63], v[124:127]
    ds_read_b64_tr_b16 a[106:107], v8 offset:2112
    v_mfma_f32_16x16x32_bf16 v[128:131], a[144:147], a[48:51], v[128:131]
    ds_read_b64_tr_b16 a[108:109], v9 offset:352
    v_mfma_f32_16x16x32_bf16 v[132:135], a[144:147], a[52:55], v[132:135]
    ds_read_b64_tr_b16 a[110:111], v9 offset:2144
    buffer_load_dwordx4 a[44:47], v0, s[12:15], s28 offen offset:1024 sc1
    v_mfma_f32_16x16x32_bf16 v[136:139], a[144:147], a[56:59], v[136:139]
    ds_read_b64_tr_b16 a[112:113], v8 offset:384
    v_mfma_f32_16x16x32_bf16 v[140:143], a[144:147], a[60:63], v[140:143]
    ds_read_b64_tr_b16 a[114:115], v8 offset:2176
    v_mfma_f32_16x16x32_bf16 v[144:147], a[148:151], a[48:51], v[144:147]
    ds_read_b64_tr_b16 a[116:117], v9 offset:416
    v_mfma_f32_16x16x32_bf16 v[148:151], a[148:151], a[52:55], v[148:151]
    ds_read_b64_tr_b16 a[118:119], v9 offset:2208
    v_mfma_f32_16x16x32_bf16 v[152:155], a[148:151], a[56:59], v[152:155]
    s_add_u32 s24, s24, s43
    s_add_u32 s38, s38, 32768
    s_and_b32 s38, s38, 131071
    s_mov_b32 m0, s38
    s_nop 0
    buffer_load_dwordx4 v1, s[8:11], s24 offen offset:0 lds
    v_mfma_f32_16x16x32_bf16 v[156:159], a[148:151], a[60:63], v[156:159]
    v_mfma_f32_16x16x32_bf16 v[160:163], a[152:155], a[48:51], v[160:163]
    v_mfma_f32_16x16x32_bf16 v[164:167], a[152:155], a[52:55], v[164:167]
    v_mfma_f32_16x16x32_bf16 v[168:171], a[152:155], a[56:59], v[168:171]
    v_mfma_f32_16x16x32_bf16 v[172:175], a[152:155], a[60:63], v[172:175]
    buffer_load_dwordx4 v2, s[8:11], s24 offen offset:1024 lds
    v_mfma_f32_16x16x32_bf16 v[176:179], a[156:159], a[48:51], v[176:179]
    v_mfma_f32_16x16x32_bf16 v[180:183], a[156:159], a[52:55], v[180:183]
    v_mfma_f32_16x16x32_bf16 v[184:187], a[156:159], a[56:59], v[184:187]
    v_mfma_f32_16x16x32_bf16 v[188:191], a[156:159], a[60:63], v[188:191]
    v_mfma_f32_16x16x32_bf16 v[192:195], a[160:163], a[48:51], v[192:195]
    buffer_load_dwordx4 v3, s[8:11], s24 offen offset:2048 lds
    v_mfma_f32_16x16x32_bf16 v[196:199], a[160:163], a[52:55], v[196:199]
    v_mfma_f32_16x16x32_bf16 v[200:203], a[160:163], a[56:59], v[200:203]
    v_mfma_f32_16x16x32_bf16 v[204:207], a[160:163], a[60:63], v[204:207]
    v_mfma_f32_16x16x32_bf16 v[208:211], a[164:167], a[48:51], v[208:211]
    v_mfma_f32_16x16x32_bf16 v[212:215], a[164:167], a[52:55], v[212:215]
    buffer_load_dwordx4 v4, s[8:11], s24 offen offset:3072 lds
    v_mfma_f32_16x16x32_bf16 v[216:219], a[164:167], a[56:59], v[216:219]
    v_mfma_f32_16x16x32_bf16 v[220:223], a[164:167], a[60:63], v[220:223]
    v_mfma_f32_16x16x32_bf16 v[224:227], a[168:171], a[48:51], v[224:227]
    v_mfma_f32_16x16x32_bf16 v[228:231], a[168:171], a[52:55], v[228:231]
    v_mfma_f32_16x16x32_bf16 v[232:235], a[168:171], a[56:59], v[232:235]
    v_mfma_f32_16x16x32_bf16 v[236:239], a[168:171], a[60:63], v[236:239]
    v_mfma_f32_16x16x32_bf16 v[240:243], a[172:175], a[48:51], v[240:243]
    v_mfma_f32_16x16x32_bf16 v[244:247], a[172:175], a[52:55], v[244:247]
    v_mfma_f32_16x16x32_bf16 v[248:251], a[172:175], a[56:59], v[248:251]
    v_mfma_f32_16x16x32_bf16 v[252:255], a[172:175], a[60:63], v[252:255]
    s_sub_u32 s29, s29, 1
    s_cmp_lg_u32 s29, 0
    s_cbranch_scc1 L_p1_h_loop
    s_waitcnt vmcnt(0)
    s_barrier
    v_and_b32 v3, 15, v17
    v_lshrrev_b32 v4, 4, v17
    v_lshrrev_b32 v7, 1, v4
    v_lshlrev_b32 v7, 10, v7
    v_and_b32 v8, 1, v4
    v_lshl_add_u32 v7, v8, 9, v7
    s_add_u32 s4, s40, 18874368
    s_addc_u32 s5, s41, 0
    s_mov_b32 s16, s4
    s_and_b32 s17, s5, 0xffff
    s_mov_b32 s18, 19152896
    s_mov_b32 s19, 0x00020000
    v_lshl_add_u32 v7, v3, 4, v7
    s_lshr_b32 s35, s39, 5
    s_mul_i32 s35, s35, 299264
    s_lshl_b32 s36, s32, 11
    s_add_u32 s35, s35, s36
    s_add_u32 s35, s35, 65536
    s_mov_b32 s44, 0xbfb8aa3b
    s_mov_b32 s45, s44
    s_mov_b32 s46, 1.0
    s_mov_b32 s47, 1.0
    v_pk_mul_f32 v[8:9], v[32:33], s[44:45]
    v_pk_mul_f32 v[10:11], v[34:35], s[44:45]
    v_pk_mul_f32 v[12:13], v[48:49], s[44:45]
    v_pk_mul_f32 v[14:15], v[50:51], s[44:45]
    v_exp_f32 v8, v8
    v_exp_f32 v9, v9
    v_exp_f32 v10, v10
    v_exp_f32 v11, v11
    v_exp_f32 v12, v12
    v_exp_f32 v13, v13
    v_exp_f32 v14, v14
    v_exp_f32 v15, v15
    v_pk_add_f32 v[8:9], v[8:9], s[46:47]
    v_pk_add_f32 v[10:11], v[10:11], s[46:47]
    v_pk_add_f32 v[12:13], v[12:13], s[46:47]
    v_pk_add_f32 v[14:15], v[14:15], s[46:47]
    v_rcp_f32 v8, v8
    v_rcp_f32 v9, v9
    v_rcp_f32 v10, v10
    v_rcp_f32 v11, v11
    v_rcp_f32 v12, v12
    v_rcp_f32 v13, v13
    v_rcp_f32 v14, v14
    v_rcp_f32 v15, v15
    s_add_u32 s36, s35, 0
    v_pk_mul_f32 v[32:33], v[32:33], v[8:9]
    v_pk_mul_f32 v[34:35], v[34:35], v[10:11]
    v_pk_mul_f32 v[48:49], v[48:49], v[12:13]
    v_pk_mul_f32 v[50:51], v[50:51], v[14:15]
    v_cvt_pk_bf16_f32 v32, v32, v33
    v_cvt_pk_bf16_f32 v33, v34, v35
    v_cvt_pk_bf16_f32 v34, v48, v49
    v_cvt_pk_bf16_f32 v35, v50, v51
    buffer_store_dwordx4 v[32:35], v7, s[16:19], s36 offen sc1
    v_pk_mul_f32 v[8:9], v[36:37], s[44:45]
    v_pk_mul_f32 v[10:11], v[38:39], s[44:45]
    v_pk_mul_f32 v[12:13], v[52:53], s[44:45]
    v_pk_mul_f32 v[14:15], v[54:55], s[44:45]
    v_exp_f32 v8, v8
    v_exp_f32 v9, v9
    v_exp_f32 v10, v10
    v_exp_f32 v11, v11
    v_exp_f32 v12, v12
    v_exp_f32 v13, v13
    v_exp_f32 v14, v14
    v_exp_f32 v15, v15
    v_pk_add_f32 v[8:9], v[8:9], s[46:47]
    v_pk_add_f32 v[10:11], v[10:11], s[46:47]
    v_pk_add_f32 v[12:13], v[12:13], s[46:47]
    v_pk_add_f32 v[14:15], v[14:15], s[46:47]
    v_rcp_f32 v8, v8
    v_rcp_f32 v9, v9
    v_rcp_f32 v10, v10
    v_rcp_f32 v11, v11
    v_rcp_f32 v12, v12
    v_rcp_f32 v13, v13
    v_rcp_f32 v14, v14
    v_rcp_f32 v15, v15
    s_add_u32 s36, s35, 256
    v_pk_mul_f32 v[36:37], v[36:37], v[8:9]
    v_pk_mul_f32 v[38:39], v[38:39], v[10:11]
    v_pk_mul_f32 v[52:53], v[52:53], v[12:13]
    v_pk_mul_f32 v[54:55], v[54:55], v[14:15]
    v_cvt_pk_bf16_f32 v36, v36, v37
    v_cvt_pk_bf16_f32 v37, v38, v39
    v_cvt_pk_bf16_f32 v38, v52, v53
    v_cvt_pk_bf16_f32 v39, v54, v55
    buffer_store_dwordx4 v[36:39], v7, s[16:19], s36 offen sc1
    v_pk_mul_f32 v[8:9], v[40:41], s[44:45]
    v_pk_mul_f32 v[10:11], v[42:43], s[44:45]
    v_pk_mul_f32 v[12:13], v[56:57], s[44:45]
    v_pk_mul_f32 v[14:15], v[58:59], s[44:45]
    v_exp_f32 v8, v8
    v_exp_f32 v9, v9
    v_exp_f32 v10, v10
    v_exp_f32 v11, v11
    v_exp_f32 v12, v12
    v_exp_f32 v13, v13
    v_exp_f32 v14, v14
    v_exp_f32 v15, v15
    v_pk_add_f32 v[8:9], v[8:9], s[46:47]
    v_pk_add_f32 v[10:11], v[10:11], s[46:47]
    v_pk_add_f32 v[12:13], v[12:13], s[46:47]
    v_pk_add_f32 v[14:15], v[14:15], s[46:47]
    v_rcp_f32 v8, v8
    v_rcp_f32 v9, v9
    v_rcp_f32 v10, v10
    v_rcp_f32 v11, v11
    v_rcp_f32 v12, v12
    v_rcp_f32 v13, v13
    v_rcp_f32 v14, v14
    v_rcp_f32 v15, v15
    s_add_u32 s36, s35, 299264
    v_pk_mul_f32 v[40:41], v[40:41], v[8:9]
    v_pk_mul_f32 v[42:43], v[42:43], v[10:11]
    v_pk_mul_f32 v[56:57], v[56:57], v[12:13]
    v_pk_mul_f32 v[58:59], v[58:59], v[14:15]
    v_cvt_pk_bf16_f32 v40, v40, v41
    v_cvt_pk_bf16_f32 v41, v42, v43
    v_cvt_pk_bf16_f32 v42, v56, v57
    v_cvt_pk_bf16_f32 v43, v58, v59
    buffer_store_dwordx4 v[40:43], v7, s[16:19], s36 offen sc1
    v_pk_mul_f32 v[8:9], v[44:45], s[44:45]
    v_pk_mul_f32 v[10:11], v[46:47], s[44:45]
    v_pk_mul_f32 v[12:13], v[60:61], s[44:45]
    v_pk_mul_f32 v[14:15], v[62:63], s[44:45]
    v_exp_f32 v8, v8
    v_exp_f32 v9, v9
    v_exp_f32 v10, v10
    v_exp_f32 v11, v11
    v_exp_f32 v12, v12
    v_exp_f32 v13, v13
    v_exp_f32 v14, v14
    v_exp_f32 v15, v15
    v_pk_add_f32 v[8:9], v[8:9], s[46:47]
    v_pk_add_f32 v[10:11], v[10:11], s[46:47]
    v_pk_add_f32 v[12:13], v[12:13], s[46:47]
    v_pk_add_f32 v[14:15], v[14:15], s[46:47]
    v_rcp_f32 v8, v8
    v_rcp_f32 v9, v9
    v_rcp_f32 v10, v10
    v_rcp_f32 v11, v11
    v_rcp_f32 v12, v12
    v_rcp_f32 v13, v13
    v_rcp_f32 v14, v14
    v_rcp_f32 v15, v15
    s_add_u32 s36, s35, 299520
    v_pk_mul_f32 v[44:45], v[44:45], v[8:9]
    v_pk_mul_f32 v[46:47], v[46:47], v[10:11]
    v_pk_mul_f32 v[60:61], v[60:61], v[12:13]
    v_pk_mul_f32 v[62:63], v[62:63], v[14:15]
    v_cvt_pk_bf16_f32 v44, v44, v45
    v_cvt_pk_bf16_f32 v45, v46, v47
    v_cvt_pk_bf16_f32 v46, v60, v61
    v_cvt_pk_bf16_f32 v47, v62, v63
    buffer_store_dwordx4 v[44:47], v7, s[16:19], s36 offen sc1
    v_pk_mul_f32 v[8:9], v[64:65], s[44:45]
    v_pk_mul_f32 v[10:11], v[66:67], s[44:45]
    v_pk_mul_f32 v[12:13], v[80:81], s[44:45]
    v_pk_mul_f32 v[14:15], v[82:83], s[44:45]
    v_exp_f32 v8, v8
    v_exp_f32 v9, v9
    v_exp_f32 v10, v10
    v_exp_f32 v11, v11
    v_exp_f32 v12, v12
    v_exp_f32 v13, v13
    v_exp_f32 v14, v14
    v_exp_f32 v15, v15
    v_pk_add_f32 v[8:9], v[8:9], s[46:47]
    v_pk_add_f32 v[10:11], v[10:11], s[46:47]
    v_pk_add_f32 v[12:13], v[12:13], s[46:47]
    v_pk_add_f32 v[14:15], v[14:15], s[46:47]
    v_rcp_f32 v8, v8
    v_rcp_f32 v9, v9
    v_rcp_f32 v10, v10
    v_rcp_f32 v11, v11
    v_rcp_f32 v12, v12
    v_rcp_f32 v13, v13
    v_rcp_f32 v14, v14
    v_rcp_f32 v15, v15
    s_add_u32 s36, s35, 2048
    v_pk_mul_f32 v[64:65], v[64:65], v[8:9]
    v_pk_mul_f32 v[66:67], v[66:67], v[10:11]
    v_pk_mul_f32 v[80:81], v[80:81], v[12:13]
    v_pk_mul_f32 v[82:83], v[82:83], v[14:15]
    v_cvt_pk_bf16_f32 v64, v64, v65
    v_cvt_pk_bf16_f32 v65, v66, v67
    v_cvt_pk_bf16_f32 v66, v80, v81
    v_cvt_pk_bf16_f32 v67, v82, v83
    buffer_store_dwordx4 v[64:67], v7, s[16:19], s36 offen sc1
    v_pk_mul_f32 v[8:9], v[68:69], s[44:45]
    v_pk_mul_f32 v[10:11], v[70:71], s[44:45]
    v_pk_mul_f32 v[12:13], v[84:85], s[44:45]
    v_pk_mul_f32 v[14:15], v[86:87], s[44:45]
    v_exp_f32 v8, v8
    v_exp_f32 v9, v9
    v_exp_f32 v10, v10
    v_exp_f32 v11, v11
    v_exp_f32 v12, v12
    v_exp_f32 v13, v13
    v_exp_f32 v14, v14
    v_exp_f32 v15, v15
    v_pk_add_f32 v[8:9], v[8:9], s[46:47]
    v_pk_add_f32 v[10:11], v[10:11], s[46:47]
    v_pk_add_f32 v[12:13], v[12:13], s[46:47]
    v_pk_add_f32 v[14:15], v[14:15], s[46:47]
    v_rcp_f32 v8, v8
    v_rcp_f32 v9, v9
    v_rcp_f32 v10, v10
    v_rcp_f32 v11, v11
    v_rcp_f32 v12, v12
    v_rcp_f32 v13, v13
    v_rcp_f32 v14, v14
    v_rcp_f32 v15, v15
    s_add_u32 s36, s35, 2304
    v_pk_mul_f32 v[68:69], v[68:69], v[8:9]
    v_pk_mul_f32 v[70:71], v[70:71], v[10:11]
    v_pk_mul_f32 v[84:85], v[84:85], v[12:13]
    v_pk_mul_f32 v[86:87], v[86:87], v[14:15]
    v_cvt_pk_bf16_f32 v68, v68, v69
    v_cvt_pk_bf16_f32 v69, v70, v71
    v_cvt_pk_bf16_f32 v70, v84, v85
    v_cvt_pk_bf16_f32 v71, v86, v87
    buffer_store_dwordx4 v[68:71], v7, s[16:19], s36 offen sc1
    v_pk_mul_f32 v[8:9], v[72:73], s[44:45]
    v_pk_mul_f32 v[10:11], v[74:75], s[44:45]
    v_pk_mul_f32 v[12:13], v[88:89], s[44:45]
    v_pk_mul_f32 v[14:15], v[90:91], s[44:45]
    v_exp_f32 v8, v8
    v_exp_f32 v9, v9
    v_exp_f32 v10, v10
    v_exp_f32 v11, v11
    v_exp_f32 v12, v12
    v_exp_f32 v13, v13
    v_exp_f32 v14, v14
    v_exp_f32 v15, v15
    v_pk_add_f32 v[8:9], v[8:9], s[46:47]
    v_pk_add_f32 v[10:11], v[10:11], s[46:47]
    v_pk_add_f32 v[12:13], v[12:13], s[46:47]
    v_pk_add_f32 v[14:15], v[14:15], s[46:47]
    v_rcp_f32 v8, v8
    v_rcp_f32 v9, v9
    v_rcp_f32 v10, v10
    v_rcp_f32 v11, v11
    v_rcp_f32 v12, v12
    v_rcp_f32 v13, v13
    v_rcp_f32 v14, v14
    v_rcp_f32 v15, v15
    s_add_u32 s36, s35, 301312
    v_pk_mul_f32 v[72:73], v[72:73], v[8:9]
    v_pk_mul_f32 v[74:75], v[74:75], v[10:11]
    v_pk_mul_f32 v[88:89], v[88:89], v[12:13]
    v_pk_mul_f32 v[90:91], v[90:91], v[14:15]
    v_cvt_pk_bf16_f32 v72, v72, v73
    v_cvt_pk_bf16_f32 v73, v74, v75
    v_cvt_pk_bf16_f32 v74, v88, v89
    v_cvt_pk_bf16_f32 v75, v90, v91
    buffer_store_dwordx4 v[72:75], v7, s[16:19], s36 offen sc1
    v_pk_mul_f32 v[8:9], v[76:77], s[44:45]
    v_pk_mul_f32 v[10:11], v[78:79], s[44:45]
    v_pk_mul_f32 v[12:13], v[92:93], s[44:45]
    v_pk_mul_f32 v[14:15], v[94:95], s[44:45]
    v_exp_f32 v8, v8
    v_exp_f32 v9, v9
    v_exp_f32 v10, v10
    v_exp_f32 v11, v11
    v_exp_f32 v12, v12
    v_exp_f32 v13, v13
    v_exp_f32 v14, v14
    v_exp_f32 v15, v15
    v_pk_add_f32 v[8:9], v[8:9], s[46:47]
    v_pk_add_f32 v[10:11], v[10:11], s[46:47]
    v_pk_add_f32 v[12:13], v[12:13], s[46:47]
    v_pk_add_f32 v[14:15], v[14:15], s[46:47]
    v_rcp_f32 v8, v8
    v_rcp_f32 v9, v9
    v_rcp_f32 v10, v10
    v_rcp_f32 v11, v11
    v_rcp_f32 v12, v12
    v_rcp_f32 v13, v13
    v_rcp_f32 v14, v14
    v_rcp_f32 v15, v15
    s_add_u32 s36, s35, 301568
    v_pk_mul_f32 v[76:77], v[76:77], v[8:9]
    v_pk_mul_f32 v[78:79], v[78:79], v[10:11]
    v_pk_mul_f32 v[92:93], v[92:93], v[12:13]
    v_pk_mul_f32 v[94:95], v[94:95], v[14:15]
    v_cvt_pk_bf16_f32 v76, v76, v77
    v_cvt_pk_bf16_f32 v77, v78, v79
    v_cvt_pk_bf16_f32 v78, v92, v93
    v_cvt_pk_bf16_f32 v79, v94, v95
    buffer_store_dwordx4 v[76:79], v7, s[16:19], s36 offen sc1
    v_pk_mul_f32 v[8:9], v[96:97], s[44:45]
    v_pk_mul_f32 v[10:11], v[98:99], s[44:45]
    v_pk_mul_f32 v[12:13], v[112:113], s[44:45]
    v_pk_mul_f32 v[14:15], v[114:115], s[44:45]
    v_exp_f32 v8, v8
    v_exp_f32 v9, v9
    v_exp_f32 v10, v10
    v_exp_f32 v11, v11
    v_exp_f32 v12, v12
    v_exp_f32 v13, v13
    v_exp_f32 v14, v14
    v_exp_f32 v15, v15
    v_pk_add_f32 v[8:9], v[8:9], s[46:47]
    v_pk_add_f32 v[10:11], v[10:11], s[46:47]
    v_pk_add_f32 v[12:13], v[12:13], s[46:47]
    v_pk_add_f32 v[14:15], v[14:15], s[46:47]
    v_rcp_f32 v8, v8
    v_rcp_f32 v9, v9
    v_rcp_f32 v10, v10
    v_rcp_f32 v11, v11
    v_rcp_f32 v12, v12
    v_rcp_f32 v13, v13
    v_rcp_f32 v14, v14
    v_rcp_f32 v15, v15
    s_add_u32 s36, s35, 4096
    v_pk_mul_f32 v[96:97], v[96:97], v[8:9]
    v_pk_mul_f32 v[98:99], v[98:99], v[10:11]
    v_pk_mul_f32 v[112:113], v[112:113], v[12:13]
    v_pk_mul_f32 v[114:115], v[114:115], v[14:15]
    v_cvt_pk_bf16_f32 v96, v96, v97
    v_cvt_pk_bf16_f32 v97, v98, v99
    v_cvt_pk_bf16_f32 v98, v112, v113
    v_cvt_pk_bf16_f32 v99, v114, v115
    buffer_store_dwordx4 v[96:99], v7, s[16:19], s36 offen sc1
    v_pk_mul_f32 v[8:9], v[100:101], s[44:45]
    v_pk_mul_f32 v[10:11], v[102:103], s[44:45]
    v_pk_mul_f32 v[12:13], v[116:117], s[44:45]
    v_pk_mul_f32 v[14:15], v[118:119], s[44:45]
    v_exp_f32 v8, v8
    v_exp_f32 v9, v9
    v_exp_f32 v10, v10
    v_exp_f32 v11, v11
    v_exp_f32 v12, v12
    v_exp_f32 v13, v13
    v_exp_f32 v14, v14
    v_exp_f32 v15, v15
    v_pk_add_f32 v[8:9], v[8:9], s[46:47]
    v_pk_add_f32 v[10:11], v[10:11], s[46:47]
    v_pk_add_f32 v[12:13], v[12:13], s[46:47]
    v_pk_add_f32 v[14:15], v[14:15], s[46:47]
    v_rcp_f32 v8, v8
    v_rcp_f32 v9, v9
    v_rcp_f32 v10, v10
    v_rcp_f32 v11, v11
    v_rcp_f32 v12, v12
    v_rcp_f32 v13, v13
    v_rcp_f32 v14, v14
    v_rcp_f32 v15, v15
    s_add_u32 s36, s35, 4352
    v_pk_mul_f32 v[100:101], v[100:101], v[8:9]
    v_pk_mul_f32 v[102:103], v[102:103], v[10:11]
    v_pk_mul_f32 v[116:117], v[116:117], v[12:13]
    v_pk_mul_f32 v[118:119], v[118:119], v[14:15]
    v_cvt_pk_bf16_f32 v100, v100, v101
    v_cvt_pk_bf16_f32 v101, v102, v103
    v_cvt_pk_bf16_f32 v102, v116, v117
    v_cvt_pk_bf16_f32 v103, v118, v119
    buffer_store_dwordx4 v[100:103], v7, s[16:19], s36 offen sc1
    v_pk_mul_f32 v[8:9], v[104:105], s[44:45]
    v_pk_mul_f32 v[10:11], v[106:107], s[44:45]
    v_pk_mul_f32 v[12:13], v[120:121], s[44:45]
    v_pk_mul_f32 v[14:15], v[122:123], s[44:45]
    v_exp_f32 v8, v8
    v_exp_f32 v9, v9
    v_exp_f32 v10, v10
    v_exp_f32 v11, v11
    v_exp_f32 v12, v12
    v_exp_f32 v13, v13
    v_exp_f32 v14, v14
    v_exp_f32 v15, v15
    v_pk_add_f32 v[8:9], v[8:9], s[46:47]
    v_pk_add_f32 v[10:11], v[10:11], s[46:47]
    v_pk_add_f32 v[12:13], v[12:13], s[46:47]
    v_pk_add_f32 v[14:15], v[14:15], s[46:47]
    v_rcp_f32 v8, v8
    v_rcp_f32 v9, v9
    v_rcp_f32 v10, v10
    v_rcp_f32 v11, v11
    v_rcp_f32 v12, v12
    v_rcp_f32 v13, v13
    v_rcp_f32 v14, v14
    v_rcp_f32 v15, v15
    s_add_u32 s36, s35, 303360
    v_pk_mul_f32 v[104:105], v[104:105], v[8:9]
    v_pk_mul_f32 v[106:107], v[106:107], v[10:11]
    v_pk_mul_f32 v[120:121], v[120:121], v[12:13]
    v_pk_mul_f32 v[122:123], v[122:123], v[14:15]
    v_cvt_pk_bf16_f32 v104, v104, v105
    v_cvt_pk_bf16_f32 v105, v106, v107
    v_cvt_pk_bf16_f32 v106, v120, v121
    v_cvt_pk_bf16_f32 v107, v122, v123
    buffer_store_dwordx4 v[104:107], v7, s[16:19], s36 offen sc1
    v_pk_mul_f32 v[8:9], v[108:109], s[44:45]
    v_pk_mul_f32 v[10:11], v[110:111], s[44:45]
    v_pk_mul_f32 v[12:13], v[124:125], s[44:45]
    v_pk_mul_f32 v[14:15], v[126:127], s[44:45]
    v_exp_f32 v8, v8
    v_exp_f32 v9, v9
    v_exp_f32 v10, v10
    v_exp_f32 v11, v11
    v_exp_f32 v12, v12
    v_exp_f32 v13, v13
    v_exp_f32 v14, v14
    v_exp_f32 v15, v15
    v_pk_add_f32 v[8:9], v[8:9], s[46:47]
    v_pk_add_f32 v[10:11], v[10:11], s[46:47]
    v_pk_add_f32 v[12:13], v[12:13], s[46:47]
    v_pk_add_f32 v[14:15], v[14:15], s[46:47]
    v_rcp_f32 v8, v8
    v_rcp_f32 v9, v9
    v_rcp_f32 v10, v10
    v_rcp_f32 v11, v11
    v_rcp_f32 v12, v12
    v_rcp_f32 v13, v13
    v_rcp_f32 v14, v14
    v_rcp_f32 v15, v15
    s_add_u32 s36, s35, 303616
    v_pk_mul_f32 v[108:109], v[108:109], v[8:9]
    v_pk_mul_f32 v[110:111], v[110:111], v[10:11]
    v_pk_mul_f32 v[124:125], v[124:125], v[12:13]
    v_pk_mul_f32 v[126:127], v[126:127], v[14:15]
    v_cvt_pk_bf16_f32 v108, v108, v109
    v_cvt_pk_bf16_f32 v109, v110, v111
    v_cvt_pk_bf16_f32 v110, v124, v125
    v_cvt_pk_bf16_f32 v111, v126, v127
    buffer_store_dwordx4 v[108:111], v7, s[16:19], s36 offen sc1
    v_pk_mul_f32 v[8:9], v[128:129], s[44:45]
    v_pk_mul_f32 v[10:11], v[130:131], s[44:45]
    v_pk_mul_f32 v[12:13], v[144:145], s[44:45]
    v_pk_mul_f32 v[14:15], v[146:147], s[44:45]
    v_exp_f32 v8, v8
    v_exp_f32 v9, v9
    v_exp_f32 v10, v10
    v_exp_f32 v11, v11
    v_exp_f32 v12, v12
    v_exp_f32 v13, v13
    v_exp_f32 v14, v14
    v_exp_f32 v15, v15
    v_pk_add_f32 v[8:9], v[8:9], s[46:47]
    v_pk_add_f32 v[10:11], v[10:11], s[46:47]
    v_pk_add_f32 v[12:13], v[12:13], s[46:47]
    v_pk_add_f32 v[14:15], v[14:15], s[46:47]
    v_rcp_f32 v8, v8
    v_rcp_f32 v9, v9
    v_rcp_f32 v10, v10
    v_rcp_f32 v11, v11
    v_rcp_f32 v12, v12
    v_rcp_f32 v13, v13
    v_rcp_f32 v14, v14
    v_rcp_f32 v15, v15
    s_add_u32 s36, s35, 6144
    v_pk_mul_f32 v[128:129], v[128:129], v[8:9]
    v_pk_mul_f32 v[130:131], v[130:131], v[10:11]
    v_pk_mul_f32 v[144:145], v[144:145], v[12:13]
    v_pk_mul_f32 v[146:147], v[146:147], v[14:15]
    v_cvt_pk_bf16_f32 v128, v128, v129
    v_cvt_pk_bf16_f32 v129, v130, v131
    v_cvt_pk_bf16_f32 v130, v144, v145
    v_cvt_pk_bf16_f32 v131, v146, v147
    buffer_store_dwordx4 v[128:131], v7, s[16:19], s36 offen sc1
    v_pk_mul_f32 v[8:9], v[132:133], s[44:45]
    v_pk_mul_f32 v[10:11], v[134:135], s[44:45]
    v_pk_mul_f32 v[12:13], v[148:149], s[44:45]
    v_pk_mul_f32 v[14:15], v[150:151], s[44:45]
    v_exp_f32 v8, v8
    v_exp_f32 v9, v9
    v_exp_f32 v10, v10
    v_exp_f32 v11, v11
    v_exp_f32 v12, v12
    v_exp_f32 v13, v13
    v_exp_f32 v14, v14
    v_exp_f32 v15, v15
    v_pk_add_f32 v[8:9], v[8:9], s[46:47]
    v_pk_add_f32 v[10:11], v[10:11], s[46:47]
    v_pk_add_f32 v[12:13], v[12:13], s[46:47]
    v_pk_add_f32 v[14:15], v[14:15], s[46:47]
    v_rcp_f32 v8, v8
    v_rcp_f32 v9, v9
    v_rcp_f32 v10, v10
    v_rcp_f32 v11, v11
    v_rcp_f32 v12, v12
    v_rcp_f32 v13, v13
    v_rcp_f32 v14, v14
    v_rcp_f32 v15, v15
    s_add_u32 s36, s35, 6400
    v_pk_mul_f32 v[132:133], v[132:133], v[8:9]
    v_pk_mul_f32 v[134:135], v[134:135], v[10:11]
    v_pk_mul_f32 v[148:149], v[148:149], v[12:13]
    v_pk_mul_f32 v[150:151], v[150:151], v[14:15]
    v_cvt_pk_bf16_f32 v132, v132, v133
    v_cvt_pk_bf16_f32 v133, v134, v135
    v_cvt_pk_bf16_f32 v134, v148, v149
    v_cvt_pk_bf16_f32 v135, v150, v151
    buffer_store_dwordx4 v[132:135], v7, s[16:19], s36 offen sc1
    v_pk_mul_f32 v[8:9], v[136:137], s[44:45]
    v_pk_mul_f32 v[10:11], v[138:139], s[44:45]
    v_pk_mul_f32 v[12:13], v[152:153], s[44:45]
    v_pk_mul_f32 v[14:15], v[154:155], s[44:45]
    v_exp_f32 v8, v8
    v_exp_f32 v9, v9
    v_exp_f32 v10, v10
    v_exp_f32 v11, v11
    v_exp_f32 v12, v12
    v_exp_f32 v13, v13
    v_exp_f32 v14, v14
    v_exp_f32 v15, v15
    v_pk_add_f32 v[8:9], v[8:9], s[46:47]
    v_pk_add_f32 v[10:11], v[10:11], s[46:47]
    v_pk_add_f32 v[12:13], v[12:13], s[46:47]
    v_pk_add_f32 v[14:15], v[14:15], s[46:47]
    v_rcp_f32 v8, v8
    v_rcp_f32 v9, v9
    v_rcp_f32 v10, v10
    v_rcp_f32 v11, v11
    v_rcp_f32 v12, v12
    v_rcp_f32 v13, v13
    v_rcp_f32 v14, v14
    v_rcp_f32 v15, v15
    s_add_u32 s36, s35, 305408
    v_pk_mul_f32 v[136:137], v[136:137], v[8:9]
    v_pk_mul_f32 v[138:139], v[138:139], v[10:11]
    v_pk_mul_f32 v[152:153], v[152:153], v[12:13]
    v_pk_mul_f32 v[154:155], v[154:155], v[14:15]
    v_cvt_pk_bf16_f32 v136, v136, v137
    v_cvt_pk_bf16_f32 v137, v138, v139
    v_cvt_pk_bf16_f32 v138, v152, v153
    v_cvt_pk_bf16_f32 v139, v154, v155
    buffer_store_dwordx4 v[136:139], v7, s[16:19], s36 offen sc1
    v_pk_mul_f32 v[8:9], v[140:141], s[44:45]
    v_pk_mul_f32 v[10:11], v[142:143], s[44:45]
    v_pk_mul_f32 v[12:13], v[156:157], s[44:45]
    v_pk_mul_f32 v[14:15], v[158:159], s[44:45]
    v_exp_f32 v8, v8
    v_exp_f32 v9, v9
    v_exp_f32 v10, v10
    v_exp_f32 v11, v11
    v_exp_f32 v12, v12
    v_exp_f32 v13, v13
    v_exp_f32 v14, v14
    v_exp_f32 v15, v15
    v_pk_add_f32 v[8:9], v[8:9], s[46:47]
    v_pk_add_f32 v[10:11], v[10:11], s[46:47]
    v_pk_add_f32 v[12:13], v[12:13], s[46:47]
    v_pk_add_f32 v[14:15], v[14:15], s[46:47]
    v_rcp_f32 v8, v8
    v_rcp_f32 v9, v9
    v_rcp_f32 v10, v10
    v_rcp_f32 v11, v11
    v_rcp_f32 v12, v12
    v_rcp_f32 v13, v13
    v_rcp_f32 v14, v14
    v_rcp_f32 v15, v15
    s_add_u32 s36, s35, 305664
    v_pk_mul_f32 v[140:141], v[140:141], v[8:9]
    v_pk_mul_f32 v[142:143], v[142:143], v[10:11]
    v_pk_mul_f32 v[156:157], v[156:157], v[12:13]
    v_pk_mul_f32 v[158:159], v[158:159], v[14:15]
    v_cvt_pk_bf16_f32 v140, v140, v141
    v_cvt_pk_bf16_f32 v141, v142, v143
    v_cvt_pk_bf16_f32 v142, v156, v157
    v_cvt_pk_bf16_f32 v143, v158, v159
    buffer_store_dwordx4 v[140:143], v7, s[16:19], s36 offen sc1
    v_pk_mul_f32 v[8:9], v[160:161], s[44:45]
    v_pk_mul_f32 v[10:11], v[162:163], s[44:45]
    v_pk_mul_f32 v[12:13], v[176:177], s[44:45]
    v_pk_mul_f32 v[14:15], v[178:179], s[44:45]
    v_exp_f32 v8, v8
    v_exp_f32 v9, v9
    v_exp_f32 v10, v10
    v_exp_f32 v11, v11
    v_exp_f32 v12, v12
    v_exp_f32 v13, v13
    v_exp_f32 v14, v14
    v_exp_f32 v15, v15
    v_pk_add_f32 v[8:9], v[8:9], s[46:47]
    v_pk_add_f32 v[10:11], v[10:11], s[46:47]
    v_pk_add_f32 v[12:13], v[12:13], s[46:47]
    v_pk_add_f32 v[14:15], v[14:15], s[46:47]
    v_rcp_f32 v8, v8
    v_rcp_f32 v9, v9
    v_rcp_f32 v10, v10
    v_rcp_f32 v11, v11
    v_rcp_f32 v12, v12
    v_rcp_f32 v13, v13
    v_rcp_f32 v14, v14
    v_rcp_f32 v15, v15
    s_add_u32 s36, s35, 8192
    v_pk_mul_f32 v[160:161], v[160:161], v[8:9]
    v_pk_mul_f32 v[162:163], v[162:163], v[10:11]
    v_pk_mul_f32 v[176:177], v[176:177], v[12:13]
    v_pk_mul_f32 v[178:179], v[178:179], v[14:15]
    v_cvt_pk_bf16_f32 v160, v160, v161
    v_cvt_pk_bf16_f32 v161, v162, v163
    v_cvt_pk_bf16_f32 v162, v176, v177
    v_cvt_pk_bf16_f32 v163, v178, v179
    buffer_store_dwordx4 v[160:163], v7, s[16:19], s36 offen sc1
    v_pk_mul_f32 v[8:9], v[164:165], s[44:45]
    v_pk_mul_f32 v[10:11], v[166:167], s[44:45]
    v_pk_mul_f32 v[12:13], v[180:181], s[44:45]
    v_pk_mul_f32 v[14:15], v[182:183], s[44:45]
    v_exp_f32 v8, v8
    v_exp_f32 v9, v9
    v_exp_f32 v10, v10
    v_exp_f32 v11, v11
    v_exp_f32 v12, v12
    v_exp_f32 v13, v13
    v_exp_f32 v14, v14
    v_exp_f32 v15, v15
    v_pk_add_f32 v[8:9], v[8:9], s[46:47]
    v_pk_add_f32 v[10:11], v[10:11], s[46:47]
    v_pk_add_f32 v[12:13], v[12:13], s[46:47]
    v_pk_add_f32 v[14:15], v[14:15], s[46:47]
    v_rcp_f32 v8, v8
    v_rcp_f32 v9, v9
    v_rcp_f32 v10, v10
    v_rcp_f32 v11, v11
    v_rcp_f32 v12, v12
    v_rcp_f32 v13, v13
    v_rcp_f32 v14, v14
    v_rcp_f32 v15, v15
    s_add_u32 s36, s35, 8448
    v_pk_mul_f32 v[164:165], v[164:165], v[8:9]
    v_pk_mul_f32 v[166:167], v[166:167], v[10:11]
    v_pk_mul_f32 v[180:181], v[180:181], v[12:13]
    v_pk_mul_f32 v[182:183], v[182:183], v[14:15]
    v_cvt_pk_bf16_f32 v164, v164, v165
    v_cvt_pk_bf16_f32 v165, v166, v167
    v_cvt_pk_bf16_f32 v166, v180, v181
    v_cvt_pk_bf16_f32 v167, v182, v183
    buffer_store_dwordx4 v[164:167], v7, s[16:19], s36 offen sc1
    v_pk_mul_f32 v[8:9], v[168:169], s[44:45]
    v_pk_mul_f32 v[10:11], v[170:171], s[44:45]
    v_pk_mul_f32 v[12:13], v[184:185], s[44:45]
    v_pk_mul_f32 v[14:15], v[186:187], s[44:45]
    v_exp_f32 v8, v8
    v_exp_f32 v9, v9
    v_exp_f32 v10, v10
    v_exp_f32 v11, v11
    v_exp_f32 v12, v12
    v_exp_f32 v13, v13
    v_exp_f32 v14, v14
    v_exp_f32 v15, v15
    v_pk_add_f32 v[8:9], v[8:9], s[46:47]
    v_pk_add_f32 v[10:11], v[10:11], s[46:47]
    v_pk_add_f32 v[12:13], v[12:13], s[46:47]
    v_pk_add_f32 v[14:15], v[14:15], s[46:47]
    v_rcp_f32 v8, v8
    v_rcp_f32 v9, v9
    v_rcp_f32 v10, v10
    v_rcp_f32 v11, v11
    v_rcp_f32 v12, v12
    v_rcp_f32 v13, v13
    v_rcp_f32 v14, v14
    v_rcp_f32 v15, v15
    s_add_u32 s36, s35, 307456
    v_pk_mul_f32 v[168:169], v[168:169], v[8:9]
    v_pk_mul_f32 v[170:171], v[170:171], v[10:11]
    v_pk_mul_f32 v[184:185], v[184:185], v[12:13]
    v_pk_mul_f32 v[186:187], v[186:187], v[14:15]
    v_cvt_pk_bf16_f32 v168, v168, v169
    v_cvt_pk_bf16_f32 v169, v170, v171
    v_cvt_pk_bf16_f32 v170, v184, v185
    v_cvt_pk_bf16_f32 v171, v186, v187
    buffer_store_dwordx4 v[168:171], v7, s[16:19], s36 offen sc1
    v_pk_mul_f32 v[8:9], v[172:173], s[44:45]
    v_pk_mul_f32 v[10:11], v[174:175], s[44:45]
    v_pk_mul_f32 v[12:13], v[188:189], s[44:45]
    v_pk_mul_f32 v[14:15], v[190:191], s[44:45]
    v_exp_f32 v8, v8
    v_exp_f32 v9, v9
    v_exp_f32 v10, v10
    v_exp_f32 v11, v11
    v_exp_f32 v12, v12
    v_exp_f32 v13, v13
    v_exp_f32 v14, v14
    v_exp_f32 v15, v15
    v_pk_add_f32 v[8:9], v[8:9], s[46:47]
    v_pk_add_f32 v[10:11], v[10:11], s[46:47]
    v_pk_add_f32 v[12:13], v[12:13], s[46:47]
    v_pk_add_f32 v[14:15], v[14:15], s[46:47]
    v_rcp_f32 v8, v8
    v_rcp_f32 v9, v9
    v_rcp_f32 v10, v10
    v_rcp_f32 v11, v11
    v_rcp_f32 v12, v12
    v_rcp_f32 v13, v13
    v_rcp_f32 v14, v14
    v_rcp_f32 v15, v15
    s_add_u32 s36, s35, 307712
    v_pk_mul_f32 v[172:173], v[172:173], v[8:9]
    v_pk_mul_f32 v[174:175], v[174:175], v[10:11]
    v_pk_mul_f32 v[188:189], v[188:189], v[12:13]
    v_pk_mul_f32 v[190:191], v[190:191], v[14:15]
    v_cvt_pk_bf16_f32 v172, v172, v173
    v_cvt_pk_bf16_f32 v173, v174, v175
    v_cvt_pk_bf16_f32 v174, v188, v189
    v_cvt_pk_bf16_f32 v175, v190, v191
    buffer_store_dwordx4 v[172:175], v7, s[16:19], s36 offen sc1
    v_pk_mul_f32 v[8:9], v[192:193], s[44:45]
    v_pk_mul_f32 v[10:11], v[194:195], s[44:45]
    v_pk_mul_f32 v[12:13], v[208:209], s[44:45]
    v_pk_mul_f32 v[14:15], v[210:211], s[44:45]
    v_exp_f32 v8, v8
    v_exp_f32 v9, v9
    v_exp_f32 v10, v10
    v_exp_f32 v11, v11
    v_exp_f32 v12, v12
    v_exp_f32 v13, v13
    v_exp_f32 v14, v14
    v_exp_f32 v15, v15
    v_pk_add_f32 v[8:9], v[8:9], s[46:47]
    v_pk_add_f32 v[10:11], v[10:11], s[46:47]
    v_pk_add_f32 v[12:13], v[12:13], s[46:47]
    v_pk_add_f32 v[14:15], v[14:15], s[46:47]
    v_rcp_f32 v8, v8
    v_rcp_f32 v9, v9
    v_rcp_f32 v10, v10
    v_rcp_f32 v11, v11
    v_rcp_f32 v12, v12
    v_rcp_f32 v13, v13
    v_rcp_f32 v14, v14
    v_rcp_f32 v15, v15
    s_add_u32 s36, s35, 10240
    v_pk_mul_f32 v[192:193], v[192:193], v[8:9]
    v_pk_mul_f32 v[194:195], v[194:195], v[10:11]
    v_pk_mul_f32 v[208:209], v[208:209], v[12:13]
    v_pk_mul_f32 v[210:211], v[210:211], v[14:15]
    v_cvt_pk_bf16_f32 v192, v192, v193
    v_cvt_pk_bf16_f32 v193, v194, v195
    v_cvt_pk_bf16_f32 v194, v208, v209
    v_cvt_pk_bf16_f32 v195, v210, v211
    buffer_store_dwordx4 v[192:195], v7, s[16:19], s36 offen sc1
    v_pk_mul_f32 v[8:9], v[196:197], s[44:45]
    v_pk_mul_f32 v[10:11], v[198:199], s[44:45]
    v_pk_mul_f32 v[12:13], v[212:213], s[44:45]
    v_pk_mul_f32 v[14:15], v[214:215], s[44:45]
    v_exp_f32 v8, v8
    v_exp_f32 v9, v9
    v_exp_f32 v10, v10
    v_exp_f32 v11, v11
    v_exp_f32 v12, v12
    v_exp_f32 v13, v13
    v_exp_f32 v14, v14
    v_exp_f32 v15, v15
    v_pk_add_f32 v[8:9], v[8:9], s[46:47]
    v_pk_add_f32 v[10:11], v[10:11], s[46:47]
    v_pk_add_f32 v[12:13], v[12:13], s[46:47]
    v_pk_add_f32 v[14:15], v[14:15], s[46:47]
    v_rcp_f32 v8, v8
    v_rcp_f32 v9, v9
    v_rcp_f32 v10, v10
    v_rcp_f32 v11, v11
    v_rcp_f32 v12, v12
    v_rcp_f32 v13, v13
    v_rcp_f32 v14, v14
    v_rcp_f32 v15, v15
    s_add_u32 s36, s35, 10496
    v_pk_mul_f32 v[196:197], v[196:197], v[8:9]
    v_pk_mul_f32 v[198:199], v[198:199], v[10:11]
    v_pk_mul_f32 v[212:213], v[212:213], v[12:13]
    v_pk_mul_f32 v[214:215], v[214:215], v[14:15]
    v_cvt_pk_bf16_f32 v196, v196, v197
    v_cvt_pk_bf16_f32 v197, v198, v199
    v_cvt_pk_bf16_f32 v198, v212, v213
    v_cvt_pk_bf16_f32 v199, v214, v215
    buffer_store_dwordx4 v[196:199], v7, s[16:19], s36 offen sc1
    v_pk_mul_f32 v[8:9], v[200:201], s[44:45]
    v_pk_mul_f32 v[10:11], v[202:203], s[44:45]
    v_pk_mul_f32 v[12:13], v[216:217], s[44:45]
    v_pk_mul_f32 v[14:15], v[218:219], s[44:45]
    v_exp_f32 v8, v8
    v_exp_f32 v9, v9
    v_exp_f32 v10, v10
    v_exp_f32 v11, v11
    v_exp_f32 v12, v12
    v_exp_f32 v13, v13
    v_exp_f32 v14, v14
    v_exp_f32 v15, v15
    v_pk_add_f32 v[8:9], v[8:9], s[46:47]
    v_pk_add_f32 v[10:11], v[10:11], s[46:47]
    v_pk_add_f32 v[12:13], v[12:13], s[46:47]
    v_pk_add_f32 v[14:15], v[14:15], s[46:47]
    v_rcp_f32 v8, v8
    v_rcp_f32 v9, v9
    v_rcp_f32 v10, v10
    v_rcp_f32 v11, v11
    v_rcp_f32 v12, v12
    v_rcp_f32 v13, v13
    v_rcp_f32 v14, v14
    v_rcp_f32 v15, v15
    s_add_u32 s36, s35, 309504
    v_pk_mul_f32 v[200:201], v[200:201], v[8:9]
    v_pk_mul_f32 v[202:203], v[202:203], v[10:11]
    v_pk_mul_f32 v[216:217], v[216:217], v[12:13]
    v_pk_mul_f32 v[218:219], v[218:219], v[14:15]
    v_cvt_pk_bf16_f32 v200, v200, v201
    v_cvt_pk_bf16_f32 v201, v202, v203
    v_cvt_pk_bf16_f32 v202, v216, v217
    v_cvt_pk_bf16_f32 v203, v218, v219
    buffer_store_dwordx4 v[200:203], v7, s[16:19], s36 offen sc1
    v_pk_mul_f32 v[8:9], v[204:205], s[44:45]
    v_pk_mul_f32 v[10:11], v[206:207], s[44:45]
    v_pk_mul_f32 v[12:13], v[220:221], s[44:45]
    v_pk_mul_f32 v[14:15], v[222:223], s[44:45]
    v_exp_f32 v8, v8
    v_exp_f32 v9, v9
    v_exp_f32 v10, v10
    v_exp_f32 v11, v11
    v_exp_f32 v12, v12
    v_exp_f32 v13, v13
    v_exp_f32 v14, v14
    v_exp_f32 v15, v15
    v_pk_add_f32 v[8:9], v[8:9], s[46:47]
    v_pk_add_f32 v[10:11], v[10:11], s[46:47]
    v_pk_add_f32 v[12:13], v[12:13], s[46:47]
    v_pk_add_f32 v[14:15], v[14:15], s[46:47]
    v_rcp_f32 v8, v8
    v_rcp_f32 v9, v9
    v_rcp_f32 v10, v10
    v_rcp_f32 v11, v11
    v_rcp_f32 v12, v12
    v_rcp_f32 v13, v13
    v_rcp_f32 v14, v14
    v_rcp_f32 v15, v15
    s_add_u32 s36, s35, 309760
    v_pk_mul_f32 v[204:205], v[204:205], v[8:9]
    v_pk_mul_f32 v[206:207], v[206:207], v[10:11]
    v_pk_mul_f32 v[220:221], v[220:221], v[12:13]
    v_pk_mul_f32 v[222:223], v[222:223], v[14:15]
    v_cvt_pk_bf16_f32 v204, v204, v205
    v_cvt_pk_bf16_f32 v205, v206, v207
    v_cvt_pk_bf16_f32 v206, v220, v221
    v_cvt_pk_bf16_f32 v207, v222, v223
    buffer_store_dwordx4 v[204:207], v7, s[16:19], s36 offen sc1
    v_pk_mul_f32 v[8:9], v[224:225], s[44:45]
    v_pk_mul_f32 v[10:11], v[226:227], s[44:45]
    v_pk_mul_f32 v[12:13], v[240:241], s[44:45]
    v_pk_mul_f32 v[14:15], v[242:243], s[44:45]
    v_exp_f32 v8, v8
    v_exp_f32 v9, v9
    v_exp_f32 v10, v10
    v_exp_f32 v11, v11
    v_exp_f32 v12, v12
    v_exp_f32 v13, v13
    v_exp_f32 v14, v14
    v_exp_f32 v15, v15
    v_pk_add_f32 v[8:9], v[8:9], s[46:47]
    v_pk_add_f32 v[10:11], v[10:11], s[46:47]
    v_pk_add_f32 v[12:13], v[12:13], s[46:47]
    v_pk_add_f32 v[14:15], v[14:15], s[46:47]
    v_rcp_f32 v8, v8
    v_rcp_f32 v9, v9
    v_rcp_f32 v10, v10
    v_rcp_f32 v11, v11
    v_rcp_f32 v12, v12
    v_rcp_f32 v13, v13
    v_rcp_f32 v14, v14
    v_rcp_f32 v15, v15
    s_add_u32 s36, s35, 12288
    v_pk_mul_f32 v[224:225], v[224:225], v[8:9]
    v_pk_mul_f32 v[226:227], v[226:227], v[10:11]
    v_pk_mul_f32 v[240:241], v[240:241], v[12:13]
    v_pk_mul_f32 v[242:243], v[242:243], v[14:15]
    v_cvt_pk_bf16_f32 v224, v224, v225
    v_cvt_pk_bf16_f32 v225, v226, v227
    v_cvt_pk_bf16_f32 v226, v240, v241
    v_cvt_pk_bf16_f32 v227, v242, v243
    buffer_store_dwordx4 v[224:227], v7, s[16:19], s36 offen sc1
    v_pk_mul_f32 v[8:9], v[228:229], s[44:45]
    v_pk_mul_f32 v[10:11], v[230:231], s[44:45]
    v_pk_mul_f32 v[12:13], v[244:245], s[44:45]
    v_pk_mul_f32 v[14:15], v[246:247], s[44:45]
    v_exp_f32 v8, v8
    v_exp_f32 v9, v9
    v_exp_f32 v10, v10
    v_exp_f32 v11, v11
    v_exp_f32 v12, v12
    v_exp_f32 v13, v13
    v_exp_f32 v14, v14
    v_exp_f32 v15, v15
    v_pk_add_f32 v[8:9], v[8:9], s[46:47]
    v_pk_add_f32 v[10:11], v[10:11], s[46:47]
    v_pk_add_f32 v[12:13], v[12:13], s[46:47]
    v_pk_add_f32 v[14:15], v[14:15], s[46:47]
    v_rcp_f32 v8, v8
    v_rcp_f32 v9, v9
    v_rcp_f32 v10, v10
    v_rcp_f32 v11, v11
    v_rcp_f32 v12, v12
    v_rcp_f32 v13, v13
    v_rcp_f32 v14, v14
    v_rcp_f32 v15, v15
    s_add_u32 s36, s35, 12544
    v_pk_mul_f32 v[228:229], v[228:229], v[8:9]
    v_pk_mul_f32 v[230:231], v[230:231], v[10:11]
    v_pk_mul_f32 v[244:245], v[244:245], v[12:13]
    v_pk_mul_f32 v[246:247], v[246:247], v[14:15]
    v_cvt_pk_bf16_f32 v228, v228, v229
    v_cvt_pk_bf16_f32 v229, v230, v231
    v_cvt_pk_bf16_f32 v230, v244, v245
    v_cvt_pk_bf16_f32 v231, v246, v247
    buffer_store_dwordx4 v[228:231], v7, s[16:19], s36 offen sc1
    v_pk_mul_f32 v[8:9], v[232:233], s[44:45]
    v_pk_mul_f32 v[10:11], v[234:235], s[44:45]
    v_pk_mul_f32 v[12:13], v[248:249], s[44:45]
    v_pk_mul_f32 v[14:15], v[250:251], s[44:45]
    v_exp_f32 v8, v8
    v_exp_f32 v9, v9
    v_exp_f32 v10, v10
    v_exp_f32 v11, v11
    v_exp_f32 v12, v12
    v_exp_f32 v13, v13
    v_exp_f32 v14, v14
    v_exp_f32 v15, v15
    v_pk_add_f32 v[8:9], v[8:9], s[46:47]
    v_pk_add_f32 v[10:11], v[10:11], s[46:47]
    v_pk_add_f32 v[12:13], v[12:13], s[46:47]
    v_pk_add_f32 v[14:15], v[14:15], s[46:47]
    v_rcp_f32 v8, v8
    v_rcp_f32 v9, v9
    v_rcp_f32 v10, v10
    v_rcp_f32 v11, v11
    v_rcp_f32 v12, v12
    v_rcp_f32 v13, v13
    v_rcp_f32 v14, v14
    v_rcp_f32 v15, v15
    s_add_u32 s36, s35, 311552
    v_pk_mul_f32 v[232:233], v[232:233], v[8:9]
    v_pk_mul_f32 v[234:235], v[234:235], v[10:11]
    v_pk_mul_f32 v[248:249], v[248:249], v[12:13]
    v_pk_mul_f32 v[250:251], v[250:251], v[14:15]
    v_cvt_pk_bf16_f32 v232, v232, v233
    v_cvt_pk_bf16_f32 v233, v234, v235
    v_cvt_pk_bf16_f32 v234, v248, v249
    v_cvt_pk_bf16_f32 v235, v250, v251
    buffer_store_dwordx4 v[232:235], v7, s[16:19], s36 offen sc1
    v_pk_mul_f32 v[8:9], v[236:237], s[44:45]
    v_pk_mul_f32 v[10:11], v[238:239], s[44:45]
    v_pk_mul_f32 v[12:13], v[252:253], s[44:45]
    v_pk_mul_f32 v[14:15], v[254:255], s[44:45]
    v_exp_f32 v8, v8
    v_exp_f32 v9, v9
    v_exp_f32 v10, v10
    v_exp_f32 v11, v11
    v_exp_f32 v12, v12
    v_exp_f32 v13, v13
    v_exp_f32 v14, v14
    v_exp_f32 v15, v15
    v_pk_add_f32 v[8:9], v[8:9], s[46:47]
    v_pk_add_f32 v[10:11], v[10:11], s[46:47]
    v_pk_add_f32 v[12:13], v[12:13], s[46:47]
    v_pk_add_f32 v[14:15], v[14:15], s[46:47]
    v_rcp_f32 v8, v8
    v_rcp_f32 v9, v9
    v_rcp_f32 v10, v10
    v_rcp_f32 v11, v11
    v_rcp_f32 v12, v12
    v_rcp_f32 v13, v13
    v_rcp_f32 v14, v14
    v_rcp_f32 v15, v15
    s_add_u32 s36, s35, 311808
    v_pk_mul_f32 v[236:237], v[236:237], v[8:9]
    v_pk_mul_f32 v[238:239], v[238:239], v[10:11]
    v_pk_mul_f32 v[252:253], v[252:253], v[12:13]
    v_pk_mul_f32 v[254:255], v[254:255], v[14:15]
    v_cvt_pk_bf16_f32 v236, v236, v237
    v_cvt_pk_bf16_f32 v237, v238, v239
    v_cvt_pk_bf16_f32 v238, v252, v253
    v_cvt_pk_bf16_f32 v239, v254, v255
    buffer_store_dwordx4 v[236:239], v7, s[16:19], s36 offen sc1
    s_mov_b32 s55, s35
    s_mov_b32 s100, s31
    s_branch L_p1_fin
L_p1_sigqkv:
    s_add_u32 s4, s40, 148480
    s_addc_u32 s5, s41, 0
    s_mov_b32 s20, s4
    s_and_b32 s21, s5, 0xffff
    s_mov_b32 s22, 32768
    s_mov_b32 s23, 0x00020000
    s_mul_i32 s34, s58, 6
    v_lshrrev_b32 v3, 3, v17
    v_add_u32 v3, s34, v3
    v_cmp_gt_u32 vcc, 48, v17
    s_nop 3
    s_mov_b64 s[44:45], vcc
    v_and_b32 v3, 31, v3
    v_lshrrev_b32 v4, 2, v3
    v_and_b32 v3, 3, v3
    v_lshlrev_b32 v3, 3, v3
    v_and_b32 v5, 7, v17
    v_or_b32 v3, v3, v5
    v_lshl_add_u32 v3, v3, 3, v4
    v_lshlrev_b32 v3, 7, v3
    v_mov_b32 v4, 1
    s_waitcnt vmcnt(0)
    s_barrier
    s_cmp_eq_u32 s30, 0
    s_cbranch_scc0 L_p1_nosq
    s_mov_b64 exec, s[44:45]
    s_cbranch_execz L_p1_nosq2
    buffer_atomic_add v4, v3, s[20:23], 0 offen
L_p1_nosq2:
    s_mov_b64 exec, -1
L_p1_nosq:
    s_mov_b32 s100, -1
    s_load_dwordx2 s[4:5], s[0:1], 16
    s_load_dwordx2 s[6:7], s[0:1], 40
    s_lshl_b32 s34, s58, 3
    s_add_u32 s34, s34, s31
    s_lshl_b32 s35, s30, 6
    v_add_u32 v9, s35, v17
    v_lshlrev_b32 v9, 7, v9
    s_waitcnt lgkmcnt(0)
    s_mul_i32 s35, s34, 16384
    s_add_u32 s4, s4, s35
    s_addc_u32 s5, s5, 0
    s_mov_b32 s8, s4
    s_and_b32 s9, s5, 0xffff
    s_mov_b32 s10, 16384
    s_mov_b32 s11, 0x00020000
    buffer_load_dword v10, v9, s[8:11], 0 offen
    s_mul_i32 s35, s34, 57344
    s_add_u32 s6, s6, s35
    s_addc_u32 s7, s7, 0
    s_mov_b32 s8, s6
    s_and_b32 s9, s7, 0xffff
    s_mov_b32 s10, 57344
    s_mov_b32 s11, 0x00020000
    buffer_load_dword v10, v9, s[8:11], 0 offen
    s_mov_b32 s35, 32768
    buffer_load_dword v10, v9, s[8:11], s35 offen
L_p1_fin:
    s_load_dwordx2 s[34:35], s[0:1], 64
    s_load_dwordx2 s[52:53], s[0:1], 16
    s_load_dwordx2 s[4:5], s[0:1], 40
    s_load_dwordx2 s[96:97], s[0:1], 0
    s_load_dwordx2 s[98:99], s[0:1], 48
    s_and_b32 s3, s2, 7
    s_lshr_b32 s6, s2, 3
    s_lshl_b32 s7, s3, 2
    s_lshr_b32 s36, s6, 3
    s_add_u32 s31, s7, s36
    s_and_b32 s33, s6, 7
    s_and_b32 s61, s6, 1
    s_lshr_b32 s6, s6, 1
    s_and_b32 s7, s3, 3
    s_lshl_b32 s7, s7, 2
    s_and_b32 s36, s6, 3
    s_add_u32 s62, s7, s36
    s_lshr_b32 s7, s3, 2
    s_lshl_b32 s7, s7, 2
    s_lshr_b32 s36, s6, 2
    s_add_u32 s63, s7, s36
    v_mbcnt_lo_u32_b32 v1, -1, 0
    v_mbcnt_hi_u32_b32 v1, -1, v1
    v_lshlrev_b32 v2, 4, v1
    s_lshl_b32 s6, s33, 3
    s_lshl_b32 s7, s30, 1
    s_add_u32 s32, s6, s7
    s_waitcnt lgkmcnt(0)
    s_mul_i32 s6, s31, 135424
    s_add_u32 s36, s34, 4194304
    s_addc_u32 s37, s35, 0
    s_add_u32 s36, s36, s6
    s_addc_u32 s37, s37, 0
    s_mov_b32 s16, s36
    s_and_b32 s17, s37, 0xffff
    s_mov_b32 s18, 131072
    s_mov_b32 s19, 0x00020000
    s_add_u32 s36, s36, 4333568
    s_addc_u32 s37, s37, 0
    s_mov_b32 s8, s36
    s_and_b32 s9, s37, 0xffff
    s_mov_b32 s10, 131072
    s_mov_b32 s11, 0x00020000
    s_add_u32 s36, s36, 4333568
    s_addc_u32 s37, s37, 0
    s_sub_u32 s38, s36, 2048
    s_subb_u32 s39, s37, 0
    s_mov_b32 s12, s38
    s_and_b32 s13, s39, 0xffff
    s_mov_b32 s14, 133120
    s_mov_b32 s15, 0x00020000
    s_add_u32 s36, s34, 17825792
    s_addc_u32 s37, s35, 0
    s_mov_b32 s24, s36
    s_and_b32 s25, s37, 0xffff
    s_mov_b32 s26, 524288
    s_mov_b32 s27, 0x00020000
    s_lshl_b32 s6, s63, 8
    s_add_u32 s52, s52, s6
    s_addc_u32 s53, s53, 0
    s_and_b32 s53, s53, 0xffff
    s_sub_u32 s54, 2097152, s6
    s_add_u32 s4, s4, s6
    s_addc_u32 s5, s5, 0
    s_sub_u32 s7, 7340032, s6
    s_mov_b32 s40, s4
    s_and_b32 s41, s5, 0xffff
    s_mov_b32 s42, s7
    s_mov_b32 s43, 0x00020000
    s_add_u32 s36, s34, 18874368
    s_addc_u32 s37, s35, 0
    s_lshl_b32 s6, s62, 2
    s_add_u32 s6, s6, s30
    s_mul_i32 s6, s6, 299264
    s_add_u32 s36, s36, s6
    s_addc_u32 s37, s37, 0
    s_mov_b32 s44, s36
    s_and_b32 s45, s37, 0xffff
    s_mov_b32 s46, 299264
    s_mov_b32 s47, 0x00020000
    s_add_u32 s36, s34, 131072
    s_addc_u32 s37, s35, 0
    s_mov_b32 s48, s36
    s_and_b32 s49, s37, 0xffff
    s_mov_b32 s50, 50176
    s_mov_b32 s51, 0x00020000
    s_mul_i32 s6, s61, 56
    s_add_u32 s6, s6, 32
    s_lshl_b32 s57, s6, 11
    s_mul_i32 s56, s61, 3670016
    s_lshl_b32 s88, s61, 20
    s_lshl_b32 s89, s61, 15
    s_add_u32 s6, s61, 1
    s_lshl_b32 s6, s6, 20
    s_lshl_b32 s7, s63, 8
    s_sub_u32 s54, s6, s7
    s_mov_b32 s90, 2
    s_mov_b32 s94, 3
    s_lshr_b32 s6, s62, 1
    s_lshl_b32 s6, s6, 7
    s_lshl_b32 s7, s62, 3
    s_add_u32 s7, s7, s63
    s_add_u32 s7, s7, 8
    s_lshl_b32 s7, s7, 7
    s_xor_b32 s36, s61, 1
    s_lshl_b32 s36, s36, 2
    s_add_u32 s7, s7, s36
    v_mov_b32 v5, s7
    v_mov_b32 v6, s6
    v_cmp_eq_u32 vcc, 0, v1
    s_nop 1
    v_cndmask_b32 v222, v5, v6, vcc
    v_lshrrev_b32 v5, 4, v1
    v_and_b32 v6, 15, v1
    s_lshl_b32 s6, s30, 5
    v_add_u32 v7, 0, v5
    v_lshlrev_b32 v7, 1, v7
    v_xor_b32 v7, v7, v6
    v_add_u32 v24, s6, v5
    v_lshlrev_b32 v24, 11, v24
    v_lshl_add_u32 v24, v7, 4, v24
    v_add_u32 v232, 0, v24
    v_add_u32 v7, 4, v5
    v_lshlrev_b32 v7, 1, v7
    v_xor_b32 v7, v7, v6
    v_add_u32 v24, s6, v5
    v_lshlrev_b32 v24, 11, v24
    v_lshl_add_u32 v24, v7, 4, v24
    v_add_u32 v233, 7168, v24
    v_add_u32 v7, 0, v5
    v_lshlrev_b32 v7, 1, v7
    v_xor_b32 v7, v7, v6
    v_add_u32 v24, s6, v5
    v_lshlrev_b32 v24, 11, v24
    v_lshl_add_u32 v24, v7, 4, v24
    v_add_u32 v234, 14336, v24
    v_add_u32 v7, 4, v5
    v_lshlrev_b32 v7, 1, v7
    v_xor_b32 v7, v7, v6
    v_add_u32 v24, s6, v5
    v_lshlrev_b32 v24, 11, v24
    v_lshl_add_u32 v24, v7, 4, v24
    v_add_u32 v235, 21504, v24
    v_add_u32 v7, 0, v5
    v_lshlrev_b32 v7, 1, v7
    v_xor_b32 v7, v7, v6
    v_add_u32 v24, s6, v5
    v_lshlrev_b32 v24, 11, v24
    v_lshl_add_u32 v24, v7, 4, v24
    v_add_u32 v236, 32768, v24
    v_add_u32 v7, 4, v5
    v_lshlrev_b32 v7, 1, v7
    v_xor_b32 v7, v7, v6
    v_add_u32 v24, s6, v5
    v_lshlrev_b32 v24, 11, v24
    v_lshl_add_u32 v24, v7, 4, v24
    v_add_u32 v237, 39936, v24
    v_add_u32 v7, 0, v5
    v_lshlrev_b32 v7, 1, v7
    v_xor_b32 v7, v7, v6
    v_add_u32 v24, s6, v5
    v_lshlrev_b32 v24, 11, v24
    v_lshl_add_u32 v24, v7, 4, v24
    v_add_u32 v238, 47104, v24
    v_add_u32 v7, 4, v5
    v_lshlrev_b32 v7, 1, v7
    v_xor_b32 v7, v7, v6
    v_add_u32 v24, s6, v5
    v_lshlrev_b32 v24, 11, v24
    v_lshl_add_u32 v24, v7, 4, v24
    v_add_u32 v239, 54272, v24
    v_lshrrev_b32 v7, 2, v6
    v_lshl_add_u32 v7, v5, 2, v7
    v_and_b32 v24, 7, v7
    v_lshlrev_b32 v7, 8, v7
    v_and_b32 v25, 3, v6
    v_lshl_add_u32 v7, v25, 3, v7
    v_xor_b32 v25, 0, v24
    v_lshl_add_u32 v240, v25, 5, v7
    v_xor_b32 v25, 1, v24
    v_lshl_add_u32 v241, v25, 5, v7
    v_xor_b32 v25, 2, v24
    v_lshl_add_u32 v242, v25, 5, v7
    v_xor_b32 v25, 3, v24
    v_lshl_add_u32 v243, v25, 5, v7
    v_xor_b32 v25, 4, v24
    v_lshl_add_u32 v244, v25, 5, v7
    v_xor_b32 v25, 5, v24
    v_lshl_add_u32 v245, v25, 5, v7
    v_xor_b32 v25, 6, v24
    v_lshl_add_u32 v246, v25, 5, v7
    v_xor_b32 v25, 7, v24
    v_lshl_add_u32 v247, v25, 5, v7
    v_lshrrev_b32 v7, 1, v5
    v_lshlrev_b32 v7, 10, v7
    v_and_b32 v24, 1, v5
    v_lshl_add_u32 v7, v24, 9, v7
    v_lshl_add_u32 v248, v6, 4, v7
    v_mov_b64 v[80:81], 0
    v_mov_b64 v[82:83], 0
    v_mov_b64 v[84:85], 0
    v_mov_b64 v[86:87], 0
    v_mov_b64 v[88:89], 0
    v_mov_b64 v[90:91], 0
    v_mov_b64 v[92:93], 0
    v_mov_b64 v[94:95], 0
    v_mov_b64 v[112:113], 0
    v_mov_b64 v[114:115], 0
    v_mov_b64 v[96:97], 0
    v_mov_b64 v[98:99], 0
    v_mov_b64 v[100:101], 0
    v_mov_b64 v[102:103], 0
    v_mov_b64 v[104:105], 0
    v_mov_b64 v[106:107], 0
    v_mov_b64 v[108:109], 0
    v_mov_b64 v[110:111], 0
    v_mov_b64 v[128:129], 0
    v_mov_b64 v[130:131], 0
    v_mov_b64 v[72:73], 0
    v_mov_b64 v[74:75], 0
    v_mov_b64 v[76:77], 0
    v_mov_b64 v[78:79], 0
    v_mov_b64 v[152:153], 0
    v_mov_b64 v[154:155], 0
    v_mov_b64 v[156:157], 0
    v_mov_b64 v[158:159], 0
    v_mov_b64 v[160:161], 0
    v_mov_b64 v[162:163], 0
    v_mov_b64 v[164:165], 0
    v_mov_b64 v[166:167], 0
    v_mov_b64 v[168:169], 0
    v_mov_b64 v[170:171], 0
    v_mov_b64 v[172:173], 0
    v_mov_b64 v[174:175], 0
    v_mov_b64 v[176:177], 0
    v_mov_b64 v[178:179], 0
    v_mov_b64 v[180:181], 0
    v_mov_b64 v[182:183], 0
    v_mov_b64 v[184:185], 0
    v_mov_b64 v[186:187], 0
    v_mov_b64 v[188:189], 0
    v_mov_b64 v[190:191], 0
    v_mov_b64 v[192:193], 0
    v_mov_b64 v[194:195], 0
    v_mov_b64 v[196:197], 0
    v_mov_b64 v[198:199], 0
    v_mov_b64 v[200:201], 0
    v_mov_b64 v[202:203], 0
    v_mov_b64 v[204:205], 0
    v_mov_b64 v[206:207], 0
    v_mov_b64 v[208:209], 0
    v_mov_b64 v[210:211], 0
    v_mov_b64 v[212:213], 0
    v_mov_b64 v[214:215], 0
    v_and_b32 v5, 15, v1
    v_lshrrev_b32 v6, 4, v1
    v_and_b32 v6, 1, v6
    v_cmp_eq_u32 vcc, v5, v6
    v_mov_b32 v7, 0x3f803f80
    s_nop 0
    v_cndmask_b32 v144, 0, v7, vcc
    v_cndmask_b32 v145, 0, v7, vcc
    v_cndmask_b32 v146, 0, v7, vcc
    v_cndmask_b32 v147, 0, v7, vcc
    s_add_u32 s36, s34, 148480
    s_addc_u32 s37, s35, 0
    s_mov_b32 s20, s36
    s_and_b32 s21, s37, 0xffff
    s_mov_b32 s22, 32768
    s_mov_b32 s23, 0x00020000
    s_lshl_b32 s101, s2, 7
    s_mov_b32 s6, 0x8000
L_p2_pq:
    buffer_load_dword v4, off, s[20:23], s101 sc1
    s_waitcnt vmcnt(0)
    v_readfirstlane_b32 s7, v4
    s_sub_u32 s6, s6, 1
    s_cmp_eq_u32 s6, 0
    s_cbranch_scc1 L_p2_pqd
    s_cmp_ge_u32 s7, 24
    s_cbranch_scc1 L_p2_pqd
    s_sleep 1
    s_branch L_p2_pq
L_p2_pqd:
    s_add_u32 s36, s34, 18874368
    s_addc_u32 s37, s35, 0
    s_mov_b32 s20, s36
    s_and_b32 s21, s37, 0xffff
    s_mov_b32 s22, 19152896
    s_mov_b32 s23, 0x00020000
    s_lshl_b32 s6, s32, 11
    buffer_load_dwordx4 v[8:11], v2, s[16:19], s6 offen offset:0 sc1
    buffer_load_dwordx4 v[12:15], v2, s[16:19], s6 offen offset:1024 sc1
    buffer_load_dwordx4 v[16:19], v2, s[16:19], s6 offen offset:2048 sc1
    buffer_load_dwordx4 v[20:23], v2, s[16:19], s6 offen offset:3072 sc1
    s_mov_b32 s28, 0
    buffer_load_dwordx4 a[0:3], v2, s[8:11], s28 offen offset:0 sc1
    buffer_load_dwordx4 a[4:7], v2, s[8:11], s28 offen offset:1024 sc1
    s_lshl_b32 s6, s31, 13
    s_lshl_b32 s7, s32, 7
    s_add_u32 s7, s7, s6
    v_lshlrev_b32 v3, 2, v1
    buffer_load_dword v4, v3, s[24:27], s7 offen sc1
    s_add_u32 s6, s6, 262144
    buffer_load_dwordx4 v[32:35], v2, s[24:27], s6 offen offset:0 sc1
    buffer_load_dwordx4 v[36:39], v2, s[24:27], s6 offen offset:1024 sc1
    buffer_load_dwordx4 v[40:43], v2, s[24:27], s6 offen offset:2048 sc1
    buffer_load_dwordx4 v[44:47], v2, s[24:27], s6 offen offset:3072 sc1
    s_add_u32 s6, s6, 4096
    buffer_load_dwordx4 v[48:51], v2, s[24:27], s6 offen offset:0 sc1
    buffer_load_dwordx4 v[52:55], v2, s[24:27], s6 offen offset:1024 sc1
    buffer_load_dwordx4 v[56:59], v2, s[24:27], s6 offen offset:2048 sc1
    buffer_load_dwordx4 v[60:63], v2, s[24:27], s6 offen offset:3072 sc1
    s_add_u32 s36, s34, 148480
    s_addc_u32 s37, s35, 0
    s_mov_b32 s24, s36
    s_and_b32 s25, s37, 0xffff
    s_mov_b32 s26, 32768
    s_mov_b32 s27, 0x00020000
    s_add_u32 s101, s101, 4
    v_accvgpr_write_b32 a120, 0
    v_accvgpr_write_b32 a121, 0
    v_accvgpr_write_b32 a122, 0
    v_accvgpr_write_b32 a123, 0
    v_accvgpr_write_b32 a124, 0
    v_accvgpr_write_b32 a125, 0
    v_accvgpr_write_b32 a126, 0
    v_accvgpr_write_b32 a127, 0
    s_mov_b32 s28, 2048
    buffer_load_dwordx4 a[16:19], v2, s[8:11], s28 offen offset:0 sc1
    buffer_load_dwordx4 a[20:23], v2, s[8:11], s28 offen offset:1024 sc1
    buffer_load_dwordx4 a[8:11], v2, s[12:15], s28 offen offset:0 sc1
    buffer_load_dwordx4 a[12:15], v2, s[12:15], s28 offen offset:1024 sc1
    s_mov_b32 s28, 4096
    buffer_load_dwordx4 a[32:35], v2, s[8:11], s28 offen offset:0 sc1
    buffer_load_dwordx4 a[36:39], v2, s[8:11], s28 offen offset:1024 sc1
    buffer_load_dwordx4 a[24:27], v2, s[12:15], s28 offen offset:0 sc1
    buffer_load_dwordx4 a[28:31], v2, s[12:15], s28 offen offset:1024 sc1
    s_mov_b32 s28, 6144
    buffer_load_dwordx4 a[48:51], v2, s[8:11], s28 offen offset:0 sc1
    buffer_load_dwordx4 a[52:55], v2, s[8:11], s28 offen offset:1024 sc1
    buffer_load_dwordx4 a[40:43], v2, s[12:15], s28 offen offset:0 sc1
    buffer_load_dwordx4 a[44:47], v2, s[12:15], s28 offen offset:1024 sc1
    v_and_b32 v5, 15, v1
    v_lshrrev_b32 v6, 4, v1
    v_lshrrev_b32 v7, 1, v6
    v_lshlrev_b32 v7, 10, v7
    v_and_b32 v6, 1, v6
    v_lshl_add_u32 v7, v6, 9, v7
    v_lshl_add_u32 v230, v5, 4, v7
    s_mov_b32 s16, s20
    s_mov_b32 s17, s21
    s_mov_b32 s19, 0x00020000
    s_cmp_lt_i32 s100, 0
    s_cselect_b32 s18, 0, s22
    s_waitcnt vmcnt(12)
    v_max_f32 v32, v32, v48
    v_max_f32 v33, v33, v49
    v_max_f32 v34, v34, v50
    v_max_f32 v35, v35, v51
    v_max_f32 v36, v36, v52
    v_max_f32 v37, v37, v53
    v_max_f32 v38, v38, v54
    v_max_f32 v39, v39, v55
    v_max_f32 v40, v40, v56
    v_max_f32 v41, v41, v57
    v_max_f32 v42, v42, v58
    v_max_f32 v43, v43, v59
    v_max_f32 v44, v44, v60
    v_max_f32 v45, v45, v61
    v_max_f32 v46, v46, v62
    v_max_f32 v47, v47, v63
    v_max_f32 v32, v32, v40
    v_max_f32 v33, v33, v41
    v_max_f32 v34, v34, v42
    v_max_f32 v35, v35, v43
    v_max_f32 v36, v36, v44
    v_max_f32 v37, v37, v45
    v_max_f32 v38, v38, v46
    v_max_f32 v39, v39, v47
    v_max_f32 v32, v32, v36
    v_max_f32 v33, v33, v37
    v_max_f32 v34, v34, v38
    v_max_f32 v35, v35, v39
    v_max_f32 v32, v32, v34
    v_max_f32 v33, v33, v35
    v_max_f32 v32, v32, v33
    s_nop 1
    v_max_f32_dpp v32, v32, v32 row_ror:8 row_mask:0xf bank_mask:0xf
    s_nop 1
    v_max_f32_dpp v32, v32, v32 row_ror:4 row_mask:0xf bank_mask:0xf
    s_nop 1
    v_max_f32_dpp v32, v32, v32 row_ror:2 row_mask:0xf bank_mask:0xf
    s_nop 1
    v_max_f32_dpp v32, v32, v32 row_ror:1 row_mask:0xf bank_mask:0xf
    s_nop 1
    v_readlane_b32 s36, v32, 0
    v_readlane_b32 s37, v32, 16
    v_readlane_b32 s38, v32, 32
    v_readlane_b32 s39, v32, 48
    s_nop 1
    s_max_u32 s36, s36, s37
    s_max_u32 s38, s38, s39
    s_max_u32 s6, s36, s38
    s_nop 1
    v_max_f32_dpp v4, v4, v4 row_ror:8 row_mask:0xf bank_mask:0xf
    s_nop 1
    v_max_f32_dpp v4, v4, v4 row_ror:4 row_mask:0xf bank_mask:0xf
    s_nop 1
    v_max_f32_dpp v4, v4, v4 row_ror:2 row_mask:0xf bank_mask:0xf
    s_nop 1
    v_max_f32_dpp v4, v4, v4 row_ror:1 row_mask:0xf bank_mask:0xf
    s_nop 1
    v_readlane_b32 s36, v4, 0
    v_readlane_b32 s37, v4, 16
    v_readlane_b32 s38, v4, 32
    v_readlane_b32 s39, v4, 48
    s_nop 1
    s_max_u32 s36, s36, s37
    s_max_u32 s38, s38, s39
    s_max_u32 s7, s36, s38
    v_mov_b32 v5, s6
    v_mul_f32 v5, s7, v5
    v_mov_b32 v6, 0x457a0000
    v_cmp_le_f32 vcc, v5, v6
    s_nop 4
    s_cbranch_vccz L_p2_slow
    v_mfma_f32_32x32x16_bf16 v[32:47], a[0:3], v[8:11], 0
    v_mfma_f32_32x32x16_bf16 v[32:47], a[4:7], v[12:15], v[32:47]
    s_mov_b32 s28, 16384
    s_movk_i32 s29, 6
    s_nop 7
    s_nop 7
    v_mfma_f32_32x32x16_bf16 v[48:63], a[0:3], v[16:19], 0
    v_exp_f32 v32, v32
    s_add_u32 s36, s28, 4096
    s_add_u32 s37, s28, 8192
    s_add_u32 s38, s28, 12288
    v_exp_f32 v33, v33
    s_mov_b32 s3, 8192
    buffer_load_dwordx4 a[64:67], v2, s[8:11], s3 offen offset:0 sc1
    v_exp_f32 v34, v34
    v_mfma_f32_32x32x16_bf16 v[48:63], a[4:7], v[20:23], v[48:63]
    v_exp_f32 v35, v35
    buffer_load_dwordx4 a[68:71], v2, s[8:11], s3 offen offset:1024 sc1
    v_cvt_pk_bf16_f32 v64, v32, v33
    v_exp_f32 v36, v36
    buffer_load_dwordx4 a[56:59], v2, s[12:15], s3 offen offset:0 sc1
    v_exp_f32 v37, v37
    v_cvt_pk_bf16_f32 v65, v34, v35
    buffer_load_dwordx4 a[60:63], v2, s[12:15], s3 offen offset:1024 sc1
    v_mfma_f32_32x32x16_bf16 v[96:111], a[120:123], v[72:75], v[96:111]
    v_exp_f32 v38, v38
    v_exp_f32 v39, v39
    buffer_load_dwordx4 a[0:3], v2, s[8:11], s28 offen offset:0 sc1
    v_cvt_pk_bf16_f32 v66, v36, v37
    v_exp_f32 v40, v40
    v_mfma_f32_32x32x16_bf16 v[96:111], a[124:127], v[76:79], v[96:111]
    v_exp_f32 v41, v41
    v_cvt_pk_bf16_f32 v67, v38, v39
    v_exp_f32 v42, v42
    v_exp_f32 v43, v43
    v_cvt_pk_bf16_f32 v68, v40, v41
    v_mfma_f32_16x16x32_bf16 v[128:131], v[144:147], v[72:75], v[128:131]
    v_exp_f32 v44, v44
    v_exp_f32 v45, v45
    v_cvt_pk_bf16_f32 v69, v42, v43
    v_exp_f32 v46, v46
    buffer_load_dwordx4 a[4:7], v2, s[8:11], s28 offen offset:1024 sc1
    v_mfma_f32_16x16x32_bf16 v[128:131], v[144:147], v[76:79], v[128:131]
    v_exp_f32 v47, v47
    v_cvt_pk_bf16_f32 v70, v44, v45
    v_cvt_pk_bf16_f32 v71, v46, v47
    s_waitcnt vmcnt(14)
    v_mfma_f32_32x32x16_bf16 v[32:47], a[16:19], v[8:11], 0
    v_exp_f32 v48, v48
    v_exp_f32 v49, v49
    s_mov_b32 s3, 10240
    buffer_load_dwordx4 a[80:83], v2, s[8:11], s3 offen offset:0 sc1
    v_exp_f32 v50, v50
    v_mfma_f32_32x32x16_bf16 v[32:47], a[20:23], v[12:15], v[32:47]
    v_exp_f32 v51, v51
    buffer_load_dwordx4 a[84:87], v2, s[8:11], s3 offen offset:1024 sc1
    v_cvt_pk_bf16_f32 v72, v48, v49
    v_exp_f32 v52, v52
    buffer_load_dwordx4 a[72:75], v2, s[12:15], s3 offen offset:0 sc1
    v_exp_f32 v53, v53
    v_cvt_pk_bf16_f32 v73, v50, v51
    buffer_load_dwordx4 a[76:79], v2, s[12:15], s3 offen offset:1024 sc1
    v_mfma_f32_32x32x16_bf16 v[80:95], a[8:11], v[64:67], v[80:95]
    v_exp_f32 v54, v54
    v_exp_f32 v55, v55
    buffer_load_dwordx4 a[120:123], v2, s[12:15], s28 offen offset:0 sc1
    v_cvt_pk_bf16_f32 v74, v52, v53
    v_exp_f32 v56, v56
    v_mfma_f32_32x32x16_bf16 v[80:95], a[12:15], v[68:71], v[80:95]
    v_exp_f32 v57, v57
    v_cvt_pk_bf16_f32 v75, v54, v55
    v_exp_f32 v58, v58
    v_exp_f32 v59, v59
    v_cvt_pk_bf16_f32 v76, v56, v57
    v_mfma_f32_16x16x32_bf16 v[112:115], v[144:147], v[64:67], v[112:115]
    v_exp_f32 v60, v60
    v_exp_f32 v61, v61
    v_cvt_pk_bf16_f32 v77, v58, v59
    v_exp_f32 v62, v62
    buffer_load_dwordx4 a[124:127], v2, s[12:15], s28 offen offset:1024 sc1
    v_mfma_f32_16x16x32_bf16 v[112:115], v[144:147], v[68:71], v[112:115]
    v_exp_f32 v63, v63
    v_cvt_pk_bf16_f32 v78, v60, v61
    v_cvt_pk_bf16_f32 v79, v62, v63
    v_mfma_f32_32x32x16_bf16 v[48:63], a[16:19], v[16:19], 0
    v_exp_f32 v32, v32
    v_exp_f32 v33, v33
    s_mov_b32 s3, 12288
    buffer_load_dwordx4 a[96:99], v2, s[8:11], s3 offen offset:0 sc1
    v_exp_f32 v34, v34
    v_mfma_f32_32x32x16_bf16 v[48:63], a[20:23], v[20:23], v[48:63]
    v_exp_f32 v35, v35
    buffer_load_dwordx4 a[100:103], v2, s[8:11], s3 offen offset:1024 sc1
    v_cvt_pk_bf16_f32 v64, v32, v33
    v_exp_f32 v36, v36
    buffer_load_dwordx4 a[88:91], v2, s[12:15], s3 offen offset:0 sc1
    v_exp_f32 v37, v37
    v_cvt_pk_bf16_f32 v65, v34, v35
    buffer_load_dwordx4 a[92:95], v2, s[12:15], s3 offen offset:1024 sc1
    v_mfma_f32_32x32x16_bf16 v[96:111], a[8:11], v[72:75], v[96:111]
    v_exp_f32 v38, v38
    v_exp_f32 v39, v39
    buffer_load_dwordx4 a[16:19], v2, s[8:11], s28 offen offset:2048 sc1
    v_cvt_pk_bf16_f32 v66, v36, v37
    v_exp_f32 v40, v40
    v_mfma_f32_32x32x16_bf16 v[96:111], a[12:15], v[76:79], v[96:111]
    v_exp_f32 v41, v41
    v_cvt_pk_bf16_f32 v67, v38, v39
    v_exp_f32 v42, v42
    v_exp_f32 v43, v43
    v_cvt_pk_bf16_f32 v68, v40, v41
    v_mfma_f32_16x16x32_bf16 v[128:131], v[144:147], v[72:75], v[128:131]
    v_exp_f32 v44, v44
    v_exp_f32 v45, v45
    v_cvt_pk_bf16_f32 v69, v42, v43
    v_exp_f32 v46, v46
    buffer_load_dwordx4 a[20:23], v2, s[8:11], s28 offen offset:3072 sc1
    v_mfma_f32_16x16x32_bf16 v[128:131], v[144:147], v[76:79], v[128:131]
    v_exp_f32 v47, v47
    v_cvt_pk_bf16_f32 v70, v44, v45
    v_cvt_pk_bf16_f32 v71, v46, v47
    s_waitcnt vmcnt(22)
    v_mfma_f32_32x32x16_bf16 v[32:47], a[32:35], v[8:11], 0
    v_exp_f32 v48, v48
    v_exp_f32 v49, v49
    s_mov_b32 s3, 14336
    buffer_load_dwordx4 a[112:115], v2, s[8:11], s3 offen offset:0 sc1
    v_exp_f32 v50, v50
    v_mfma_f32_32x32x16_bf16 v[32:47], a[36:39], v[12:15], v[32:47]
    v_exp_f32 v51, v51
    buffer_load_dwordx4 a[116:119], v2, s[8:11], s3 offen offset:1024 sc1
    v_cvt_pk_bf16_f32 v72, v48, v49
    v_exp_f32 v52, v52
    buffer_load_dwordx4 a[104:107], v2, s[12:15], s3 offen offset:0 sc1
    v_exp_f32 v53, v53
    v_cvt_pk_bf16_f32 v73, v50, v51
    buffer_load_dwordx4 a[108:111], v2, s[12:15], s3 offen offset:1024 sc1
    v_mfma_f32_32x32x16_bf16 v[80:95], a[24:27], v[64:67], v[80:95]
    v_exp_f32 v54, v54
    v_exp_f32 v55, v55
    buffer_load_dwordx4 a[8:11], v2, s[12:15], s28 offen offset:2048 sc1
    v_cvt_pk_bf16_f32 v74, v52, v53
    v_exp_f32 v56, v56
    v_mfma_f32_32x32x16_bf16 v[80:95], a[28:31], v[68:71], v[80:95]
    v_exp_f32 v57, v57
    v_cvt_pk_bf16_f32 v75, v54, v55
    v_exp_f32 v58, v58
    v_exp_f32 v59, v59
    v_cvt_pk_bf16_f32 v76, v56, v57
    v_mfma_f32_16x16x32_bf16 v[112:115], v[144:147], v[64:67], v[112:115]
    v_exp_f32 v60, v60
    v_exp_f32 v61, v61
    v_cvt_pk_bf16_f32 v77, v58, v59
    v_exp_f32 v62, v62
    buffer_load_dwordx4 a[12:15], v2, s[12:15], s28 offen offset:3072 sc1
    v_mfma_f32_16x16x32_bf16 v[112:115], v[144:147], v[68:71], v[112:115]
    v_exp_f32 v63, v63
    v_cvt_pk_bf16_f32 v78, v60, v61
    v_cvt_pk_bf16_f32 v79, v62, v63
    v_mfma_f32_32x32x16_bf16 v[48:63], a[32:35], v[16:19], 0
    v_exp_f32 v32, v32
    v_exp_f32 v33, v33
    v_exp_f32 v34, v34
    v_mfma_f32_32x32x16_bf16 v[48:63], a[36:39], v[20:23], v[48:63]
    v_exp_f32 v35, v35
    v_cvt_pk_bf16_f32 v64, v32, v33
    v_exp_f32 v36, v36
    v_exp_f32 v37, v37
    v_cvt_pk_bf16_f32 v65, v34, v35
    v_mfma_f32_32x32x16_bf16 v[96:111], a[24:27], v[72:75], v[96:111]
    v_exp_f32 v38, v38
    v_exp_f32 v39, v39
    buffer_load_dwordx4 a[32:35], v2, s[8:11], s36 offen offset:0 sc1
    v_cvt_pk_bf16_f32 v66, v36, v37
    v_exp_f32 v40, v40
    v_mfma_f32_32x32x16_bf16 v[96:111], a[28:31], v[76:79], v[96:111]
    v_exp_f32 v41, v41
    v_cvt_pk_bf16_f32 v67, v38, v39
    v_exp_f32 v42, v42
    v_exp_f32 v43, v43
    v_cvt_pk_bf16_f32 v68, v40, v41
    v_mfma_f32_16x16x32_bf16 v[128:131], v[144:147], v[72:75], v[128:131]
    v_exp_f32 v44, v44
    v_exp_f32 v45, v45
    v_cvt_pk_bf16_f32 v69, v42, v43
    v_exp_f32 v46, v46
    buffer_load_dwordx4 a[36:39], v2, s[8:11], s36 offen offset:1024 sc1
    v_mfma_f32_16x16x32_bf16 v[128:131], v[144:147], v[76:79], v[128:131]
    v_exp_f32 v47, v47
    v_cvt_pk_bf16_f32 v70, v44, v45
    v_cvt_pk_bf16_f32 v71, v46, v47
    s_waitcnt vmcnt(26)
    v_mfma_f32_32x32x16_bf16 v[32:47], a[48:51], v[8:11], 0
    v_exp_f32 v48, v48
    v_exp_f32 v49, v49
    v_exp_f32 v50, v50
    v_mfma_f32_32x32x16_bf16 v[32:47], a[52:55], v[12:15], v[32:47]
    v_exp_f32 v51, v51
    v_cvt_pk_bf16_f32 v72, v48, v49
    v_exp_f32 v52, v52
    v_exp_f32 v53, v53
    v_cvt_pk_bf16_f32 v73, v50, v51
    v_mfma_f32_32x32x16_bf16 v[80:95], a[40:43], v[64:67], v[80:95]
    v_exp_f32 v54, v54
    v_exp_f32 v55, v55
    buffer_load_dwordx4 a[24:27], v2, s[12:15], s36 offen offset:0 sc1
    v_cvt_pk_bf16_f32 v74, v52, v53
    v_exp_f32 v56, v56
    v_mfma_f32_32x32x16_bf16 v[80:95], a[44:47], v[68:71], v[80:95]
    v_exp_f32 v57, v57
    v_cvt_pk_bf16_f32 v75, v54, v55
    v_exp_f32 v58, v58
    v_exp_f32 v59, v59
    v_cvt_pk_bf16_f32 v76, v56, v57
    v_mfma_f32_16x16x32_bf16 v[112:115], v[144:147], v[64:67], v[112:115]
    v_exp_f32 v60, v60
    v_exp_f32 v61, v61
    v_cvt_pk_bf16_f32 v77, v58, v59
    v_exp_f32 v62, v62
    buffer_load_dwordx4 a[28:31], v2, s[12:15], s36 offen offset:1024 sc1
    v_mfma_f32_16x16x32_bf16 v[112:115], v[144:147], v[68:71], v[112:115]
    v_exp_f32 v63, v63
    v_cvt_pk_bf16_f32 v78, v60, v61
    v_cvt_pk_bf16_f32 v79, v62, v63
    v_mfma_f32_32x32x16_bf16 v[48:63], a[48:51], v[16:19], 0
    v_exp_f32 v32, v32
    v_exp_f32 v33, v33
    v_exp_f32 v34, v34
    v_mfma_f32_32x32x16_bf16 v[48:63], a[52:55], v[20:23], v[48:63]
    v_exp_f32 v35, v35
    v_cvt_pk_bf16_f32 v64, v32, v33
    v_exp_f32 v36, v36
    v_exp_f32 v37, v37
    v_cvt_pk_bf16_f32 v65, v34, v35
    v_mfma_f32_32x32x16_bf16 v[96:111], a[40:43], v[72:75], v[96:111]
    v_exp_f32 v38, v38
    v_exp_f32 v39, v39
    buffer_load_dwordx4 a[48:51], v2, s[8:11], s36 offen offset:2048 sc1
    v_cvt_pk_bf16_f32 v66, v36, v37
    v_exp_f32 v40, v40
    v_mfma_f32_32x32x16_bf16 v[96:111], a[44:47], v[76:79], v[96:111]
    v_exp_f32 v41, v41
    v_cvt_pk_bf16_f32 v67, v38, v39
    v_exp_f32 v42, v42
    v_exp_f32 v43, v43
    v_cvt_pk_bf16_f32 v68, v40, v41
    v_mfma_f32_16x16x32_bf16 v[128:131], v[144:147], v[72:75], v[128:131]
    v_exp_f32 v44, v44
    v_exp_f32 v45, v45
    v_cvt_pk_bf16_f32 v69, v42, v43
    v_exp_f32 v46, v46
    buffer_load_dwordx4 a[52:55], v2, s[8:11], s36 offen offset:3072 sc1
    v_mfma_f32_16x16x32_bf16 v[128:131], v[144:147], v[76:79], v[128:131]
    v_exp_f32 v47, v47
    v_cvt_pk_bf16_f32 v70, v44, v45
    v_cvt_pk_bf16_f32 v71, v46, v47
    s_waitcnt vmcnt(26)
    v_mfma_f32_32x32x16_bf16 v[32:47], a[64:67], v[8:11], 0
    v_exp_f32 v48, v48
    v_exp_f32 v49, v49
    v_exp_f32 v50, v50
    v_mfma_f32_32x32x16_bf16 v[32:47], a[68:71], v[12:15], v[32:47]
    v_exp_f32 v51, v51
    v_cvt_pk_bf16_f32 v72, v48, v49
    v_exp_f32 v52, v52
    v_exp_f32 v53, v53
    v_cvt_pk_bf16_f32 v73, v50, v51
    v_mfma_f32_32x32x16_bf16 v[80:95], a[56:59], v[64:67], v[80:95]
    v_exp_f32 v54, v54
    v_exp_f32 v55, v55
    buffer_load_dwordx4 a[40:43], v2, s[12:15], s36 offen offset:2048 sc1
    v_cvt_pk_bf16_f32 v74, v52, v53
    v_exp_f32 v56, v56
    v_mfma_f32_32x32x16_bf16 v[80:95], a[60:63], v[68:71], v[80:95]
    v_exp_f32 v57, v57
    v_cvt_pk_bf16_f32 v75, v54, v55
    v_exp_f32 v58, v58
    v_exp_f32 v59, v59
    v_cvt_pk_bf16_f32 v76, v56, v57
    v_mfma_f32_16x16x32_bf16 v[112:115], v[144:147], v[64:67], v[112:115]
    v_exp_f32 v60, v60
    v_exp_f32 v61, v61
    v_cvt_pk_bf16_f32 v77, v58, v59
    v_exp_f32 v62, v62
    buffer_load_dwordx4 a[44:47], v2, s[12:15], s36 offen offset:3072 sc1
    v_mfma_f32_16x16x32_bf16 v[112:115], v[144:147], v[68:71], v[112:115]
    v_exp_f32 v63, v63
    v_cvt_pk_bf16_f32 v78, v60, v61
    v_cvt_pk_bf16_f32 v79, v62, v63
    v_mfma_f32_32x32x16_bf16 v[48:63], a[64:67], v[16:19], 0
    v_exp_f32 v32, v32
    v_exp_f32 v33, v33
    v_exp_f32 v34, v34
    v_mfma_f32_32x32x16_bf16 v[48:63], a[68:71], v[20:23], v[48:63]
    v_exp_f32 v35, v35
    v_cvt_pk_bf16_f32 v64, v32, v33
    v_exp_f32 v36, v36
    v_exp_f32 v37, v37
    v_cvt_pk_bf16_f32 v65, v34, v35
    v_mfma_f32_32x32x16_bf16 v[96:111], a[56:59], v[72:75], v[96:111]
    v_exp_f32 v38, v38
    v_exp_f32 v39, v39
    buffer_load_dwordx4 a[64:67], v2, s[8:11], s37 offen offset:0 sc1
    v_cvt_pk_bf16_f32 v66, v36, v37
    v_exp_f32 v40, v40
    v_mfma_f32_32x32x16_bf16 v[96:111], a[60:63], v[76:79], v[96:111]
    v_exp_f32 v41, v41
    v_cvt_pk_bf16_f32 v67, v38, v39
    v_exp_f32 v42, v42
    v_exp_f32 v43, v43
    v_cvt_pk_bf16_f32 v68, v40, v41
    v_mfma_f32_16x16x32_bf16 v[128:131], v[144:147], v[72:75], v[128:131]
    v_exp_f32 v44, v44
    v_exp_f32 v45, v45
    v_cvt_pk_bf16_f32 v69, v42, v43
    v_exp_f32 v46, v46
    buffer_load_dwordx4 a[68:71], v2, s[8:11], s37 offen offset:1024 sc1
    v_mfma_f32_16x16x32_bf16 v[128:131], v[144:147], v[76:79], v[128:131]
    v_exp_f32 v47, v47
    v_cvt_pk_bf16_f32 v70, v44, v45
    v_cvt_pk_bf16_f32 v71, v46, v47
    s_waitcnt vmcnt(24)
    v_mfma_f32_32x32x16_bf16 v[32:47], a[80:83], v[8:11], 0
    v_exp_f32 v48, v48
    v_exp_f32 v49, v49
    v_exp_f32 v50, v50
    v_mfma_f32_32x32x16_bf16 v[32:47], a[84:87], v[12:15], v[32:47]
    v_exp_f32 v51, v51
    v_cvt_pk_bf16_f32 v72, v48, v49
    v_exp_f32 v52, v52
    v_exp_f32 v53, v53
    v_cvt_pk_bf16_f32 v73, v50, v51
    v_mfma_f32_32x32x16_bf16 v[80:95], a[72:75], v[64:67], v[80:95]
    v_exp_f32 v54, v54
    v_exp_f32 v55, v55
    buffer_load_dwordx4 a[56:59], v2, s[12:15], s37 offen offset:0 sc1
    v_cvt_pk_bf16_f32 v74, v52, v53
    v_exp_f32 v56, v56
    v_mfma_f32_32x32x16_bf16 v[80:95], a[76:79], v[68:71], v[80:95]
    v_exp_f32 v57, v57
    v_cvt_pk_bf16_f32 v75, v54, v55
    v_exp_f32 v58, v58
    v_exp_f32 v59, v59
    v_cvt_pk_bf16_f32 v76, v56, v57
    v_mfma_f32_16x16x32_bf16 v[112:115], v[144:147], v[64:67], v[112:115]
    v_exp_f32 v60, v60
    v_exp_f32 v61, v61
    v_cvt_pk_bf16_f32 v77, v58, v59
    v_exp_f32 v62, v62
    buffer_load_dwordx4 a[60:63], v2, s[12:15], s37 offen offset:1024 sc1
    v_mfma_f32_16x16x32_bf16 v[112:115], v[144:147], v[68:71], v[112:115]
    v_exp_f32 v63, v63
    v_cvt_pk_bf16_f32 v78, v60, v61
    v_cvt_pk_bf16_f32 v79, v62, v63
    v_mfma_f32_32x32x16_bf16 v[48:63], a[80:83], v[16:19], 0
    v_exp_f32 v32, v32
    v_exp_f32 v33, v33
    v_exp_f32 v34, v34
    v_mfma_f32_32x32x16_bf16 v[48:63], a[84:87], v[20:23], v[48:63]
    v_exp_f32 v35, v35
    v_cvt_pk_bf16_f32 v64, v32, v33
    v_exp_f32 v36, v36
    v_exp_f32 v37, v37
    v_cvt_pk_bf16_f32 v65, v34, v35
    v_mfma_f32_32x32x16_bf16 v[96:111], a[72:75], v[72:75], v[96:111]
    v_exp_f32 v38, v38
    v_exp_f32 v39, v39
    buffer_load_dwordx4 a[80:83], v2, s[8:11], s37 offen offset:2048 sc1
    v_cvt_pk_bf16_f32 v66, v36, v37
    v_exp_f32 v40, v40
    v_mfma_f32_32x32x16_bf16 v[96:111], a[76:79], v[76:79], v[96:111]
    v_exp_f32 v41, v41
    v_cvt_pk_bf16_f32 v67, v38, v39
    v_exp_f32 v42, v42
    v_exp_f32 v43, v43
    v_cvt_pk_bf16_f32 v68, v40, v41
    v_mfma_f32_16x16x32_bf16 v[128:131], v[144:147], v[72:75], v[128:131]
    v_exp_f32 v44, v44
    v_exp_f32 v45, v45
    v_cvt_pk_bf16_f32 v69, v42, v43
    v_exp_f32 v46, v46
    buffer_load_dwordx4 a[84:87], v2, s[8:11], s37 offen offset:3072 sc1
    v_mfma_f32_16x16x32_bf16 v[128:131], v[144:147], v[76:79], v[128:131]
    v_exp_f32 v47, v47
    v_cvt_pk_bf16_f32 v70, v44, v45
    v_cvt_pk_bf16_f32 v71, v46, v47
    s_waitcnt vmcnt(22)
    v_mfma_f32_32x32x16_bf16 v[32:47], a[96:99], v[8:11], 0
    v_exp_f32 v48, v48
    v_exp_f32 v49, v49
    v_exp_f32 v50, v50
    v_mfma_f32_32x32x16_bf16 v[32:47], a[100:103], v[12:15], v[32:47]
    v_exp_f32 v51, v51
    v_cvt_pk_bf16_f32 v72, v48, v49
    v_exp_f32 v52, v52
    v_exp_f32 v53, v53
    v_cvt_pk_bf16_f32 v73, v50, v51
    v_mfma_f32_32x32x16_bf16 v[80:95], a[88:91], v[64:67], v[80:95]
    v_exp_f32 v54, v54
    v_exp_f32 v55, v55
    buffer_load_dwordx4 a[72:75], v2, s[12:15], s37 offen offset:2048 sc1
    v_cvt_pk_bf16_f32 v74, v52, v53
    v_exp_f32 v56, v56
    v_mfma_f32_32x32x16_bf16 v[80:95], a[92:95], v[68:71], v[80:95]
    v_exp_f32 v57, v57
    v_cvt_pk_bf16_f32 v75, v54, v55
    v_exp_f32 v58, v58
    v_exp_f32 v59, v59
    v_cvt_pk_bf16_f32 v76, v56, v57
    v_mfma_f32_16x16x32_bf16 v[112:115], v[144:147], v[64:67], v[112:115]
    v_exp_f32 v60, v60
    v_exp_f32 v61, v61
    v_cvt_pk_bf16_f32 v77, v58, v59
    v_exp_f32 v62, v62
    buffer_load_dwordx4 a[76:79], v2, s[12:15], s37 offen offset:3072 sc1
    v_mfma_f32_16x16x32_bf16 v[112:115], v[144:147], v[68:71], v[112:115]
    v_exp_f32 v63, v63
    v_cvt_pk_bf16_f32 v78, v60, v61
    v_cvt_pk_bf16_f32 v79, v62, v63
    v_mfma_f32_32x32x16_bf16 v[48:63], a[96:99], v[16:19], 0
    v_exp_f32 v32, v32
    v_exp_f32 v33, v33
    v_exp_f32 v34, v34
    v_mfma_f32_32x32x16_bf16 v[48:63], a[100:103], v[20:23], v[48:63]
    v_exp_f32 v35, v35
    v_cvt_pk_bf16_f32 v64, v32, v33
    v_exp_f32 v36, v36
    v_exp_f32 v37, v37
    v_cvt_pk_bf16_f32 v65, v34, v35
    v_mfma_f32_32x32x16_bf16 v[96:111], a[88:91], v[72:75], v[96:111]
    v_exp_f32 v38, v38
    v_exp_f32 v39, v39
    buffer_load_dwordx4 a[96:99], v2, s[8:11], s38 offen offset:0 sc1
    v_cvt_pk_bf16_f32 v66, v36, v37
    v_exp_f32 v40, v40
    v_mfma_f32_32x32x16_bf16 v[96:111], a[92:95], v[76:79], v[96:111]
    v_exp_f32 v41, v41
    v_cvt_pk_bf16_f32 v67, v38, v39
    v_exp_f32 v42, v42
    v_exp_f32 v43, v43
    v_cvt_pk_bf16_f32 v68, v40, v41
    v_mfma_f32_16x16x32_bf16 v[128:131], v[144:147], v[72:75], v[128:131]
    v_exp_f32 v44, v44
    v_exp_f32 v45, v45
    v_cvt_pk_bf16_f32 v69, v42, v43
    v_exp_f32 v46, v46
    buffer_load_dwordx4 a[100:103], v2, s[8:11], s38 offen offset:1024 sc1
    v_mfma_f32_16x16x32_bf16 v[128:131], v[144:147], v[76:79], v[128:131]
    v_exp_f32 v47, v47
    v_cvt_pk_bf16_f32 v70, v44, v45
    v_cvt_pk_bf16_f32 v71, v46, v47
    s_waitcnt vmcnt(20)
    v_mfma_f32_32x32x16_bf16 v[32:47], a[112:115], v[8:11], 0
    v_exp_f32 v48, v48
    v_exp_f32 v49, v49
    v_exp_f32 v50, v50
    v_mfma_f32_32x32x16_bf16 v[32:47], a[116:119], v[12:15], v[32:47]
    v_exp_f32 v51, v51
    v_cvt_pk_bf16_f32 v72, v48, v49
    v_exp_f32 v52, v52
    v_exp_f32 v53, v53
    v_cvt_pk_bf16_f32 v73, v50, v51
    v_mfma_f32_32x32x16_bf16 v[80:95], a[104:107], v[64:67], v[80:95]
    v_exp_f32 v54, v54
    v_exp_f32 v55, v55
    buffer_load_dwordx4 a[88:91], v2, s[12:15], s38 offen offset:0 sc1
    v_cvt_pk_bf16_f32 v74, v52, v53
    v_exp_f32 v56, v56
    v_mfma_f32_32x32x16_bf16 v[80:95], a[108:111], v[68:71], v[80:95]
    v_exp_f32 v57, v57
    v_cvt_pk_bf16_f32 v75, v54, v55
    v_exp_f32 v58, v58
    v_exp_f32 v59, v59
    v_cvt_pk_bf16_f32 v76, v56, v57
    v_mfma_f32_16x16x32_bf16 v[112:115], v[144:147], v[64:67], v[112:115]
    v_exp_f32 v60, v60
    v_exp_f32 v61, v61
    v_cvt_pk_bf16_f32 v77, v58, v59
    v_exp_f32 v62, v62
    buffer_load_dwordx4 a[92:95], v2, s[12:15], s38 offen offset:1024 sc1
    v_mfma_f32_16x16x32_bf16 v[112:115], v[144:147], v[68:71], v[112:115]
    v_exp_f32 v63, v63
    v_cvt_pk_bf16_f32 v78, v60, v61
    v_cvt_pk_bf16_f32 v79, v62, v63
    v_mfma_f32_32x32x16_bf16 v[48:63], a[112:115], v[16:19], 0
    v_exp_f32 v32, v32
    v_exp_f32 v33, v33
    v_exp_f32 v34, v34
    v_mfma_f32_32x32x16_bf16 v[48:63], a[116:119], v[20:23], v[48:63]
    v_exp_f32 v35, v35
    v_cvt_pk_bf16_f32 v64, v32, v33
    v_exp_f32 v36, v36
    v_exp_f32 v37, v37
    v_cvt_pk_bf16_f32 v65, v34, v35
    v_mfma_f32_32x32x16_bf16 v[96:111], a[104:107], v[72:75], v[96:111]
    v_exp_f32 v38, v38
    v_exp_f32 v39, v39
    buffer_load_dwordx4 a[112:115], v2, s[8:11], s38 offen offset:2048 sc1
    v_cvt_pk_bf16_f32 v66, v36, v37
    v_exp_f32 v40, v40
    v_mfma_f32_32x32x16_bf16 v[96:111], a[108:111], v[76:79], v[96:111]
    v_exp_f32 v41, v41
    v_cvt_pk_bf16_f32 v67, v38, v39
    v_exp_f32 v42, v42
    v_exp_f32 v43, v43
    v_cvt_pk_bf16_f32 v68, v40, v41
    v_mfma_f32_16x16x32_bf16 v[128:131], v[144:147], v[72:75], v[128:131]
    v_exp_f32 v44, v44
    v_exp_f32 v45, v45
    v_cvt_pk_bf16_f32 v69, v42, v43
    v_exp_f32 v46, v46
    buffer_load_dwordx4 a[116:119], v2, s[8:11], s38 offen offset:3072 sc1
    v_mfma_f32_16x16x32_bf16 v[128:131], v[144:147], v[76:79], v[128:131]
    v_exp_f32 v47, v47
    v_cvt_pk_bf16_f32 v70, v44, v45
    v_cvt_pk_bf16_f32 v71, v46, v47
    s_waitcnt vmcnt(34)
    v_mfma_f32_32x32x16_bf16 v[32:47], a[0:3], v[8:11], 0
    v_exp_f32 v48, v48
    v_exp_f32 v49, v49
    v_exp_f32 v50, v50
    v_mfma_f32_32x32x16_bf16 v[32:47], a[4:7], v[12:15], v[32:47]
    v_exp_f32 v51, v51
    v_cvt_pk_bf16_f32 v72, v48, v49
    v_exp_f32 v52, v52
    v_exp_f32 v53, v53
    v_cvt_pk_bf16_f32 v73, v50, v51
    v_mfma_f32_32x32x16_bf16 v[80:95], a[120:123], v[64:67], v[80:95]
    v_exp_f32 v54, v54
    v_exp_f32 v55, v55
    buffer_load_dwordx4 a[104:107], v2, s[12:15], s38 offen offset:2048 sc1
    v_cvt_pk_bf16_f32 v74, v52, v53
    v_exp_f32 v56, v56
    v_mfma_f32_32x32x16_bf16 v[80:95], a[124:127], v[68:71], v[80:95]
    v_exp_f32 v57, v57
    v_cvt_pk_bf16_f32 v75, v54, v55
    v_exp_f32 v58, v58
    v_exp_f32 v59, v59
    v_cvt_pk_bf16_f32 v76, v56, v57
    v_mfma_f32_16x16x32_bf16 v[112:115], v[144:147], v[64:67], v[112:115]
    v_exp_f32 v60, v60
    v_exp_f32 v61, v61
    v_cvt_pk_bf16_f32 v77, v58, v59
    v_exp_f32 v62, v62
    buffer_load_dwordx4 a[108:111], v2, s[12:15], s38 offen offset:3072 sc1
    v_mfma_f32_16x16x32_bf16 v[112:115], v[144:147], v[68:71], v[112:115]
    v_exp_f32 v63, v63
    v_cvt_pk_bf16_f32 v78, v60, v61
    v_cvt_pk_bf16_f32 v79, v62, v63
    s_add_u32 s28, s28, 16384
.p2align 6
L_p2_loop:
    v_mfma_f32_32x32x16_bf16 v[48:63], a[0:3], v[16:19], 0
    v_exp_f32 v32, v32
    s_add_u32 s36, s28, 4096
    s_add_u32 s37, s28, 8192
    s_add_u32 s38, s28, 12288
    v_exp_f32 v33, v33
    v_exp_f32 v34, v34
    buffer_load_dword v231, off, s[24:27], s101 sc1
    v_mfma_f32_32x32x16_bf16 v[48:63], a[4:7], v[20:23], v[48:63]
    v_exp_f32 v35, v35
    v_cvt_pk_bf16_f32 v64, v32, v33
    v_exp_f32 v36, v36
    v_exp_f32 v37, v37
    v_cvt_pk_bf16_f32 v65, v34, v35
    v_mfma_f32_32x32x16_bf16 v[96:111], a[120:123], v[72:75], v[96:111]
    v_exp_f32 v38, v38
    v_exp_f32 v39, v39
    buffer_load_dwordx4 a[0:3], v2, s[8:11], s28 offen offset:0 sc1
    v_cvt_pk_bf16_f32 v66, v36, v37
    v_exp_f32 v40, v40
    v_mfma_f32_32x32x16_bf16 v[96:111], a[124:127], v[76:79], v[96:111]
    v_exp_f32 v41, v41
    v_cvt_pk_bf16_f32 v67, v38, v39
    v_exp_f32 v42, v42
    v_exp_f32 v43, v43
    v_cvt_pk_bf16_f32 v68, v40, v41
    v_mfma_f32_16x16x32_bf16 v[128:131], v[144:147], v[72:75], v[128:131]
    v_exp_f32 v44, v44
    v_exp_f32 v45, v45
    v_cvt_pk_bf16_f32 v69, v42, v43
    v_exp_f32 v46, v46
    buffer_load_dwordx4 a[4:7], v2, s[8:11], s28 offen offset:1024 sc1
    v_mfma_f32_16x16x32_bf16 v[128:131], v[144:147], v[76:79], v[128:131]
    v_exp_f32 v47, v47
    v_cvt_pk_bf16_f32 v70, v44, v45
    v_cvt_pk_bf16_f32 v71, v46, v47
    s_waitcnt vmcnt(27)
    v_mfma_f32_32x32x16_bf16 v[32:47], a[16:19], v[8:11], 0
    v_exp_f32 v48, v48
    v_exp_f32 v49, v49
    v_exp_f32 v50, v50
    v_mfma_f32_32x32x16_bf16 v[32:47], a[20:23], v[12:15], v[32:47]
    v_exp_f32 v51, v51
    v_cvt_pk_bf16_f32 v72, v48, v49
    v_exp_f32 v52, v52
    v_exp_f32 v53, v53
    v_cvt_pk_bf16_f32 v73, v50, v51
    v_mfma_f32_32x32x16_bf16 v[80:95], a[8:11], v[64:67], v[80:95]
    v_exp_f32 v54, v54
    v_exp_f32 v55, v55
    buffer_load_dwordx4 a[120:123], v2, s[12:15], s28 offen offset:0 sc1
    v_cvt_pk_bf16_f32 v74, v52, v53
    v_exp_f32 v56, v56
    v_mfma_f32_32x32x16_bf16 v[80:95], a[12:15], v[68:71], v[80:95]
    v_exp_f32 v57, v57
    v_cvt_pk_bf16_f32 v75, v54, v55
    v_exp_f32 v58, v58
    v_exp_f32 v59, v59
    v_cvt_pk_bf16_f32 v76, v56, v57
    v_mfma_f32_16x16x32_bf16 v[112:115], v[144:147], v[64:67], v[112:115]
    v_exp_f32 v60, v60
    v_exp_f32 v61, v61
    v_cvt_pk_bf16_f32 v77, v58, v59
    v_exp_f32 v62, v62
    buffer_load_dwordx4 a[124:127], v2, s[12:15], s28 offen offset:1024 sc1
    v_mfma_f32_16x16x32_bf16 v[112:115], v[144:147], v[68:71], v[112:115]
    v_exp_f32 v63, v63
    v_cvt_pk_bf16_f32 v78, v60, v61
    v_cvt_pk_bf16_f32 v79, v62, v63
    v_mfma_f32_32x32x16_bf16 v[48:63], a[16:19], v[16:19], 0
    v_exp_f32 v32, v32
    v_exp_f32 v33, v33
    v_exp_f32 v34, v34
    v_mfma_f32_32x32x16_bf16 v[48:63], a[20:23], v[20:23], v[48:63]
    v_exp_f32 v35, v35
    v_cvt_pk_bf16_f32 v64, v32, v33
    v_exp_f32 v36, v36
    v_exp_f32 v37, v37
    v_cvt_pk_bf16_f32 v65, v34, v35
    v_mfma_f32_32x32x16_bf16 v[96:111], a[8:11], v[72:75], v[96:111]
    v_exp_f32 v38, v38
    v_exp_f32 v39, v39
    buffer_load_dwordx4 a[16:19], v2, s[8:11], s28 offen offset:2048 sc1
    v_cvt_pk_bf16_f32 v66, v36, v37
    v_exp_f32 v40, v40
    v_mfma_f32_32x32x16_bf16 v[96:111], a[12:15], v[76:79], v[96:111]
    v_exp_f32 v41, v41
    v_cvt_pk_bf16_f32 v67, v38, v39
    v_exp_f32 v42, v42
    v_exp_f32 v43, v43
    v_cvt_pk_bf16_f32 v68, v40, v41
    v_mfma_f32_16x16x32_bf16 v[128:131], v[144:147], v[72:75], v[128:131]
    v_exp_f32 v44, v44
    v_exp_f32 v45, v45
    v_cvt_pk_bf16_f32 v69, v42, v43
    v_exp_f32 v46, v46
    buffer_load_dwordx4 a[20:23], v2, s[8:11], s28 offen offset:3072 sc1
    v_mfma_f32_16x16x32_bf16 v[128:131], v[144:147], v[76:79], v[128:131]
    v_exp_f32 v47, v47
    v_cvt_pk_bf16_f32 v70, v44, v45
    v_cvt_pk_bf16_f32 v71, v46, v47
    s_waitcnt vmcnt(27)
    v_mfma_f32_32x32x16_bf16 v[32:47], a[32:35], v[8:11], 0
    v_exp_f32 v48, v48
    v_exp_f32 v49, v49
    v_exp_f32 v50, v50
    v_mfma_f32_32x32x16_bf16 v[32:47], a[36:39], v[12:15], v[32:47]
    v_exp_f32 v51, v51
    v_cvt_pk_bf16_f32 v72, v48, v49
    v_exp_f32 v52, v52
    v_exp_f32 v53, v53
    v_cvt_pk_bf16_f32 v73, v50, v51
    v_mfma_f32_32x32x16_bf16 v[80:95], a[24:27], v[64:67], v[80:95]
    v_exp_f32 v54, v54
    v_exp_f32 v55, v55
    buffer_load_dwordx4 a[8:11], v2, s[12:15], s28 offen offset:2048 sc1
    v_cvt_pk_bf16_f32 v74, v52, v53
    v_exp_f32 v56, v56
    v_mfma_f32_32x32x16_bf16 v[80:95], a[28:31], v[68:71], v[80:95]
    v_exp_f32 v57, v57
    v_cvt_pk_bf16_f32 v75, v54, v55
    v_exp_f32 v58, v58
    v_exp_f32 v59, v59
    v_cvt_pk_bf16_f32 v76, v56, v57
    v_mfma_f32_16x16x32_bf16 v[112:115], v[144:147], v[64:67], v[112:115]
    v_exp_f32 v60, v60
    v_exp_f32 v61, v61
    v_cvt_pk_bf16_f32 v77, v58, v59
    v_exp_f32 v62, v62
    buffer_load_dwordx4 a[12:15], v2, s[12:15], s28 offen offset:3072 sc1
    v_mfma_f32_16x16x32_bf16 v[112:115], v[144:147], v[68:71], v[112:115]
    v_exp_f32 v63, v63
    v_cvt_pk_bf16_f32 v78, v60, v61
    v_cvt_pk_bf16_f32 v79, v62, v63
    v_mfma_f32_32x32x16_bf16 v[48:63], a[32:35], v[16:19], 0
    v_exp_f32 v32, v32
    v_exp_f32 v33, v33
    v_exp_f32 v34, v34
    v_mfma_f32_32x32x16_bf16 v[48:63], a[36:39], v[20:23], v[48:63]
    v_exp_f32 v35, v35
    v_cvt_pk_bf16_f32 v64, v32, v33
    v_exp_f32 v36, v36
    v_exp_f32 v37, v37
    v_cvt_pk_bf16_f32 v65, v34, v35
    v_mfma_f32_32x32x16_bf16 v[96:111], a[24:27], v[72:75], v[96:111]
    v_exp_f32 v38, v38
    v_exp_f32 v39, v39
    buffer_load_dwordx4 a[32:35], v2, s[8:11], s36 offen offset:0 sc1
    v_cvt_pk_bf16_f32 v66, v36, v37
    v_exp_f32 v40, v40
    v_mfma_f32_32x32x16_bf16 v[96:111], a[28:31], v[76:79], v[96:111]
    v_exp_f32 v41, v41
    v_cvt_pk_bf16_f32 v67, v38, v39
    v_exp_f32 v42, v42
    v_exp_f32 v43, v43
    v_cvt_pk_bf16_f32 v68, v40, v41
    v_mfma_f32_16x16x32_bf16 v[128:131], v[144:147], v[72:75], v[128:131]
    v_exp_f32 v44, v44
    v_exp_f32 v45, v45
    v_cvt_pk_bf16_f32 v69, v42, v43
    v_exp_f32 v46, v46
    buffer_load_dwordx4 a[36:39], v2, s[8:11], s36 offen offset:1024 sc1
    v_mfma_f32_16x16x32_bf16 v[128:131], v[144:147], v[76:79], v[128:131]
    v_exp_f32 v47, v47
    v_cvt_pk_bf16_f32 v70, v44, v45
    v_cvt_pk_bf16_f32 v71, v46, v47
    s_waitcnt vmcnt(27)
    v_mfma_f32_32x32x16_bf16 v[32:47], a[48:51], v[8:11], 0
    v_exp_f32 v48, v48
    v_exp_f32 v49, v49
    v_exp_f32 v50, v50
    v_mfma_f32_32x32x16_bf16 v[32:47], a[52:55], v[12:15], v[32:47]
    v_exp_f32 v51, v51
    v_cvt_pk_bf16_f32 v72, v48, v49
    v_exp_f32 v52, v52
    v_exp_f32 v53, v53
    v_cvt_pk_bf16_f32 v73, v50, v51
    v_mfma_f32_32x32x16_bf16 v[80:95], a[40:43], v[64:67], v[80:95]
    v_exp_f32 v54, v54
    v_exp_f32 v55, v55
    buffer_load_dwordx4 a[24:27], v2, s[12:15], s36 offen offset:0 sc1
    v_cvt_pk_bf16_f32 v74, v52, v53
    v_exp_f32 v56, v56
    v_mfma_f32_32x32x16_bf16 v[80:95], a[44:47], v[68:71], v[80:95]
    v_exp_f32 v57, v57
    v_cvt_pk_bf16_f32 v75, v54, v55
    v_exp_f32 v58, v58
    v_exp_f32 v59, v59
    v_cvt_pk_bf16_f32 v76, v56, v57
    v_mfma_f32_16x16x32_bf16 v[112:115], v[144:147], v[64:67], v[112:115]
    v_exp_f32 v60, v60
    v_exp_f32 v61, v61
    v_cvt_pk_bf16_f32 v77, v58, v59
    v_exp_f32 v62, v62
    buffer_load_dwordx4 a[28:31], v2, s[12:15], s36 offen offset:1024 sc1
    v_mfma_f32_16x16x32_bf16 v[112:115], v[144:147], v[68:71], v[112:115]
    v_exp_f32 v63, v63
    v_cvt_pk_bf16_f32 v78, v60, v61
    v_cvt_pk_bf16_f32 v79, v62, v63
    v_mfma_f32_32x32x16_bf16 v[48:63], a[48:51], v[16:19], 0
    v_exp_f32 v32, v32
    v_exp_f32 v33, v33
    v_exp_f32 v34, v34
    v_mfma_f32_32x32x16_bf16 v[48:63], a[52:55], v[20:23], v[48:63]
    v_exp_f32 v35, v35
    v_cvt_pk_bf16_f32 v64, v32, v33
    v_exp_f32 v36, v36
    v_exp_f32 v37, v37
    v_cvt_pk_bf16_f32 v65, v34, v35
    v_mfma_f32_32x32x16_bf16 v[96:111], a[40:43], v[72:75], v[96:111]
    v_exp_f32 v38, v38
    v_exp_f32 v39, v39
    buffer_load_dwordx4 a[48:51], v2, s[8:11], s36 offen offset:2048 sc1
    v_cvt_pk_bf16_f32 v66, v36, v37
    v_exp_f32 v40, v40
    v_mfma_f32_32x32x16_bf16 v[96:111], a[44:47], v[76:79], v[96:111]
    v_exp_f32 v41, v41
    v_cvt_pk_bf16_f32 v67, v38, v39
    v_exp_f32 v42, v42
    v_exp_f32 v43, v43
    v_cvt_pk_bf16_f32 v68, v40, v41
    v_mfma_f32_16x16x32_bf16 v[128:131], v[144:147], v[72:75], v[128:131]
    v_exp_f32 v44, v44
    v_exp_f32 v45, v45
    v_cvt_pk_bf16_f32 v69, v42, v43
    v_exp_f32 v46, v46
    buffer_load_dwordx4 a[52:55], v2, s[8:11], s36 offen offset:3072 sc1
    v_mfma_f32_16x16x32_bf16 v[128:131], v[144:147], v[76:79], v[128:131]
    v_exp_f32 v47, v47
    v_cvt_pk_bf16_f32 v70, v44, v45
    v_cvt_pk_bf16_f32 v71, v46, v47
    s_waitcnt vmcnt(27)
    v_mfma_f32_32x32x16_bf16 v[32:47], a[64:67], v[8:11], 0
    v_exp_f32 v48, v48
    v_exp_f32 v49, v49
    v_exp_f32 v50, v50
    v_mfma_f32_32x32x16_bf16 v[32:47], a[68:71], v[12:15], v[32:47]
    v_exp_f32 v51, v51
    v_cvt_pk_bf16_f32 v72, v48, v49
    v_exp_f32 v52, v52
    v_exp_f32 v53, v53
    v_cvt_pk_bf16_f32 v73, v50, v51
    v_mfma_f32_32x32x16_bf16 v[80:95], a[56:59], v[64:67], v[80:95]
    v_exp_f32 v54, v54
    v_exp_f32 v55, v55
    buffer_load_dwordx4 a[40:43], v2, s[12:15], s36 offen offset:2048 sc1
    v_cvt_pk_bf16_f32 v74, v52, v53
    v_exp_f32 v56, v56
    v_mfma_f32_32x32x16_bf16 v[80:95], a[60:63], v[68:71], v[80:95]
    v_exp_f32 v57, v57
    v_cvt_pk_bf16_f32 v75, v54, v55
    v_exp_f32 v58, v58
    v_exp_f32 v59, v59
    v_cvt_pk_bf16_f32 v76, v56, v57
    v_mfma_f32_16x16x32_bf16 v[112:115], v[144:147], v[64:67], v[112:115]
    v_exp_f32 v60, v60
    v_exp_f32 v61, v61
    v_cvt_pk_bf16_f32 v77, v58, v59
    v_exp_f32 v62, v62
    buffer_load_dwordx4 a[44:47], v2, s[12:15], s36 offen offset:3072 sc1
    v_mfma_f32_16x16x32_bf16 v[112:115], v[144:147], v[68:71], v[112:115]
    v_exp_f32 v63, v63
    v_cvt_pk_bf16_f32 v78, v60, v61
    v_cvt_pk_bf16_f32 v79, v62, v63
    v_mfma_f32_32x32x16_bf16 v[48:63], a[64:67], v[16:19], 0
    v_exp_f32 v32, v32
    v_exp_f32 v33, v33
    v_exp_f32 v34, v34
    v_mfma_f32_32x32x16_bf16 v[48:63], a[68:71], v[20:23], v[48:63]
    v_exp_f32 v35, v35
    v_cvt_pk_bf16_f32 v64, v32, v33
    v_exp_f32 v36, v36
    v_exp_f32 v37, v37
    v_cvt_pk_bf16_f32 v65, v34, v35
    v_mfma_f32_32x32x16_bf16 v[96:111], a[56:59], v[72:75], v[96:111]
    v_exp_f32 v38, v38
    v_exp_f32 v39, v39
    buffer_load_dwordx4 a[64:67], v2, s[8:11], s37 offen offset:0 sc1
    v_cvt_pk_bf16_f32 v66, v36, v37
    v_exp_f32 v40, v40
    v_mfma_f32_32x32x16_bf16 v[96:111], a[60:63], v[76:79], v[96:111]
    v_exp_f32 v41, v41
    v_cvt_pk_bf16_f32 v67, v38, v39
    v_exp_f32 v42, v42
    v_exp_f32 v43, v43
    v_cvt_pk_bf16_f32 v68, v40, v41
    v_mfma_f32_16x16x32_bf16 v[128:131], v[144:147], v[72:75], v[128:131]
    v_exp_f32 v44, v44
    v_exp_f32 v45, v45
    v_cvt_pk_bf16_f32 v69, v42, v43
    v_exp_f32 v46, v46
    buffer_load_dwordx4 a[68:71], v2, s[8:11], s37 offen offset:1024 sc1
    v_mfma_f32_16x16x32_bf16 v[128:131], v[144:147], v[76:79], v[128:131]
    v_exp_f32 v47, v47
    v_cvt_pk_bf16_f32 v70, v44, v45
    v_cvt_pk_bf16_f32 v71, v46, v47
    s_waitcnt vmcnt(27)
    v_mfma_f32_32x32x16_bf16 v[32:47], a[80:83], v[8:11], 0
    v_exp_f32 v48, v48
    v_exp_f32 v49, v49
    v_exp_f32 v50, v50
    v_mfma_f32_32x32x16_bf16 v[32:47], a[84:87], v[12:15], v[32:47]
    v_exp_f32 v51, v51
    v_cvt_pk_bf16_f32 v72, v48, v49
    v_exp_f32 v52, v52
    v_exp_f32 v53, v53
    v_cvt_pk_bf16_f32 v73, v50, v51
    v_mfma_f32_32x32x16_bf16 v[80:95], a[72:75], v[64:67], v[80:95]
    v_exp_f32 v54, v54
    v_exp_f32 v55, v55
    buffer_load_dwordx4 a[56:59], v2, s[12:15], s37 offen offset:0 sc1
    v_cvt_pk_bf16_f32 v74, v52, v53
    v_exp_f32 v56, v56
    v_mfma_f32_32x32x16_bf16 v[80:95], a[76:79], v[68:71], v[80:95]
    v_exp_f32 v57, v57
    v_cvt_pk_bf16_f32 v75, v54, v55
    v_exp_f32 v58, v58
    v_exp_f32 v59, v59
    v_cvt_pk_bf16_f32 v76, v56, v57
    v_mfma_f32_16x16x32_bf16 v[112:115], v[144:147], v[64:67], v[112:115]
    v_exp_f32 v60, v60
    v_exp_f32 v61, v61
    v_cvt_pk_bf16_f32 v77, v58, v59
    v_exp_f32 v62, v62
    buffer_load_dwordx4 a[60:63], v2, s[12:15], s37 offen offset:1024 sc1
    v_mfma_f32_16x16x32_bf16 v[112:115], v[144:147], v[68:71], v[112:115]
    v_exp_f32 v63, v63
    v_cvt_pk_bf16_f32 v78, v60, v61
    v_cvt_pk_bf16_f32 v79, v62, v63
    v_mfma_f32_32x32x16_bf16 v[48:63], a[80:83], v[16:19], 0
    v_exp_f32 v32, v32
    v_exp_f32 v33, v33
    v_exp_f32 v34, v34
    v_mfma_f32_32x32x16_bf16 v[48:63], a[84:87], v[20:23], v[48:63]
    v_exp_f32 v35, v35
    v_cvt_pk_bf16_f32 v64, v32, v33
    v_exp_f32 v36, v36
    v_exp_f32 v37, v37
    v_cvt_pk_bf16_f32 v65, v34, v35
    v_mfma_f32_32x32x16_bf16 v[96:111], a[72:75], v[72:75], v[96:111]
    v_exp_f32 v38, v38
    v_exp_f32 v39, v39
    buffer_load_dwordx4 a[80:83], v2, s[8:11], s37 offen offset:2048 sc1
    v_cvt_pk_bf16_f32 v66, v36, v37
    v_exp_f32 v40, v40
    v_mfma_f32_32x32x16_bf16 v[96:111], a[76:79], v[76:79], v[96:111]
    v_exp_f32 v41, v41
    v_cvt_pk_bf16_f32 v67, v38, v39
    v_exp_f32 v42, v42
    v_exp_f32 v43, v43
    v_cvt_pk_bf16_f32 v68, v40, v41
    v_mfma_f32_16x16x32_bf16 v[128:131], v[144:147], v[72:75], v[128:131]
    v_exp_f32 v44, v44
    v_exp_f32 v45, v45
    v_cvt_pk_bf16_f32 v69, v42, v43
    v_exp_f32 v46, v46
    buffer_load_dwordx4 a[84:87], v2, s[8:11], s37 offen offset:3072 sc1
    v_mfma_f32_16x16x32_bf16 v[128:131], v[144:147], v[76:79], v[128:131]
    v_exp_f32 v47, v47
    v_cvt_pk_bf16_f32 v70, v44, v45
    v_cvt_pk_bf16_f32 v71, v46, v47
    s_waitcnt vmcnt(27)
    v_mfma_f32_32x32x16_bf16 v[32:47], a[96:99], v[8:11], 0
    v_exp_f32 v48, v48
    v_exp_f32 v49, v49
    v_exp_f32 v50, v50
    v_mfma_f32_32x32x16_bf16 v[32:47], a[100:103], v[12:15], v[32:47]
    v_exp_f32 v51, v51
    v_cvt_pk_bf16_f32 v72, v48, v49
    v_exp_f32 v52, v52
    v_exp_f32 v53, v53
    v_cvt_pk_bf16_f32 v73, v50, v51
    v_mfma_f32_32x32x16_bf16 v[80:95], a[88:91], v[64:67], v[80:95]
    v_exp_f32 v54, v54
    v_exp_f32 v55, v55
    buffer_load_dwordx4 a[72:75], v2, s[12:15], s37 offen offset:2048 sc1
    v_cvt_pk_bf16_f32 v74, v52, v53
    v_exp_f32 v56, v56
    v_mfma_f32_32x32x16_bf16 v[80:95], a[92:95], v[68:71], v[80:95]
    v_exp_f32 v57, v57
    v_cvt_pk_bf16_f32 v75, v54, v55
    v_exp_f32 v58, v58
    v_exp_f32 v59, v59
    v_cvt_pk_bf16_f32 v76, v56, v57
    v_mfma_f32_16x16x32_bf16 v[112:115], v[144:147], v[64:67], v[112:115]
    v_exp_f32 v60, v60
    v_exp_f32 v61, v61
    v_cvt_pk_bf16_f32 v77, v58, v59
    v_exp_f32 v62, v62
    buffer_load_dwordx4 a[76:79], v2, s[12:15], s37 offen offset:3072 sc1
    v_mfma_f32_16x16x32_bf16 v[112:115], v[144:147], v[68:71], v[112:115]
    v_exp_f32 v63, v63
    v_cvt_pk_bf16_f32 v78, v60, v61
    v_cvt_pk_bf16_f32 v79, v62, v63
    v_mfma_f32_32x32x16_bf16 v[48:63], a[96:99], v[16:19], 0
    v_exp_f32 v32, v32
    v_exp_f32 v33, v33
    v_exp_f32 v34, v34
    v_mfma_f32_32x32x16_bf16 v[48:63], a[100:103], v[20:23], v[48:63]
    v_exp_f32 v35, v35
    v_cvt_pk_bf16_f32 v64, v32, v33
    v_exp_f32 v36, v36
    v_exp_f32 v37, v37
    v_cvt_pk_bf16_f32 v65, v34, v35
    v_mfma_f32_32x32x16_bf16 v[96:111], a[88:91], v[72:75], v[96:111]
    v_exp_f32 v38, v38
    v_exp_f32 v39, v39
    buffer_load_dwordx4 a[96:99], v2, s[8:11], s38 offen offset:0 sc1
    v_cvt_pk_bf16_f32 v66, v36, v37
    v_exp_f32 v40, v40
    v_mfma_f32_32x32x16_bf16 v[96:111], a[92:95], v[76:79], v[96:111]
    v_exp_f32 v41, v41
    v_cvt_pk_bf16_f32 v67, v38, v39
    v_exp_f32 v42, v42
    v_exp_f32 v43, v43
    v_cvt_pk_bf16_f32 v68, v40, v41
    v_mfma_f32_16x16x32_bf16 v[128:131], v[144:147], v[72:75], v[128:131]
    v_exp_f32 v44, v44
    v_exp_f32 v45, v45
    v_cvt_pk_bf16_f32 v69, v42, v43
    v_exp_f32 v46, v46
    buffer_load_dwordx4 a[100:103], v2, s[8:11], s38 offen offset:1024 sc1
    v_mfma_f32_16x16x32_bf16 v[128:131], v[144:147], v[76:79], v[128:131]
    v_exp_f32 v47, v47
    v_cvt_pk_bf16_f32 v70, v44, v45
    v_cvt_pk_bf16_f32 v71, v46, v47
    s_waitcnt vmcnt(27)
    v_mfma_f32_32x32x16_bf16 v[32:47], a[112:115], v[8:11], 0
    v_exp_f32 v48, v48
    v_exp_f32 v49, v49
    v_exp_f32 v50, v50
    v_mfma_f32_32x32x16_bf16 v[32:47], a[116:119], v[12:15], v[32:47]
    v_exp_f32 v51, v51
    v_cvt_pk_bf16_f32 v72, v48, v49
    v_exp_f32 v52, v52
    v_exp_f32 v53, v53
    v_cvt_pk_bf16_f32 v73, v50, v51
    v_mfma_f32_32x32x16_bf16 v[80:95], a[104:107], v[64:67], v[80:95]
    v_exp_f32 v54, v54
    v_exp_f32 v55, v55
    buffer_load_dwordx4 a[88:91], v2, s[12:15], s38 offen offset:0 sc1
    v_cvt_pk_bf16_f32 v74, v52, v53
    v_exp_f32 v56, v56
    v_mfma_f32_32x32x16_bf16 v[80:95], a[108:111], v[68:71], v[80:95]
    v_exp_f32 v57, v57
    v_cvt_pk_bf16_f32 v75, v54, v55
    v_exp_f32 v58, v58
    v_exp_f32 v59, v59
    v_cvt_pk_bf16_f32 v76, v56, v57
    v_mfma_f32_16x16x32_bf16 v[112:115], v[144:147], v[64:67], v[112:115]
    v_exp_f32 v60, v60
    v_exp_f32 v61, v61
    v_cvt_pk_bf16_f32 v77, v58, v59
    v_exp_f32 v62, v62
    buffer_load_dwordx4 a[92:95], v2, s[12:15], s38 offen offset:1024 sc1
    v_mfma_f32_16x16x32_bf16 v[112:115], v[144:147], v[68:71], v[112:115]
    v_exp_f32 v63, v63
    v_cvt_pk_bf16_f32 v78, v60, v61
    v_cvt_pk_bf16_f32 v79, v62, v63
    v_mfma_f32_32x32x16_bf16 v[48:63], a[112:115], v[16:19], 0
    v_exp_f32 v32, v32
    v_exp_f32 v33, v33
    v_exp_f32 v34, v34
    v_mfma_f32_32x32x16_bf16 v[48:63], a[116:119], v[20:23], v[48:63]
    v_exp_f32 v35, v35
    v_cvt_pk_bf16_f32 v64, v32, v33
    v_exp_f32 v36, v36
    v_exp_f32 v37, v37
    v_cvt_pk_bf16_f32 v65, v34, v35
    v_mfma_f32_32x32x16_bf16 v[96:111], a[104:107], v[72:75], v[96:111]
    v_exp_f32 v38, v38
    v_exp_f32 v39, v39
    buffer_load_dwordx4 a[112:115], v2, s[8:11], s38 offen offset:2048 sc1
    v_cvt_pk_bf16_f32 v66, v36, v37
    v_exp_f32 v40, v40
    v_mfma_f32_32x32x16_bf16 v[96:111], a[108:111], v[76:79], v[96:111]
    v_exp_f32 v41, v41
    v_cvt_pk_bf16_f32 v67, v38, v39
    v_exp_f32 v42, v42
    v_exp_f32 v43, v43
    v_cvt_pk_bf16_f32 v68, v40, v41
    v_mfma_f32_16x16x32_bf16 v[128:131], v[144:147], v[72:75], v[128:131]
    v_exp_f32 v44, v44
    v_exp_f32 v45, v45
    v_cvt_pk_bf16_f32 v69, v42, v43
    v_exp_f32 v46, v46
    buffer_load_dwordx4 a[116:119], v2, s[8:11], s38 offen offset:3072 sc1
    v_mfma_f32_16x16x32_bf16 v[128:131], v[144:147], v[76:79], v[128:131]
    v_exp_f32 v47, v47
    v_cvt_pk_bf16_f32 v70, v44, v45
    v_cvt_pk_bf16_f32 v71, v46, v47
    s_waitcnt vmcnt(26)
    v_mfma_f32_32x32x16_bf16 v[32:47], a[0:3], v[8:11], 0
    v_exp_f32 v48, v48
    v_exp_f32 v49, v49
    v_exp_f32 v50, v50
    v_mfma_f32_32x32x16_bf16 v[32:47], a[4:7], v[12:15], v[32:47]
    v_exp_f32 v51, v51
    v_cvt_pk_bf16_f32 v72, v48, v49
    v_exp_f32 v52, v52
    v_exp_f32 v53, v53
    v_cvt_pk_bf16_f32 v73, v50, v51
    v_mfma_f32_32x32x16_bf16 v[80:95], a[120:123], v[64:67], v[80:95]
    v_exp_f32 v54, v54
    v_exp_f32 v55, v55
    buffer_load_dwordx4 a[104:107], v2, s[12:15], s38 offen offset:2048 sc1
    v_cvt_pk_bf16_f32 v74, v52, v53
    v_exp_f32 v56, v56
    v_mfma_f32_32x32x16_bf16 v[80:95], a[124:127], v[68:71], v[80:95]
    v_exp_f32 v57, v57
    v_cvt_pk_bf16_f32 v75, v54, v55
    v_exp_f32 v58, v58
    v_exp_f32 v59, v59
    v_cvt_pk_bf16_f32 v76, v56, v57
    v_mfma_f32_16x16x32_bf16 v[112:115], v[144:147], v[64:67], v[112:115]
    v_exp_f32 v60, v60
    v_exp_f32 v61, v61
    v_cvt_pk_bf16_f32 v77, v58, v59
    v_exp_f32 v62, v62
    buffer_load_dwordx4 a[108:111], v2, s[12:15], s38 offen offset:3072 sc1
    v_mfma_f32_16x16x32_bf16 v[112:115], v[144:147], v[68:71], v[112:115]
    v_exp_f32 v63, v63
    v_cvt_pk_bf16_f32 v78, v60, v61
    v_cvt_pk_bf16_f32 v79, v62, v63
    s_add_u32 s28, s28, 16384
    s_sub_u32 s29, s29, 1
    s_cmp_eq_u32 s29, 5
    s_cbranch_scc1 L_p2_hsig
L_p2_hback:
    s_cmp_lg_u32 s29, 0
    s_cbranch_scc1 L_p2_loop
    v_readfirstlane_b32 s6, v231
    s_nop 3
    s_cmp_ge_u32 s6, 64
    s_cbranch_scc1 L_p2_hok
    s_mov_b32 s7, 0x8000
L_p2_hsf:
    buffer_load_dword v231, off, s[24:27], s101 sc1
    s_waitcnt vmcnt(0)
    v_readfirstlane_b32 s6, v231
    s_sub_u32 s7, s7, 1
    s_cmp_eq_u32 s7, 0
    s_cbranch_scc1 L_p2_hsdf
    s_cmp_ge_u32 s6, 64
    s_cbranch_scc1 L_p2_hsdf
    s_sleep 4
    s_branch L_p2_hsf
L_p2_hsdf:
L_p2_hok:
    v_mfma_f32_32x32x16_bf16 v[48:63], a[0:3], v[16:19], 0
    v_exp_f32 v32, v32
    v_exp_f32 v33, v33
    v_exp_f32 v34, v34
    v_mfma_f32_32x32x16_bf16 v[48:63], a[4:7], v[20:23], v[48:63]
    v_exp_f32 v35, v35
    v_cvt_pk_bf16_f32 v64, v32, v33
    v_exp_f32 v36, v36
    s_lshl_b32 s58, s30, 13
    s_mov_b32 m0, s58
    s_nop 0
    buffer_load_dwordx4 v232, s[40:43], s56 offen offset:0 lds
    v_exp_f32 v37, v37
    v_cvt_pk_bf16_f32 v65, v34, v35
    v_mfma_f32_32x32x16_bf16 v[96:111], a[120:123], v[72:75], v[96:111]
    v_exp_f32 v38, v38
    v_exp_f32 v39, v39
    buffer_load_dwordx4 v233, s[40:43], s56 offen offset:1024 lds
    v_cvt_pk_bf16_f32 v66, v36, v37
    v_exp_f32 v40, v40
    v_mfma_f32_32x32x16_bf16 v[96:111], a[124:127], v[76:79], v[96:111]
    v_exp_f32 v41, v41
    v_cvt_pk_bf16_f32 v67, v38, v39
    v_exp_f32 v42, v42
    v_exp_f32 v43, v43
    buffer_load_dwordx4 v234, s[40:43], s56 offen offset:2048 lds
    v_cvt_pk_bf16_f32 v68, v40, v41
    v_mfma_f32_16x16x32_bf16 v[128:131], v[144:147], v[72:75], v[128:131]
    v_exp_f32 v44, v44
    v_exp_f32 v45, v45
    v_cvt_pk_bf16_f32 v69, v42, v43
    v_exp_f32 v46, v46
    buffer_load_dwordx4 v235, s[40:43], s56 offen offset:3072 lds
    v_mfma_f32_16x16x32_bf16 v[128:131], v[144:147], v[76:79], v[128:131]
    v_exp_f32 v47, v47
    v_cvt_pk_bf16_f32 v70, v44, v45
    v_cvt_pk_bf16_f32 v71, v46, v47
    s_waitcnt vmcnt(28)
    v_mfma_f32_32x32x16_bf16 v[32:47], a[16:19], v[8:11], 0
    v_exp_f32 v48, v48
    v_exp_f32 v49, v49
    v_exp_f32 v50, v50
    v_mfma_f32_32x32x16_bf16 v[32:47], a[20:23], v[12:15], v[32:47]
    v_exp_f32 v51, v51
    v_cvt_pk_bf16_f32 v72, v48, v49
    v_exp_f32 v52, v52
    s_add_u32 m0, s58, 4096
    s_nop 0
    buffer_load_dwordx4 v236, s[40:43], s56 offen offset:0 lds
    v_exp_f32 v53, v53
    v_cvt_pk_bf16_f32 v73, v50, v51
    v_mfma_f32_32x32x16_bf16 v[80:95], a[8:11], v[64:67], v[80:95]
    v_exp_f32 v54, v54
    v_exp_f32 v55, v55
    buffer_load_dwordx4 a[120:123], v2, s[12:15], s28 offen offset:0 sc1
    v_cvt_pk_bf16_f32 v74, v52, v53
    v_exp_f32 v56, v56
    v_mfma_f32_32x32x16_bf16 v[80:95], a[12:15], v[68:71], v[80:95]
    v_exp_f32 v57, v57
    v_cvt_pk_bf16_f32 v75, v54, v55
    v_exp_f32 v58, v58
    v_exp_f32 v59, v59
    buffer_load_dwordx4 v237, s[40:43], s56 offen offset:1024 lds
    v_cvt_pk_bf16_f32 v76, v56, v57
    v_mfma_f32_16x16x32_bf16 v[112:115], v[144:147], v[64:67], v[112:115]
    v_exp_f32 v60, v60
    v_exp_f32 v61, v61
    v_cvt_pk_bf16_f32 v77, v58, v59
    v_exp_f32 v62, v62
    buffer_load_dwordx4 a[124:127], v2, s[12:15], s28 offen offset:1024 sc1
    v_mfma_f32_16x16x32_bf16 v[112:115], v[144:147], v[68:71], v[112:115]
    v_exp_f32 v63, v63
    v_cvt_pk_bf16_f32 v78, v60, v61
    v_cvt_pk_bf16_f32 v79, v62, v63
    v_mfma_f32_32x32x16_bf16 v[48:63], a[16:19], v[16:19], 0
    v_exp_f32 v32, v32
    v_exp_f32 v33, v33
    v_exp_f32 v34, v34
    v_mfma_f32_32x32x16_bf16 v[48:63], a[20:23], v[20:23], v[48:63]
    v_exp_f32 v35, v35
    v_cvt_pk_bf16_f32 v64, v32, v33
    v_exp_f32 v36, v36
    buffer_load_dwordx4 v238, s[40:43], s56 offen offset:2048 lds
    v_exp_f32 v37, v37
    v_cvt_pk_bf16_f32 v65, v34, v35
    v_mfma_f32_32x32x16_bf16 v[96:111], a[8:11], v[72:75], v[96:111]
    v_exp_f32 v38, v38
    v_exp_f32 v39, v39
    buffer_load_dwordx4 v239, s[40:43], s56 offen offset:3072 lds
    v_cvt_pk_bf16_f32 v66, v36, v37
    v_exp_f32 v40, v40
    v_mfma_f32_32x32x16_bf16 v[96:111], a[12:15], v[76:79], v[96:111]
    v_exp_f32 v41, v41
    v_cvt_pk_bf16_f32 v67, v38, v39
    v_exp_f32 v42, v42
    v_exp_f32 v43, v43
    buffer_load_dwordx4 a[128:131], v248, s[44:47], s57 offen offset:0 sc1
    v_cvt_pk_bf16_f32 v68, v40, v41
    v_mfma_f32_16x16x32_bf16 v[128:131], v[144:147], v[72:75], v[128:131]
    v_exp_f32 v44, v44
    v_exp_f32 v45, v45
    v_cvt_pk_bf16_f32 v69, v42, v43
    v_exp_f32 v46, v46
    buffer_load_dwordx4 a[132:135], v248, s[44:47], s57 offen offset:256 sc1
    v_mfma_f32_16x16x32_bf16 v[128:131], v[144:147], v[76:79], v[128:131]
    v_exp_f32 v47, v47
    v_cvt_pk_bf16_f32 v70, v44, v45
    v_cvt_pk_bf16_f32 v71, v46, v47
    s_waitcnt vmcnt(32)
    v_mfma_f32_32x32x16_bf16 v[32:47], a[32:35], v[8:11], 0
    v_exp_f32 v48, v48
    v_exp_f32 v49, v49
    v_exp_f32 v50, v50
    v_mfma_f32_32x32x16_bf16 v[32:47], a[36:39], v[12:15], v[32:47]
    v_exp_f32 v51, v51
    v_cvt_pk_bf16_f32 v72, v48, v49
    v_exp_f32 v52, v52
    buffer_load_dwordx4 a[136:139], v248, s[44:47], s57 offen offset:2048 sc1
    v_exp_f32 v53, v53
    v_cvt_pk_bf16_f32 v73, v50, v51
    v_mfma_f32_32x32x16_bf16 v[80:95], a[24:27], v[64:67], v[80:95]
    v_exp_f32 v54, v54
    v_exp_f32 v55, v55
    buffer_load_dwordx4 a[140:143], v248, s[44:47], s57 offen offset:2304 sc1
    s_add_u32 s57, s57, 4096
    v_cvt_pk_bf16_f32 v74, v52, v53
    v_exp_f32 v56, v56
    v_mfma_f32_32x32x16_bf16 v[80:95], a[28:31], v[68:71], v[80:95]
    v_exp_f32 v57, v57
    v_cvt_pk_bf16_f32 v75, v54, v55
    v_exp_f32 v58, v58
    v_exp_f32 v59, v59
    buffer_load_dwordx4 a[144:147], v248, s[44:47], s57 offen offset:0 sc1
    v_cvt_pk_bf16_f32 v76, v56, v57
    v_mfma_f32_16x16x32_bf16 v[112:115], v[144:147], v[64:67], v[112:115]
    v_exp_f32 v60, v60
    v_exp_f32 v61, v61
    v_cvt_pk_bf16_f32 v77, v58, v59
    v_exp_f32 v62, v62
    buffer_load_dwordx4 a[148:151], v248, s[44:47], s57 offen offset:256 sc1
    v_mfma_f32_16x16x32_bf16 v[112:115], v[144:147], v[68:71], v[112:115]
    v_exp_f32 v63, v63
    v_cvt_pk_bf16_f32 v78, v60, v61
    v_cvt_pk_bf16_f32 v79, v62, v63
    v_mfma_f32_32x32x16_bf16 v[48:63], a[32:35], v[16:19], 0
    v_exp_f32 v32, v32
    v_exp_f32 v33, v33
    v_exp_f32 v34, v34
    v_mfma_f32_32x32x16_bf16 v[48:63], a[36:39], v[20:23], v[48:63]
    v_exp_f32 v35, v35
    v_cvt_pk_bf16_f32 v64, v32, v33
    v_exp_f32 v36, v36
    buffer_load_dwordx4 a[152:155], v248, s[44:47], s57 offen offset:2048 sc1
    v_exp_f32 v37, v37
    v_cvt_pk_bf16_f32 v65, v34, v35
    v_mfma_f32_32x32x16_bf16 v[96:111], a[24:27], v[72:75], v[96:111]
    v_exp_f32 v38, v38
    v_exp_f32 v39, v39
    buffer_load_dwordx4 a[156:159], v248, s[44:47], s57 offen offset:2304 sc1
    s_add_u32 s57, s57, 4096
    v_cvt_pk_bf16_f32 v66, v36, v37
    v_exp_f32 v40, v40
    v_mfma_f32_32x32x16_bf16 v[96:111], a[28:31], v[76:79], v[96:111]
    v_exp_f32 v41, v41
    v_cvt_pk_bf16_f32 v67, v38, v39
    v_exp_f32 v42, v42
    v_exp_f32 v43, v43
    buffer_load_dwordx4 a[160:163], v248, s[44:47], s57 offen offset:0 sc1
    v_cvt_pk_bf16_f32 v68, v40, v41
    v_mfma_f32_16x16x32_bf16 v[128:131], v[144:147], v[72:75], v[128:131]
    v_exp_f32 v44, v44
    v_exp_f32 v45, v45
    v_cvt_pk_bf16_f32 v69, v42, v43
    v_exp_f32 v46, v46
    buffer_load_dwordx4 a[164:167], v248, s[44:47], s57 offen offset:256 sc1
    v_mfma_f32_16x16x32_bf16 v[128:131], v[144:147], v[76:79], v[128:131]
    v_exp_f32 v47, v47
    v_cvt_pk_bf16_f32 v70, v44, v45
    v_cvt_pk_bf16_f32 v71, v46, v47
    s_waitcnt vmcnt(36)
    v_mfma_f32_32x32x16_bf16 v[32:47], a[48:51], v[8:11], 0
    v_exp_f32 v48, v48
    v_exp_f32 v49, v49
    v_exp_f32 v50, v50
    v_mfma_f32_32x32x16_bf16 v[32:47], a[52:55], v[12:15], v[32:47]
    v_exp_f32 v51, v51
    v_cvt_pk_bf16_f32 v72, v48, v49
    v_exp_f32 v52, v52
    buffer_load_dwordx4 a[168:171], v248, s[44:47], s57 offen offset:2048 sc1
    v_exp_f32 v53, v53
    v_cvt_pk_bf16_f32 v73, v50, v51
    v_mfma_f32_32x32x16_bf16 v[80:95], a[40:43], v[64:67], v[80:95]
    v_exp_f32 v54, v54
    v_exp_f32 v55, v55
    buffer_load_dwordx4 a[172:175], v248, s[44:47], s57 offen offset:2304 sc1
    s_add_u32 s57, s57, 4096
    v_cvt_pk_bf16_f32 v74, v52, v53
    v_exp_f32 v56, v56
    v_mfma_f32_32x32x16_bf16 v[80:95], a[44:47], v[68:71], v[80:95]
    v_exp_f32 v57, v57
    v_cvt_pk_bf16_f32 v75, v54, v55
    v_exp_f32 v58, v58
    v_exp_f32 v59, v59
    buffer_load_dwordx4 a[176:179], v248, s[44:47], s57 offen offset:0 sc1
    v_cvt_pk_bf16_f32 v76, v56, v57
    v_mfma_f32_16x16x32_bf16 v[112:115], v[144:147], v[64:67], v[112:115]
    v_exp_f32 v60, v60
    v_exp_f32 v61, v61
    v_cvt_pk_bf16_f32 v77, v58, v59
    v_exp_f32 v62, v62
    buffer_load_dwordx4 a[180:183], v248, s[44:47], s57 offen offset:256 sc1
    v_mfma_f32_16x16x32_bf16 v[112:115], v[144:147], v[68:71], v[112:115]
    v_exp_f32 v63, v63
    v_cvt_pk_bf16_f32 v78, v60, v61
    v_cvt_pk_bf16_f32 v79, v62, v63
    v_mfma_f32_32x32x16_bf16 v[48:63], a[48:51], v[16:19], 0
    v_exp_f32 v32, v32
    v_exp_f32 v33, v33
    v_exp_f32 v34, v34
    v_mfma_f32_32x32x16_bf16 v[48:63], a[52:55], v[20:23], v[48:63]
    v_exp_f32 v35, v35
    v_cvt_pk_bf16_f32 v64, v32, v33
    v_exp_f32 v36, v36
    buffer_load_dwordx4 a[184:187], v248, s[44:47], s57 offen offset:2048 sc1
    v_exp_f32 v37, v37
    v_cvt_pk_bf16_f32 v65, v34, v35
    v_mfma_f32_32x32x16_bf16 v[96:111], a[40:43], v[72:75], v[96:111]
    v_exp_f32 v38, v38
    v_exp_f32 v39, v39
    buffer_load_dwordx4 a[188:191], v248, s[44:47], s57 offen offset:2304 sc1
    s_add_u32 s57, s57, 4096
    v_cvt_pk_bf16_f32 v66, v36, v37
    v_exp_f32 v40, v40
    v_mfma_f32_32x32x16_bf16 v[96:111], a[44:47], v[76:79], v[96:111]
    v_exp_f32 v41, v41
    v_cvt_pk_bf16_f32 v67, v38, v39
    v_exp_f32 v42, v42
    v_exp_f32 v43, v43
    s_add_u32 s56, s56, 262144
    s_add_u32 s58, s58, 32768
    s_and_b32 s58, s58, 131071
    s_mov_b32 m0, s58
    s_nop 0
    buffer_load_dwordx4 v232, s[40:43], s56 offen offset:0 lds
    v_cvt_pk_bf16_f32 v68, v40, v41
    v_mfma_f32_16x16x32_bf16 v[128:131], v[144:147], v[72:75], v[128:131]
    v_exp_f32 v44, v44
    v_exp_f32 v45, v45
    v_cvt_pk_bf16_f32 v69, v42, v43
    v_exp_f32 v46, v46
    buffer_load_dwordx4 v233, s[40:43], s56 offen offset:1024 lds
    v_mfma_f32_16x16x32_bf16 v[128:131], v[144:147], v[76:79], v[128:131]
    v_exp_f32 v47, v47
    v_cvt_pk_bf16_f32 v70, v44, v45
    v_cvt_pk_bf16_f32 v71, v46, v47
    s_waitcnt vmcnt(40)
    v_mfma_f32_32x32x16_bf16 v[32:47], a[64:67], v[8:11], 0
    v_exp_f32 v48, v48
    v_exp_f32 v49, v49
    v_exp_f32 v50, v50
    v_mfma_f32_32x32x16_bf16 v[32:47], a[68:71], v[12:15], v[32:47]
    v_exp_f32 v51, v51
    v_cvt_pk_bf16_f32 v72, v48, v49
    v_exp_f32 v52, v52
    buffer_load_dwordx4 v234, s[40:43], s56 offen offset:2048 lds
    v_exp_f32 v53, v53
    v_cvt_pk_bf16_f32 v73, v50, v51
    v_mfma_f32_32x32x16_bf16 v[80:95], a[56:59], v[64:67], v[80:95]
    v_exp_f32 v54, v54
    v_exp_f32 v55, v55
    buffer_load_dwordx4 v235, s[40:43], s56 offen offset:3072 lds
    v_cvt_pk_bf16_f32 v74, v52, v53
    v_exp_f32 v56, v56
    v_mfma_f32_32x32x16_bf16 v[80:95], a[60:63], v[68:71], v[80:95]
    v_exp_f32 v57, v57
    v_cvt_pk_bf16_f32 v75, v54, v55
    v_exp_f32 v58, v58
    v_exp_f32 v59, v59
    s_add_u32 m0, s58, 4096
    s_nop 0
    buffer_load_dwordx4 v236, s[40:43], s56 offen offset:0 lds
    v_cvt_pk_bf16_f32 v76, v56, v57
    v_mfma_f32_16x16x32_bf16 v[112:115], v[144:147], v[64:67], v[112:115]
    v_exp_f32 v60, v60
    v_exp_f32 v61, v61
    v_cvt_pk_bf16_f32 v77, v58, v59
    v_exp_f32 v62, v62
    buffer_load_dwordx4 v237, s[40:43], s56 offen offset:1024 lds
    v_mfma_f32_16x16x32_bf16 v[112:115], v[144:147], v[68:71], v[112:115]
    v_exp_f32 v63, v63
    v_cvt_pk_bf16_f32 v78, v60, v61
    v_cvt_pk_bf16_f32 v79, v62, v63
    v_mfma_f32_32x32x16_bf16 v[48:63], a[64:67], v[16:19], 0
    v_exp_f32 v32, v32
    v_exp_f32 v33, v33
    v_exp_f32 v34, v34
    v_mfma_f32_32x32x16_bf16 v[48:63], a[68:71], v[20:23], v[48:63]
    v_exp_f32 v35, v35
    v_cvt_pk_bf16_f32 v64, v32, v33
    v_exp_f32 v36, v36
    buffer_load_dwordx4 v238, s[40:43], s56 offen offset:2048 lds
    v_exp_f32 v37, v37
    v_cvt_pk_bf16_f32 v65, v34, v35
    v_mfma_f32_32x32x16_bf16 v[96:111], a[56:59], v[72:75], v[96:111]
    v_exp_f32 v38, v38
    v_exp_f32 v39, v39
    buffer_load_dwordx4 v239, s[40:43], s56 offen offset:3072 lds
    v_cvt_pk_bf16_f32 v66, v36, v37
    v_exp_f32 v40, v40
    v_mfma_f32_32x32x16_bf16 v[96:111], a[60:63], v[76:79], v[96:111]
    v_exp_f32 v41, v41
    v_cvt_pk_bf16_f32 v67, v38, v39
    v_exp_f32 v42, v42
    v_exp_f32 v43, v43
    s_add_u32 s56, s56, 262144
    s_add_u32 s58, s58, 32768
    s_and_b32 s58, s58, 131071
    s_mov_b32 m0, s58
    s_nop 0
    buffer_load_dwordx4 v232, s[40:43], s56 offen offset:0 lds
    v_cvt_pk_bf16_f32 v68, v40, v41
    v_mfma_f32_16x16x32_bf16 v[128:131], v[144:147], v[72:75], v[128:131]
    v_exp_f32 v44, v44
    v_exp_f32 v45, v45
    v_cvt_pk_bf16_f32 v69, v42, v43
    v_exp_f32 v46, v46
    buffer_load_dwordx4 v233, s[40:43], s56 offen offset:1024 lds
    v_mfma_f32_16x16x32_bf16 v[128:131], v[144:147], v[76:79], v[128:131]
    v_exp_f32 v47, v47
    v_cvt_pk_bf16_f32 v70, v44, v45
    v_cvt_pk_bf16_f32 v71, v46, v47
    s_waitcnt vmcnt(44)
    v_mfma_f32_32x32x16_bf16 v[32:47], a[80:83], v[8:11], 0
    v_exp_f32 v48, v48
    v_exp_f32 v49, v49
    v_exp_f32 v50, v50
    v_mfma_f32_32x32x16_bf16 v[32:47], a[84:87], v[12:15], v[32:47]
    v_exp_f32 v51, v51
    v_cvt_pk_bf16_f32 v72, v48, v49
    v_exp_f32 v52, v52
    buffer_load_dwordx4 v234, s[40:43], s56 offen offset:2048 lds
    v_exp_f32 v53, v53
    v_cvt_pk_bf16_f32 v73, v50, v51
    v_mfma_f32_32x32x16_bf16 v[80:95], a[72:75], v[64:67], v[80:95]
    v_exp_f32 v54, v54
    v_exp_f32 v55, v55
    buffer_load_dwordx4 v235, s[40:43], s56 offen offset:3072 lds
    v_cvt_pk_bf16_f32 v74, v52, v53
    v_exp_f32 v56, v56
    v_mfma_f32_32x32x16_bf16 v[80:95], a[76:79], v[68:71], v[80:95]
    v_exp_f32 v57, v57
    v_cvt_pk_bf16_f32 v75, v54, v55
    v_exp_f32 v58, v58
    v_exp_f32 v59, v59
    s_add_u32 m0, s58, 4096
    s_nop 0
    buffer_load_dwordx4 v236, s[40:43], s56 offen offset:0 lds
    v_cvt_pk_bf16_f32 v76, v56, v57
    v_mfma_f32_16x16x32_bf16 v[112:115], v[144:147], v[64:67], v[112:115]
    v_exp_f32 v60, v60
    v_exp_f32 v61, v61
    v_cvt_pk_bf16_f32 v77, v58, v59
    v_exp_f32 v62, v62
    buffer_load_dwordx4 v237, s[40:43], s56 offen offset:1024 lds
    v_mfma_f32_16x16x32_bf16 v[112:115], v[144:147], v[68:71], v[112:115]
    v_exp_f32 v63, v63
    v_cvt_pk_bf16_f32 v78, v60, v61
    v_cvt_pk_bf16_f32 v79, v62, v63
    v_mfma_f32_32x32x16_bf16 v[48:63], a[80:83], v[16:19], 0
    v_exp_f32 v32, v32
    v_exp_f32 v33, v33
    v_exp_f32 v34, v34
    v_mfma_f32_32x32x16_bf16 v[48:63], a[84:87], v[20:23], v[48:63]
    v_exp_f32 v35, v35
    v_cvt_pk_bf16_f32 v64, v32, v33
    v_exp_f32 v36, v36
    buffer_load_dwordx4 v238, s[40:43], s56 offen offset:2048 lds
    v_exp_f32 v37, v37
    v_cvt_pk_bf16_f32 v65, v34, v35
    v_mfma_f32_32x32x16_bf16 v[96:111], a[72:75], v[72:75], v[96:111]
    v_exp_f32 v38, v38
    v_exp_f32 v39, v39
    buffer_load_dwordx4 v239, s[40:43], s56 offen offset:3072 lds
    v_cvt_pk_bf16_f32 v66, v36, v37
    v_exp_f32 v40, v40
    v_mfma_f32_32x32x16_bf16 v[96:111], a[76:79], v[76:79], v[96:111]
    v_exp_f32 v41, v41
    v_cvt_pk_bf16_f32 v67, v38, v39
    v_exp_f32 v42, v42
    v_exp_f32 v43, v43
    buffer_load_dwordx4 a[0:3], v248, s[44:47], s57 offen offset:0 sc1
    v_cvt_pk_bf16_f32 v68, v40, v41
    v_mfma_f32_16x16x32_bf16 v[128:131], v[144:147], v[72:75], v[128:131]
    v_exp_f32 v44, v44
    v_exp_f32 v45, v45
    v_cvt_pk_bf16_f32 v69, v42, v43
    v_exp_f32 v46, v46
    buffer_load_dwordx4 a[4:7], v248, s[44:47], s57 offen offset:256 sc1
    v_mfma_f32_16x16x32_bf16 v[128:131], v[144:147], v[76:79], v[128:131]
    v_exp_f32 v47, v47
    v_cvt_pk_bf16_f32 v70, v44, v45
    v_cvt_pk_bf16_f32 v71, v46, v47
    s_waitcnt vmcnt(48)
    v_mfma_f32_32x32x16_bf16 v[32:47], a[96:99], v[8:11], 0
    v_exp_f32 v48, v48
    v_exp_f32 v49, v49
    v_exp_f32 v50, v50
    v_mfma_f32_32x32x16_bf16 v[32:47], a[100:103], v[12:15], v[32:47]
    v_exp_f32 v51, v51
    v_cvt_pk_bf16_f32 v72, v48, v49
    v_exp_f32 v52, v52
    buffer_load_dwordx4 a[8:11], v248, s[44:47], s57 offen offset:2048 sc1
    v_exp_f32 v53, v53
    v_cvt_pk_bf16_f32 v73, v50, v51
    v_mfma_f32_32x32x16_bf16 v[80:95], a[88:91], v[64:67], v[80:95]
    v_exp_f32 v54, v54
    v_exp_f32 v55, v55
    buffer_load_dwordx4 a[12:15], v248, s[44:47], s57 offen offset:2304 sc1
    s_add_u32 s57, s57, 4096
    v_cvt_pk_bf16_f32 v74, v52, v53
    v_exp_f32 v56, v56
    v_mfma_f32_32x32x16_bf16 v[80:95], a[92:95], v[68:71], v[80:95]
    v_exp_f32 v57, v57
    v_cvt_pk_bf16_f32 v75, v54, v55
    v_exp_f32 v58, v58
    v_exp_f32 v59, v59
    buffer_load_dwordx4 a[16:19], v248, s[44:47], s57 offen offset:0 sc1
    v_cvt_pk_bf16_f32 v76, v56, v57
    v_mfma_f32_16x16x32_bf16 v[112:115], v[144:147], v[64:67], v[112:115]
    v_exp_f32 v60, v60
    v_exp_f32 v61, v61
    v_cvt_pk_bf16_f32 v77, v58, v59
    v_exp_f32 v62, v62
    buffer_load_dwordx4 a[20:23], v248, s[44:47], s57 offen offset:256 sc1
    v_mfma_f32_16x16x32_bf16 v[112:115], v[144:147], v[68:71], v[112:115]
    v_exp_f32 v63, v63
    v_cvt_pk_bf16_f32 v78, v60, v61
    v_cvt_pk_bf16_f32 v79, v62, v63
    v_mfma_f32_32x32x16_bf16 v[48:63], a[96:99], v[16:19], 0
    v_exp_f32 v32, v32
    v_exp_f32 v33, v33
    v_exp_f32 v34, v34
    v_mfma_f32_32x32x16_bf16 v[48:63], a[100:103], v[20:23], v[48:63]
    v_exp_f32 v35, v35
    v_cvt_pk_bf16_f32 v64, v32, v33
    v_exp_f32 v36, v36
    buffer_load_dwordx4 a[24:27], v248, s[44:47], s57 offen offset:2048 sc1
    v_exp_f32 v37, v37
    v_cvt_pk_bf16_f32 v65, v34, v35
    v_mfma_f32_32x32x16_bf16 v[96:111], a[88:91], v[72:75], v[96:111]
    v_exp_f32 v38, v38
    v_exp_f32 v39, v39
    buffer_load_dwordx4 a[28:31], v248, s[44:47], s57 offen offset:2304 sc1
    s_add_u32 s57, s57, 4096
    v_cvt_pk_bf16_f32 v66, v36, v37
    v_exp_f32 v40, v40
    v_mfma_f32_32x32x16_bf16 v[96:111], a[92:95], v[76:79], v[96:111]
    v_exp_f32 v41, v41
    v_cvt_pk_bf16_f32 v67, v38, v39
    v_exp_f32 v42, v42
    v_exp_f32 v43, v43
    buffer_load_dwordx4 a[32:35], v248, s[44:47], s57 offen offset:0 sc1
    v_cvt_pk_bf16_f32 v68, v40, v41
    v_mfma_f32_16x16x32_bf16 v[128:131], v[144:147], v[72:75], v[128:131]
    v_exp_f32 v44, v44
    v_exp_f32 v45, v45
    v_cvt_pk_bf16_f32 v69, v42, v43
    v_exp_f32 v46, v46
    buffer_load_dwordx4 a[36:39], v248, s[44:47], s57 offen offset:256 sc1
    v_mfma_f32_16x16x32_bf16 v[128:131], v[144:147], v[76:79], v[128:131]
    v_exp_f32 v47, v47
    v_cvt_pk_bf16_f32 v70, v44, v45
    v_cvt_pk_bf16_f32 v71, v46, v47
    s_waitcnt vmcnt(52)
    v_mfma_f32_32x32x16_bf16 v[32:47], a[112:115], v[8:11], 0
    v_exp_f32 v48, v48
    v_exp_f32 v49, v49
    v_exp_f32 v50, v50
    v_mfma_f32_32x32x16_bf16 v[32:47], a[116:119], v[12:15], v[32:47]
    v_exp_f32 v51, v51
    v_cvt_pk_bf16_f32 v72, v48, v49
    v_exp_f32 v52, v52
    buffer_load_dwordx4 a[40:43], v248, s[44:47], s57 offen offset:2048 sc1
    v_exp_f32 v53, v53
    v_cvt_pk_bf16_f32 v73, v50, v51
    v_mfma_f32_32x32x16_bf16 v[80:95], a[104:107], v[64:67], v[80:95]
    v_exp_f32 v54, v54
    v_exp_f32 v55, v55
    buffer_load_dwordx4 a[44:47], v248, s[44:47], s57 offen offset:2304 sc1
    s_add_u32 s57, s57, 4096
    v_cvt_pk_bf16_f32 v74, v52, v53
    v_exp_f32 v56, v56
    v_mfma_f32_32x32x16_bf16 v[80:95], a[108:111], v[68:71], v[80:95]
    v_exp_f32 v57, v57
    v_cvt_pk_bf16_f32 v75, v54, v55
    v_exp_f32 v58, v58
    v_exp_f32 v59, v59
    buffer_load_dwordx4 a[48:51], v248, s[44:47], s57 offen offset:0 sc1
    v_cvt_pk_bf16_f32 v76, v56, v57
    v_mfma_f32_16x16x32_bf16 v[112:115], v[144:147], v[64:67], v[112:115]
    v_exp_f32 v60, v60
    v_exp_f32 v61, v61
    v_cvt_pk_bf16_f32 v77, v58, v59
    v_exp_f32 v62, v62
    buffer_load_dwordx4 a[52:55], v248, s[44:47], s57 offen offset:256 sc1
    v_mfma_f32_16x16x32_bf16 v[112:115], v[144:147], v[68:71], v[112:115]
    v_exp_f32 v63, v63
    v_cvt_pk_bf16_f32 v78, v60, v61
    v_cvt_pk_bf16_f32 v79, v62, v63
    v_mfma_f32_32x32x16_bf16 v[48:63], a[112:115], v[16:19], 0
    v_exp_f32 v32, v32
    v_exp_f32 v33, v33
    v_exp_f32 v34, v34
    v_mfma_f32_32x32x16_bf16 v[48:63], a[116:119], v[20:23], v[48:63]
    v_exp_f32 v35, v35
    v_cvt_pk_bf16_f32 v64, v32, v33
    v_exp_f32 v36, v36
    s_add_u32 s56, s56, 262144
    s_add_u32 s58, s58, 32768
    s_and_b32 s58, s58, 131071
    s_mov_b32 m0, s58
    s_nop 0
    buffer_load_dwordx4 v232, s[40:43], s56 offen offset:0 lds
    v_exp_f32 v37, v37
    v_cvt_pk_bf16_f32 v65, v34, v35
    v_mfma_f32_32x32x16_bf16 v[96:111], a[104:107], v[72:75], v[96:111]
    v_exp_f32 v38, v38
    v_exp_f32 v39, v39
    buffer_load_dwordx4 v233, s[40:43], s56 offen offset:1024 lds
    v_cvt_pk_bf16_f32 v66, v36, v37
    v_exp_f32 v40, v40
    v_mfma_f32_32x32x16_bf16 v[96:111], a[108:111], v[76:79], v[96:111]
    v_exp_f32 v41, v41
    v_cvt_pk_bf16_f32 v67, v38, v39
    v_exp_f32 v42, v42
    v_exp_f32 v43, v43
    v_cvt_pk_bf16_f32 v68, v40, v41
    v_mfma_f32_16x16x32_bf16 v[128:131], v[144:147], v[72:75], v[128:131]
    v_exp_f32 v44, v44
    v_exp_f32 v45, v45
    v_cvt_pk_bf16_f32 v69, v42, v43
    v_exp_f32 v46, v46
    v_mfma_f32_16x16x32_bf16 v[128:131], v[144:147], v[76:79], v[128:131]
    v_exp_f32 v47, v47
    v_cvt_pk_bf16_f32 v70, v44, v45
    v_cvt_pk_bf16_f32 v71, v46, v47
    s_waitcnt vmcnt(50)
    s_nop 0
    v_exp_f32 v48, v48
    v_exp_f32 v49, v49
    v_exp_f32 v50, v50
    s_nop 0
    v_exp_f32 v51, v51
    v_cvt_pk_bf16_f32 v72, v48, v49
    v_exp_f32 v52, v52
    v_exp_f32 v53, v53
    v_cvt_pk_bf16_f32 v73, v50, v51
    v_mfma_f32_32x32x16_bf16 v[80:95], a[120:123], v[64:67], v[80:95]
    v_exp_f32 v54, v54
    v_exp_f32 v55, v55
    v_cvt_pk_bf16_f32 v74, v52, v53
    v_exp_f32 v56, v56
    v_mfma_f32_32x32x16_bf16 v[80:95], a[124:127], v[68:71], v[80:95]
    v_exp_f32 v57, v57
    v_cvt_pk_bf16_f32 v75, v54, v55
    v_exp_f32 v58, v58
    v_exp_f32 v59, v59
    v_cvt_pk_bf16_f32 v76, v56, v57
    v_mfma_f32_16x16x32_bf16 v[112:115], v[144:147], v[64:67], v[112:115]
    v_exp_f32 v60, v60
    v_exp_f32 v61, v61
    v_cvt_pk_bf16_f32 v77, v58, v59
    v_exp_f32 v62, v62
    v_mfma_f32_16x16x32_bf16 v[112:115], v[144:147], v[68:71], v[112:115]
    v_exp_f32 v63, v63
    v_cvt_pk_bf16_f32 v78, v60, v61
    v_cvt_pk_bf16_f32 v79, v62, v63
    s_nop 1
    v_mfma_f32_32x32x16_bf16 v[96:111], a[120:123], v[72:75], v[96:111]
    v_mfma_f32_32x32x16_bf16 v[96:111], a[124:127], v[76:79], v[96:111]
    v_mfma_f32_16x16x32_bf16 v[128:131], v[144:147], v[72:75], v[128:131]
    v_mfma_f32_16x16x32_bf16 v[128:131], v[144:147], v[76:79], v[128:131]
    s_nop 7
    s_nop 7
    v_and_b32 v3, 15, v1
    v_lshlrev_b32 v3, 2, v3
    v_lshrrev_b32 v4, 4, v1
    v_and_b32 v4, 1, v4
    v_cmp_eq_u32 vcc, 1, v4
    ds_bpermute_b32 v5, v3, v112
    ds_bpermute_b32 v6, v3, v113
    s_waitcnt lgkmcnt(0)
    v_cndmask_b32 v150, v5, v6, vcc
    ds_bpermute_b32 v5, v3, v128
    ds_bpermute_b32 v6, v3, v129
    s_waitcnt lgkmcnt(0)
    v_cndmask_b32 v151, v5, v6, vcc
    s_branch L_p2_afin
L_p2_hsig:
    s_cmp_lt_i32 s100, 0
    s_cbranch_scc1 L_p2_hback
    s_lshl_b32 s6, s100, 1
    v_lshrrev_b32 v4, 4, v1
    v_and_b32 v4, 1, v4
    v_add_u32 v4, s6, v4
    v_lshrrev_b32 v5, 3, v1
    v_and_b32 v5, 1, v5
    v_lshlrev_b32 v5, 2, v5
    v_lshrrev_b32 v6, 2, v4
    v_or_b32 v5, v5, v6
    v_lshrrev_b32 v6, 1, v1
    v_and_b32 v6, 3, v6
    v_lshlrev_b32 v6, 2, v6
    v_and_b32 v4, 3, v4
    v_or_b32 v6, v6, v4
    v_and_b32 v4, 1, v1
    v_lshl_add_u32 v6, v6, 1, v4
    v_lshl_add_u32 v6, v6, 3, v5
    v_lshlrev_b32 v6, 7, v6
    v_mov_b32 v4, 1
    s_mov_b64 s[36:37], exec
    s_mov_b32 exec_lo, -1
    s_mov_b32 exec_hi, 0
    buffer_atomic_add v4, v6, s[24:27], 0 offen offset:4
    s_mov_b64 exec, s[36:37]
    s_branch L_p2_hback
L_p2_slow:
    s_waitcnt vmcnt(0)
    s_cmp_lt_i32 s100, 0
    s_cbranch_scc1 L_p2_slow2
    s_lshl_b32 s6, s100, 1
    v_lshrrev_b32 v4, 4, v1
    v_and_b32 v4, 1, v4
    v_add_u32 v4, s6, v4
    v_lshrrev_b32 v5, 3, v1
    v_and_b32 v5, 1, v5
    v_lshlrev_b32 v5, 2, v5
    v_lshrrev_b32 v6, 2, v4
    v_or_b32 v5, v5, v6
    v_lshrrev_b32 v6, 1, v1
    v_and_b32 v6, 3, v6
    v_lshlrev_b32 v6, 2, v6
    v_and_b32 v4, 3, v4
    v_or_b32 v6, v6, v4
    v_and_b32 v4, 1, v1
    v_lshl_add_u32 v6, v6, 1, v4
    v_lshl_add_u32 v6, v6, 3, v5
    v_lshlrev_b32 v6, 7, v6
    v_mov_b32 v4, 1
    s_mov_b64 s[36:37], exec
    s_mov_b32 exec_lo, -1
    s_mov_b32 exec_hi, 0
    buffer_atomic_add v4, v6, s[24:27], 0 offen offset:4
    s_mov_b64 exec, s[36:37]
L_p2_slow2:
    v_mov_b32 v148, 0xff800000
    v_mov_b32 v150, 0
    v_mov_b32 v149, 0xff800000
    v_mov_b32 v151, 0
    s_mov_b32 s28, 0
    s_movk_i32 s29, 64
L_p2_sloop:
    buffer_load_dwordx4 a[0:3], v2, s[8:11], s28 offen offset:0 sc1
    buffer_load_dwordx4 a[4:7], v2, s[8:11], s28 offen offset:1024 sc1
    buffer_load_dwordx4 a[8:11], v2, s[12:15], s28 offen offset:2048 sc1
    buffer_load_dwordx4 a[12:15], v2, s[12:15], s28 offen offset:3072 sc1
    s_waitcnt vmcnt(0)
    v_mfma_f32_32x32x16_bf16 v[32:47], a[0:3], v[8:11], 0
    v_mfma_f32_32x32x16_bf16 v[32:47], a[4:7], v[12:15], v[32:47]
    s_nop 7
    s_nop 7
    v_max3_f32 v3, v32, v33, v148
    v_max3_f32 v3, v34, v35, v3
    v_max3_f32 v3, v36, v37, v3
    v_max3_f32 v3, v38, v39, v3
    v_max3_f32 v3, v40, v41, v3
    v_max3_f32 v3, v42, v43, v3
    v_max3_f32 v3, v44, v45, v3
    v_max3_f32 v3, v46, v47, v3
    v_mov_b32 v4, v3
    s_nop 1
    v_permlane32_swap_b32 v3, v4
    s_nop 1
    v_max_f32 v3, v3, v4
    v_sub_f32 v4, v148, v3
    v_exp_f32 v4, v4
    v_mov_b32 v148, v3
    v_sub_f32 v32, v32, v3
    v_sub_f32 v33, v33, v3
    v_sub_f32 v34, v34, v3
    v_sub_f32 v35, v35, v3
    v_sub_f32 v36, v36, v3
    v_sub_f32 v37, v37, v3
    v_sub_f32 v38, v38, v3
    v_sub_f32 v39, v39, v3
    v_sub_f32 v40, v40, v3
    v_sub_f32 v41, v41, v3
    v_sub_f32 v42, v42, v3
    v_sub_f32 v43, v43, v3
    v_sub_f32 v44, v44, v3
    v_sub_f32 v45, v45, v3
    v_sub_f32 v46, v46, v3
    v_sub_f32 v47, v47, v3
    v_exp_f32 v32, v32
    v_exp_f32 v33, v33
    v_exp_f32 v34, v34
    v_exp_f32 v35, v35
    v_exp_f32 v36, v36
    v_exp_f32 v37, v37
    v_exp_f32 v38, v38
    v_exp_f32 v39, v39
    v_exp_f32 v40, v40
    v_exp_f32 v41, v41
    v_exp_f32 v42, v42
    v_exp_f32 v43, v43
    v_exp_f32 v44, v44
    v_exp_f32 v45, v45
    v_exp_f32 v46, v46
    v_exp_f32 v47, v47
    v_mul_f32 v80, v80, v4
    v_mul_f32 v81, v81, v4
    v_mul_f32 v82, v82, v4
    v_mul_f32 v83, v83, v4
    v_mul_f32 v84, v84, v4
    v_mul_f32 v85, v85, v4
    v_mul_f32 v86, v86, v4
    v_mul_f32 v87, v87, v4
    v_mul_f32 v88, v88, v4
    v_mul_f32 v89, v89, v4
    v_mul_f32 v90, v90, v4
    v_mul_f32 v91, v91, v4
    v_mul_f32 v92, v92, v4
    v_mul_f32 v93, v93, v4
    v_mul_f32 v94, v94, v4
    v_mul_f32 v95, v95, v4
    v_cvt_pk_bf16_f32 v64, v32, v33
    v_cvt_pk_bf16_f32 v65, v34, v35
    v_cvt_pk_bf16_f32 v66, v36, v37
    v_cvt_pk_bf16_f32 v67, v38, v39
    v_cvt_pk_bf16_f32 v68, v40, v41
    v_cvt_pk_bf16_f32 v69, v42, v43
    v_cvt_pk_bf16_f32 v70, v44, v45
    v_cvt_pk_bf16_f32 v71, v46, v47
    v_mul_f32 v150, v150, v4
    v_add_f32 v150, v150, v32
    v_add_f32 v150, v150, v33
    v_add_f32 v150, v150, v34
    v_add_f32 v150, v150, v35
    v_add_f32 v150, v150, v36
    v_add_f32 v150, v150, v37
    v_add_f32 v150, v150, v38
    v_add_f32 v150, v150, v39
    v_add_f32 v150, v150, v40
    v_add_f32 v150, v150, v41
    v_add_f32 v150, v150, v42
    v_add_f32 v150, v150, v43
    v_add_f32 v150, v150, v44
    v_add_f32 v150, v150, v45
    v_add_f32 v150, v150, v46
    v_add_f32 v150, v150, v47
    v_mfma_f32_32x32x16_bf16 v[80:95], a[8:11], v[64:67], v[80:95]
    v_mfma_f32_32x32x16_bf16 v[80:95], a[12:15], v[68:71], v[80:95]
    s_nop 7
    s_nop 7
    v_mfma_f32_32x32x16_bf16 v[48:63], a[0:3], v[16:19], 0
    v_mfma_f32_32x32x16_bf16 v[48:63], a[4:7], v[20:23], v[48:63]
    s_nop 7
    s_nop 7
    v_max3_f32 v3, v48, v49, v149
    v_max3_f32 v3, v50, v51, v3
    v_max3_f32 v3, v52, v53, v3
    v_max3_f32 v3, v54, v55, v3
    v_max3_f32 v3, v56, v57, v3
    v_max3_f32 v3, v58, v59, v3
    v_max3_f32 v3, v60, v61, v3
    v_max3_f32 v3, v62, v63, v3
    v_mov_b32 v4, v3
    s_nop 1
    v_permlane32_swap_b32 v3, v4
    s_nop 1
    v_max_f32 v3, v3, v4
    v_sub_f32 v4, v149, v3
    v_exp_f32 v4, v4
    v_mov_b32 v149, v3
    v_sub_f32 v48, v48, v3
    v_sub_f32 v49, v49, v3
    v_sub_f32 v50, v50, v3
    v_sub_f32 v51, v51, v3
    v_sub_f32 v52, v52, v3
    v_sub_f32 v53, v53, v3
    v_sub_f32 v54, v54, v3
    v_sub_f32 v55, v55, v3
    v_sub_f32 v56, v56, v3
    v_sub_f32 v57, v57, v3
    v_sub_f32 v58, v58, v3
    v_sub_f32 v59, v59, v3
    v_sub_f32 v60, v60, v3
    v_sub_f32 v61, v61, v3
    v_sub_f32 v62, v62, v3
    v_sub_f32 v63, v63, v3
    v_exp_f32 v48, v48
    v_exp_f32 v49, v49
    v_exp_f32 v50, v50
    v_exp_f32 v51, v51
    v_exp_f32 v52, v52
    v_exp_f32 v53, v53
    v_exp_f32 v54, v54
    v_exp_f32 v55, v55
    v_exp_f32 v56, v56
    v_exp_f32 v57, v57
    v_exp_f32 v58, v58
    v_exp_f32 v59, v59
    v_exp_f32 v60, v60
    v_exp_f32 v61, v61
    v_exp_f32 v62, v62
    v_exp_f32 v63, v63
    v_mul_f32 v96, v96, v4
    v_mul_f32 v97, v97, v4
    v_mul_f32 v98, v98, v4
    v_mul_f32 v99, v99, v4
    v_mul_f32 v100, v100, v4
    v_mul_f32 v101, v101, v4
    v_mul_f32 v102, v102, v4
    v_mul_f32 v103, v103, v4
    v_mul_f32 v104, v104, v4
    v_mul_f32 v105, v105, v4
    v_mul_f32 v106, v106, v4
    v_mul_f32 v107, v107, v4
    v_mul_f32 v108, v108, v4
    v_mul_f32 v109, v109, v4
    v_mul_f32 v110, v110, v4
    v_mul_f32 v111, v111, v4
    v_cvt_pk_bf16_f32 v72, v48, v49
    v_cvt_pk_bf16_f32 v73, v50, v51
    v_cvt_pk_bf16_f32 v74, v52, v53
    v_cvt_pk_bf16_f32 v75, v54, v55
    v_cvt_pk_bf16_f32 v76, v56, v57
    v_cvt_pk_bf16_f32 v77, v58, v59
    v_cvt_pk_bf16_f32 v78, v60, v61
    v_cvt_pk_bf16_f32 v79, v62, v63
    v_mul_f32 v151, v151, v4
    v_add_f32 v151, v151, v48
    v_add_f32 v151, v151, v49
    v_add_f32 v151, v151, v50
    v_add_f32 v151, v151, v51
    v_add_f32 v151, v151, v52
    v_add_f32 v151, v151, v53
    v_add_f32 v151, v151, v54
    v_add_f32 v151, v151, v55
    v_add_f32 v151, v151, v56
    v_add_f32 v151, v151, v57
    v_add_f32 v151, v151, v58
    v_add_f32 v151, v151, v59
    v_add_f32 v151, v151, v60
    v_add_f32 v151, v151, v61
    v_add_f32 v151, v151, v62
    v_add_f32 v151, v151, v63
    v_mfma_f32_32x32x16_bf16 v[96:111], a[8:11], v[72:75], v[96:111]
    v_mfma_f32_32x32x16_bf16 v[96:111], a[12:15], v[76:79], v[96:111]
    s_nop 7
    s_nop 7
    s_add_u32 s28, s28, 2048
    s_sub_u32 s29, s29, 1
    s_cmp_lg_u32 s29, 0
    s_cbranch_scc1 L_p2_sloop
    v_mov_b32 v4, v150
    s_nop 1
    v_permlane32_swap_b32 v150, v4
    s_nop 1
    v_add_f32 v150, v150, v4
    v_mov_b32 v4, v151
    s_nop 1
    v_permlane32_swap_b32 v151, v4
    s_nop 1
    v_add_f32 v151, v151, v4
    s_mov_b32 s7, 0x8000
L_p2_hss:
    buffer_load_dword v231, off, s[24:27], s101 sc1
    s_waitcnt vmcnt(0)
    v_readfirstlane_b32 s6, v231
    s_sub_u32 s7, s7, 1
    s_cmp_eq_u32 s7, 0
    s_cbranch_scc1 L_p2_hsds
    s_cmp_ge_u32 s6, 64
    s_cbranch_scc1 L_p2_hsds
    s_sleep 4
    s_branch L_p2_hss
L_p2_hsds:
    s_lshl_b32 s58, s30, 13
    s_mov_b32 m0, s58
    s_nop 0
    buffer_load_dwordx4 v232, s[40:43], s56 offen offset:0 lds
    buffer_load_dwordx4 v233, s[40:43], s56 offen offset:1024 lds
    buffer_load_dwordx4 v234, s[40:43], s56 offen offset:2048 lds
    buffer_load_dwordx4 v235, s[40:43], s56 offen offset:3072 lds
    s_add_u32 m0, s58, 4096
    s_nop 0
    buffer_load_dwordx4 v236, s[40:43], s56 offen offset:0 lds
    buffer_load_dwordx4 v237, s[40:43], s56 offen offset:1024 lds
    buffer_load_dwordx4 v238, s[40:43], s56 offen offset:2048 lds
    buffer_load_dwordx4 v239, s[40:43], s56 offen offset:3072 lds
    buffer_load_dwordx4 a[128:131], v248, s[44:47], s57 offen offset:0 sc1
    buffer_load_dwordx4 a[132:135], v248, s[44:47], s57 offen offset:256 sc1
    buffer_load_dwordx4 a[136:139], v248, s[44:47], s57 offen offset:2048 sc1
    buffer_load_dwordx4 a[140:143], v248, s[44:47], s57 offen offset:2304 sc1
    s_add_u32 s57, s57, 4096
    buffer_load_dwordx4 a[144:147], v248, s[44:47], s57 offen offset:0 sc1
    buffer_load_dwordx4 a[148:151], v248, s[44:47], s57 offen offset:256 sc1
    buffer_load_dwordx4 a[152:155], v248, s[44:47], s57 offen offset:2048 sc1
    buffer_load_dwordx4 a[156:159], v248, s[44:47], s57 offen offset:2304 sc1
    s_add_u32 s57, s57, 4096
    buffer_load_dwordx4 a[160:163], v248, s[44:47], s57 offen offset:0 sc1
    buffer_load_dwordx4 a[164:167], v248, s[44:47], s57 offen offset:256 sc1
    buffer_load_dwordx4 a[168:171], v248, s[44:47], s57 offen offset:2048 sc1
    buffer_load_dwordx4 a[172:175], v248, s[44:47], s57 offen offset:2304 sc1
    s_add_u32 s57, s57, 4096
    buffer_load_dwordx4 a[176:179], v248, s[44:47], s57 offen offset:0 sc1
    buffer_load_dwordx4 a[180:183], v248, s[44:47], s57 offen offset:256 sc1
    buffer_load_dwordx4 a[184:187], v248, s[44:47], s57 offen offset:2048 sc1
    buffer_load_dwordx4 a[188:191], v248, s[44:47], s57 offen offset:2304 sc1
    s_add_u32 s57, s57, 4096
    s_add_u32 s56, s56, 262144
    s_add_u32 s58, s58, 32768
    s_and_b32 s58, s58, 131071
    s_mov_b32 m0, s58
    s_nop 0
    buffer_load_dwordx4 v232, s[40:43], s56 offen offset:0 lds
    buffer_load_dwordx4 v233, s[40:43], s56 offen offset:1024 lds
    buffer_load_dwordx4 v234, s[40:43], s56 offen offset:2048 lds
    buffer_load_dwordx4 v235, s[40:43], s56 offen offset:3072 lds
    s_add_u32 m0, s58, 4096
    s_nop 0
    buffer_load_dwordx4 v236, s[40:43], s56 offen offset:0 lds
    buffer_load_dwordx4 v237, s[40:43], s56 offen offset:1024 lds
    buffer_load_dwordx4 v238, s[40:43], s56 offen offset:2048 lds
    buffer_load_dwordx4 v239, s[40:43], s56 offen offset:3072 lds
    s_add_u32 s56, s56, 262144
    s_add_u32 s58, s58, 32768
    s_and_b32 s58, s58, 131071
    s_mov_b32 m0, s58
    s_nop 0
    buffer_load_dwordx4 v232, s[40:43], s56 offen offset:0 lds
    buffer_load_dwordx4 v233, s[40:43], s56 offen offset:1024 lds
    buffer_load_dwordx4 v234, s[40:43], s56 offen offset:2048 lds
    buffer_load_dwordx4 v235, s[40:43], s56 offen offset:3072 lds
    s_add_u32 m0, s58, 4096
    s_nop 0
    buffer_load_dwordx4 v236, s[40:43], s56 offen offset:0 lds
    buffer_load_dwordx4 v237, s[40:43], s56 offen offset:1024 lds
    buffer_load_dwordx4 v238, s[40:43], s56 offen offset:2048 lds
    buffer_load_dwordx4 v239, s[40:43], s56 offen offset:3072 lds
    buffer_load_dwordx4 a[0:3], v248, s[44:47], s57 offen offset:0 sc1
    buffer_load_dwordx4 a[4:7], v248, s[44:47], s57 offen offset:256 sc1
    buffer_load_dwordx4 a[8:11], v248, s[44:47], s57 offen offset:2048 sc1
    buffer_load_dwordx4 a[12:15], v248, s[44:47], s57 offen offset:2304 sc1
    s_add_u32 s57, s57, 4096
    buffer_load_dwordx4 a[16:19], v248, s[44:47], s57 offen offset:0 sc1
    buffer_load_dwordx4 a[20:23], v248, s[44:47], s57 offen offset:256 sc1
    buffer_load_dwordx4 a[24:27], v248, s[44:47], s57 offen offset:2048 sc1
    buffer_load_dwordx4 a[28:31], v248, s[44:47], s57 offen offset:2304 sc1
    s_add_u32 s57, s57, 4096
    buffer_load_dwordx4 a[32:35], v248, s[44:47], s57 offen offset:0 sc1
    buffer_load_dwordx4 a[36:39], v248, s[44:47], s57 offen offset:256 sc1
    buffer_load_dwordx4 a[40:43], v248, s[44:47], s57 offen offset:2048 sc1
    buffer_load_dwordx4 a[44:47], v248, s[44:47], s57 offen offset:2304 sc1
    s_add_u32 s57, s57, 4096
    buffer_load_dwordx4 a[48:51], v248, s[44:47], s57 offen offset:0 sc1
    buffer_load_dwordx4 a[52:55], v248, s[44:47], s57 offen offset:256 sc1
    s_add_u32 s56, s56, 262144
    s_add_u32 s58, s58, 32768
    s_and_b32 s58, s58, 131071
    s_mov_b32 m0, s58
    s_nop 0
    buffer_load_dwordx4 v232, s[40:43], s56 offen offset:0 lds
    buffer_load_dwordx4 v233, s[40:43], s56 offen offset:1024 lds
L_p2_afin:
    s_mul_i32 s6, s32, 299264
    s_lshl_b32 s7, s31, 11
    s_add_u32 s6, s6, s7
    v_rcp_f32 v4, v150
    s_nop 0
    v_mul_f32 v80, v80, v4
    v_mul_f32 v81, v81, v4
    v_mul_f32 v82, v82, v4
    v_mul_f32 v83, v83, v4
    v_mul_f32 v84, v84, v4
    v_mul_f32 v85, v85, v4
    v_mul_f32 v86, v86, v4
    v_mul_f32 v87, v87, v4
    v_mul_f32 v88, v88, v4
    v_mul_f32 v89, v89, v4
    v_mul_f32 v90, v90, v4
    v_mul_f32 v91, v91, v4
    v_mul_f32 v92, v92, v4
    v_mul_f32 v93, v93, v4
    v_mul_f32 v94, v94, v4
    v_mul_f32 v95, v95, v4
    v_cvt_pk_bf16_f32 v32, v80, v81
    v_cvt_pk_bf16_f32 v33, v82, v83
    v_cvt_pk_bf16_f32 v34, v88, v89
    v_cvt_pk_bf16_f32 v35, v90, v91
    buffer_store_dwordx4 v[32:35], v2, s[20:23], s6 offen offset:0 sc1
    v_cvt_pk_bf16_f32 v36, v84, v85
    v_cvt_pk_bf16_f32 v37, v86, v87
    v_cvt_pk_bf16_f32 v38, v92, v93
    v_cvt_pk_bf16_f32 v39, v94, v95
    buffer_store_dwordx4 v[36:39], v2, s[20:23], s6 offen offset:1024 sc1
    s_add_u32 s6, s6, 299264
    v_rcp_f32 v4, v151
    s_nop 0
    v_mul_f32 v96, v96, v4
    v_mul_f32 v97, v97, v4
    v_mul_f32 v98, v98, v4
    v_mul_f32 v99, v99, v4
    v_mul_f32 v100, v100, v4
    v_mul_f32 v101, v101, v4
    v_mul_f32 v102, v102, v4
    v_mul_f32 v103, v103, v4
    v_mul_f32 v104, v104, v4
    v_mul_f32 v105, v105, v4
    v_mul_f32 v106, v106, v4
    v_mul_f32 v107, v107, v4
    v_mul_f32 v108, v108, v4
    v_mul_f32 v109, v109, v4
    v_mul_f32 v110, v110, v4
    v_mul_f32 v111, v111, v4
    v_cvt_pk_bf16_f32 v48, v96, v97
    v_cvt_pk_bf16_f32 v49, v98, v99
    v_cvt_pk_bf16_f32 v50, v104, v105
    v_cvt_pk_bf16_f32 v51, v106, v107
    buffer_store_dwordx4 v[48:51], v2, s[20:23], s6 offen offset:0 sc1
    v_cvt_pk_bf16_f32 v52, v100, v101
    v_cvt_pk_bf16_f32 v53, v102, v103
    v_cvt_pk_bf16_f32 v54, v108, v109
    v_cvt_pk_bf16_f32 v55, v110, v111
    buffer_store_dwordx4 v[52:55], v2, s[20:23], s6 offen offset:1024 sc1
    s_mov_b32 s12, s96
    s_and_b32 s13, s97, 0xffff
    s_mov_b32 s14, 4194304
    s_mov_b32 s15, 0x00020000
    s_mov_b32 s16, s98
    s_and_b32 s17, s99, 0xffff
    s_mov_b32 s18, 4194304
    s_mov_b32 s19, 0x00020000
    v_lshrrev_b32 v5, 3, v1
    v_and_b32 v6, 7, v1
    v_lshlrev_b32 v3, 11, v5
    v_lshl_add_u32 v3, v6, 4, v3
    s_lshl_b32 s7, s62, 7
    s_lshl_b32 s36, s30, 5
    s_add_u32 s7, s7, s36
    s_lshl_b32 s7, s7, 11
    s_lshl_b32 s36, s63, 8
    s_add_u32 s7, s7, s36
    s_lshl_b32 s36, s61, 7
    s_add_u32 s95, s7, s36
    s_mov_b32 s7, s95
    buffer_load_dwordx4 v[112:115], v3, s[12:15], s7 offen
    s_add_u32 s7, s7, 16384
    buffer_load_dwordx4 v[116:119], v3, s[12:15], s7 offen
    s_add_u32 s7, s7, 16384
    buffer_load_dwordx4 v[120:123], v3, s[12:15], s7 offen
    s_add_u32 s7, s7, 16384
    buffer_load_dwordx4 v[124:127], v3, s[12:15], s7 offen
    s_waitcnt vmcnt(56)
    s_barrier
    s_mov_b32 s29, s94
    s_mov_b32 s91, 1
    ds_read_b64_tr_b16 a[192:193], v240 offset:0
    ds_read_b64_tr_b16 a[194:195], v240 offset:4096
    ds_read_b64_tr_b16 a[196:197], v241 offset:0
    ds_read_b64_tr_b16 a[198:199], v241 offset:4096
    ds_read_b64_tr_b16 a[200:201], v242 offset:0
    ds_read_b64_tr_b16 a[202:203], v242 offset:4096
    ds_read_b64_tr_b16 a[204:205], v243 offset:0
    ds_read_b64_tr_b16 a[206:207], v243 offset:4096
    ds_read_b64_tr_b16 a[208:209], v244 offset:0
    ds_read_b64_tr_b16 a[210:211], v244 offset:4096
    ds_read_b64_tr_b16 a[212:213], v245 offset:0
    ds_read_b64_tr_b16 a[214:215], v245 offset:4096
    ds_read_b64_tr_b16 a[216:217], v246 offset:0
    ds_read_b64_tr_b16 a[218:219], v246 offset:4096
    ds_read_b64_tr_b16 a[220:221], v247 offset:0
    ds_read_b64_tr_b16 a[222:223], v247 offset:4096
.p2align 6
L_p2_gloop:
    s_waitcnt vmcnt(54) lgkmcnt(0)
    v_mfma_f32_16x16x32_bf16 v[152:155], a[192:195], a[128:131], v[152:155]
    ds_read_b64_tr_b16 a[224:225], v240 offset:8192
    ds_read_b64_tr_b16 a[226:227], v240 offset:12288
    v_mfma_f32_16x16x32_bf16 v[156:159], a[192:195], a[132:135], v[156:159]
    ds_read_b64_tr_b16 a[228:229], v241 offset:8192
    ds_read_b64_tr_b16 a[230:231], v241 offset:12288
    v_mfma_f32_16x16x32_bf16 v[160:163], a[196:199], a[128:131], v[160:163]
    ds_read_b64_tr_b16 a[232:233], v242 offset:8192
    ds_read_b64_tr_b16 a[234:235], v242 offset:12288
    buffer_load_dwordx4 a[56:59], v248, s[44:47], s57 offen offset:2048 sc1
    v_mfma_f32_16x16x32_bf16 v[164:167], a[196:199], a[132:135], v[164:167]
    ds_read_b64_tr_b16 a[236:237], v243 offset:8192
    ds_read_b64_tr_b16 a[238:239], v243 offset:12288
    v_mfma_f32_16x16x32_bf16 v[168:171], a[200:203], a[128:131], v[168:171]
    ds_read_b64_tr_b16 a[240:241], v244 offset:8192
    ds_read_b64_tr_b16 a[242:243], v244 offset:12288
    v_mfma_f32_16x16x32_bf16 v[172:175], a[200:203], a[132:135], v[172:175]
    ds_read_b64_tr_b16 a[244:245], v245 offset:8192
    ds_read_b64_tr_b16 a[246:247], v245 offset:12288
    v_mfma_f32_16x16x32_bf16 v[176:179], a[204:207], a[128:131], v[176:179]
    ds_read_b64_tr_b16 a[248:249], v246 offset:8192
    ds_read_b64_tr_b16 a[250:251], v246 offset:12288
    buffer_load_dwordx4 v234, s[40:43], s56 offen offset:2048 lds
    v_mfma_f32_16x16x32_bf16 v[180:183], a[204:207], a[132:135], v[180:183]
    ds_read_b64_tr_b16 a[252:253], v247 offset:8192
    ds_read_b64_tr_b16 a[254:255], v247 offset:12288
    v_mfma_f32_16x16x32_bf16 v[184:187], a[208:211], a[128:131], v[184:187]
    v_mfma_f32_16x16x32_bf16 v[188:191], a[208:211], a[132:135], v[188:191]
    v_mfma_f32_16x16x32_bf16 v[192:195], a[212:215], a[128:131], v[192:195]
    buffer_load_dwordx4 a[60:63], v248, s[44:47], s57 offen offset:2304 sc1
    s_add_u32 s57, s57, 4096
    v_mfma_f32_16x16x32_bf16 v[196:199], a[212:215], a[132:135], v[196:199]
    v_mfma_f32_16x16x32_bf16 v[200:203], a[216:219], a[128:131], v[200:203]
    v_mfma_f32_16x16x32_bf16 v[204:207], a[216:219], a[132:135], v[204:207]
    v_mfma_f32_16x16x32_bf16 v[208:211], a[220:223], a[128:131], v[208:211]
    buffer_load_dwordx4 v235, s[40:43], s56 offen offset:3072 lds
    v_mfma_f32_16x16x32_bf16 v[212:215], a[220:223], a[132:135], v[212:215]
    s_waitcnt vmcnt(56) lgkmcnt(0)
    v_mfma_f32_16x16x32_bf16 v[152:155], a[224:227], a[136:139], v[152:155]
    ds_read_b64_tr_b16 a[192:193], v240 offset:16384
    ds_read_b64_tr_b16 a[194:195], v240 offset:20480
    v_mfma_f32_16x16x32_bf16 v[156:159], a[224:227], a[140:143], v[156:159]
    ds_read_b64_tr_b16 a[196:197], v241 offset:16384
    ds_read_b64_tr_b16 a[198:199], v241 offset:20480
    v_mfma_f32_16x16x32_bf16 v[160:163], a[228:231], a[136:139], v[160:163]
    ds_read_b64_tr_b16 a[200:201], v242 offset:16384
    ds_read_b64_tr_b16 a[202:203], v242 offset:20480
    buffer_load_dwordx4 a[64:67], v248, s[44:47], s57 offen offset:0 sc1
    v_mfma_f32_16x16x32_bf16 v[164:167], a[228:231], a[140:143], v[164:167]
    ds_read_b64_tr_b16 a[204:205], v243 offset:16384
    ds_read_b64_tr_b16 a[206:207], v243 offset:20480
    v_mfma_f32_16x16x32_bf16 v[168:171], a[232:235], a[136:139], v[168:171]
    ds_read_b64_tr_b16 a[208:209], v244 offset:16384
    ds_read_b64_tr_b16 a[210:211], v244 offset:20480
    v_mfma_f32_16x16x32_bf16 v[172:175], a[232:235], a[140:143], v[172:175]
    ds_read_b64_tr_b16 a[212:213], v245 offset:16384
    ds_read_b64_tr_b16 a[214:215], v245 offset:20480
    v_mfma_f32_16x16x32_bf16 v[176:179], a[236:239], a[136:139], v[176:179]
    ds_read_b64_tr_b16 a[216:217], v246 offset:16384
    ds_read_b64_tr_b16 a[218:219], v246 offset:20480
    s_add_u32 m0, s58, 4096
    s_nop 0
    buffer_load_dwordx4 v236, s[40:43], s56 offen offset:0 lds
    v_mfma_f32_16x16x32_bf16 v[180:183], a[236:239], a[140:143], v[180:183]
    ds_read_b64_tr_b16 a[220:221], v247 offset:16384
    ds_read_b64_tr_b16 a[222:223], v247 offset:20480
    v_mfma_f32_16x16x32_bf16 v[184:187], a[240:243], a[136:139], v[184:187]
    v_mfma_f32_16x16x32_bf16 v[188:191], a[240:243], a[140:143], v[188:191]
    v_mfma_f32_16x16x32_bf16 v[192:195], a[244:247], a[136:139], v[192:195]
    buffer_load_dwordx4 a[68:71], v248, s[44:47], s57 offen offset:256 sc1
    v_mfma_f32_16x16x32_bf16 v[196:199], a[244:247], a[140:143], v[196:199]
    v_mfma_f32_16x16x32_bf16 v[200:203], a[248:251], a[136:139], v[200:203]
    v_mfma_f32_16x16x32_bf16 v[204:207], a[248:251], a[140:143], v[204:207]
    v_mfma_f32_16x16x32_bf16 v[208:211], a[252:255], a[136:139], v[208:211]
    buffer_load_dwordx4 v237, s[40:43], s56 offen offset:1024 lds
    v_mfma_f32_16x16x32_bf16 v[212:215], a[252:255], a[140:143], v[212:215]
    s_waitcnt vmcnt(57) lgkmcnt(0)
    v_mfma_f32_16x16x32_bf16 v[152:155], a[192:195], a[144:147], v[152:155]
    buffer_load_dword v221, v222, s[48:51], 0 offen sc1
    ds_read_b64_tr_b16 a[224:225], v240 offset:24576
    ds_read_b64_tr_b16 a[226:227], v240 offset:28672
    v_mfma_f32_16x16x32_bf16 v[156:159], a[192:195], a[148:151], v[156:159]
    ds_read_b64_tr_b16 a[228:229], v241 offset:24576
    ds_read_b64_tr_b16 a[230:231], v241 offset:28672
    v_mfma_f32_16x16x32_bf16 v[160:163], a[196:199], a[144:147], v[160:163]
    ds_read_b64_tr_b16 a[232:233], v242 offset:24576
    ds_read_b64_tr_b16 a[234:235], v242 offset:28672
    buffer_load_dwordx4 a[72:75], v248, s[44:47], s57 offen offset:2048 sc1
    v_mfma_f32_16x16x32_bf16 v[164:167], a[196:199], a[148:151], v[164:167]
    ds_read_b64_tr_b16 a[236:237], v243 offset:24576
    ds_read_b64_tr_b16 a[238:239], v243 offset:28672
    v_mfma_f32_16x16x32_bf16 v[168:171], a[200:203], a[144:147], v[168:171]
    ds_read_b64_tr_b16 a[240:241], v244 offset:24576
    ds_read_b64_tr_b16 a[242:243], v244 offset:28672
    v_mfma_f32_16x16x32_bf16 v[172:175], a[200:203], a[148:151], v[172:175]
    ds_read_b64_tr_b16 a[244:245], v245 offset:24576
    ds_read_b64_tr_b16 a[246:247], v245 offset:28672
    v_mfma_f32_16x16x32_bf16 v[176:179], a[204:207], a[144:147], v[176:179]
    ds_read_b64_tr_b16 a[248:249], v246 offset:24576
    ds_read_b64_tr_b16 a[250:251], v246 offset:28672
    buffer_load_dwordx4 v238, s[40:43], s56 offen offset:2048 lds
    v_mfma_f32_16x16x32_bf16 v[180:183], a[204:207], a[148:151], v[180:183]
    ds_read_b64_tr_b16 a[252:253], v247 offset:24576
    ds_read_b64_tr_b16 a[254:255], v247 offset:28672
    v_mfma_f32_16x16x32_bf16 v[184:187], a[208:211], a[144:147], v[184:187]
    v_mfma_f32_16x16x32_bf16 v[188:191], a[208:211], a[148:151], v[188:191]
    v_mfma_f32_16x16x32_bf16 v[192:195], a[212:215], a[144:147], v[192:195]
    buffer_load_dwordx4 a[76:79], v248, s[44:47], s57 offen offset:2304 sc1
    s_add_u32 s57, s57, 4096
    v_mfma_f32_16x16x32_bf16 v[196:199], a[212:215], a[148:151], v[196:199]
    v_mfma_f32_16x16x32_bf16 v[200:203], a[216:219], a[144:147], v[200:203]
    v_mfma_f32_16x16x32_bf16 v[204:207], a[216:219], a[148:151], v[204:207]
    v_mfma_f32_16x16x32_bf16 v[208:211], a[220:223], a[144:147], v[208:211]
    buffer_load_dwordx4 v239, s[40:43], s56 offen offset:3072 lds
    v_mfma_f32_16x16x32_bf16 v[212:215], a[220:223], a[148:151], v[212:215]
    s_waitcnt vmcnt(33) lgkmcnt(0)
    s_barrier
    v_mfma_f32_16x16x32_bf16 v[152:155], a[224:227], a[152:155], v[152:155]
    ds_read_b64_tr_b16 a[192:193], v240 offset:32768
    ds_read_b64_tr_b16 a[194:195], v240 offset:36864
    v_mfma_f32_16x16x32_bf16 v[156:159], a[224:227], a[156:159], v[156:159]
    ds_read_b64_tr_b16 a[196:197], v241 offset:32768
    ds_read_b64_tr_b16 a[198:199], v241 offset:36864
    v_mfma_f32_16x16x32_bf16 v[160:163], a[228:231], a[152:155], v[160:163]
    ds_read_b64_tr_b16 a[200:201], v242 offset:32768
    ds_read_b64_tr_b16 a[202:203], v242 offset:36864
    buffer_load_dwordx4 a[80:83], v248, s[44:47], s57 offen offset:0 sc1
    v_mfma_f32_16x16x32_bf16 v[164:167], a[228:231], a[156:159], v[164:167]
    ds_read_b64_tr_b16 a[204:205], v243 offset:32768
    ds_read_b64_tr_b16 a[206:207], v243 offset:36864
    v_mfma_f32_16x16x32_bf16 v[168:171], a[232:235], a[152:155], v[168:171]
    ds_read_b64_tr_b16 a[208:209], v244 offset:32768
    ds_read_b64_tr_b16 a[210:211], v244 offset:36864
    s_add_u32 s56, s56, 262144
    s_add_u32 s58, s58, 32768
    s_and_b32 s58, s58, 131071
    s_mov_b32 m0, s58
    s_nop 0
    v_mfma_f32_16x16x32_bf16 v[172:175], a[232:235], a[156:159], v[172:175]
    ds_read_b64_tr_b16 a[212:213], v245 offset:32768
    ds_read_b64_tr_b16 a[214:215], v245 offset:36864
    v_mfma_f32_16x16x32_bf16 v[176:179], a[236:239], a[152:155], v[176:179]
    ds_read_b64_tr_b16 a[216:217], v246 offset:32768
    ds_read_b64_tr_b16 a[218:219], v246 offset:36864
    buffer_load_dwordx4 v232, s[40:43], s56 offen offset:0 lds
    v_mfma_f32_16x16x32_bf16 v[180:183], a[236:239], a[156:159], v[180:183]
    ds_read_b64_tr_b16 a[220:221], v247 offset:32768
    ds_read_b64_tr_b16 a[222:223], v247 offset:36864
    v_mfma_f32_16x16x32_bf16 v[184:187], a[240:243], a[152:155], v[184:187]
    v_mfma_f32_16x16x32_bf16 v[188:191], a[240:243], a[156:159], v[188:191]
    v_mfma_f32_16x16x32_bf16 v[192:195], a[244:247], a[152:155], v[192:195]
    buffer_load_dwordx4 a[84:87], v248, s[44:47], s57 offen offset:256 sc1
    v_mfma_f32_16x16x32_bf16 v[196:199], a[244:247], a[156:159], v[196:199]
    v_mfma_f32_16x16x32_bf16 v[200:203], a[248:251], a[152:155], v[200:203]
    v_mfma_f32_16x16x32_bf16 v[204:207], a[248:251], a[156:159], v[204:207]
    v_mfma_f32_16x16x32_bf16 v[208:211], a[252:255], a[152:155], v[208:211]
    buffer_load_dwordx4 v233, s[40:43], s56 offen offset:1024 lds
    v_mfma_f32_16x16x32_bf16 v[212:215], a[252:255], a[156:159], v[212:215]
    s_waitcnt vmcnt(58) lgkmcnt(0)
    v_mfma_f32_16x16x32_bf16 v[152:155], a[192:195], a[160:163], v[152:155]
    ds_read_b64_tr_b16 a[224:225], v240 offset:40960
    ds_read_b64_tr_b16 a[226:227], v240 offset:45056
    v_mfma_f32_16x16x32_bf16 v[156:159], a[192:195], a[164:167], v[156:159]
    ds_read_b64_tr_b16 a[228:229], v241 offset:40960
    ds_read_b64_tr_b16 a[230:231], v241 offset:45056
    v_mfma_f32_16x16x32_bf16 v[160:163], a[196:199], a[160:163], v[160:163]
    ds_read_b64_tr_b16 a[232:233], v242 offset:40960
    ds_read_b64_tr_b16 a[234:235], v242 offset:45056
    buffer_load_dwordx4 a[88:91], v248, s[44:47], s57 offen offset:2048 sc1
    v_mfma_f32_16x16x32_bf16 v[164:167], a[196:199], a[164:167], v[164:167]
    ds_read_b64_tr_b16 a[236:237], v243 offset:40960
    ds_read_b64_tr_b16 a[238:239], v243 offset:45056
    v_mfma_f32_16x16x32_bf16 v[168:171], a[200:203], a[160:163], v[168:171]
    ds_read_b64_tr_b16 a[240:241], v244 offset:40960
    ds_read_b64_tr_b16 a[242:243], v244 offset:45056
    v_mfma_f32_16x16x32_bf16 v[172:175], a[200:203], a[164:167], v[172:175]
    ds_read_b64_tr_b16 a[244:245], v245 offset:40960
    ds_read_b64_tr_b16 a[246:247], v245 offset:45056
    v_mfma_f32_16x16x32_bf16 v[176:179], a[204:207], a[160:163], v[176:179]
    ds_read_b64_tr_b16 a[248:249], v246 offset:40960
    ds_read_b64_tr_b16 a[250:251], v246 offset:45056
    buffer_load_dwordx4 v234, s[40:43], s56 offen offset:2048 lds
    v_mfma_f32_16x16x32_bf16 v[180:183], a[204:207], a[164:167], v[180:183]
    ds_read_b64_tr_b16 a[252:253], v247 offset:40960
    ds_read_b64_tr_b16 a[254:255], v247 offset:45056
    v_mfma_f32_16x16x32_bf16 v[184:187], a[208:211], a[160:163], v[184:187]
    v_mfma_f32_16x16x32_bf16 v[188:191], a[208:211], a[164:167], v[188:191]
    v_mfma_f32_16x16x32_bf16 v[192:195], a[212:215], a[160:163], v[192:195]
    buffer_load_dwordx4 a[92:95], v248, s[44:47], s57 offen offset:2304 sc1
    s_add_u32 s57, s57, 4096
    v_mfma_f32_16x16x32_bf16 v[196:199], a[212:215], a[164:167], v[196:199]
    v_mfma_f32_16x16x32_bf16 v[200:203], a[216:219], a[160:163], v[200:203]
    v_mfma_f32_16x16x32_bf16 v[204:207], a[216:219], a[164:167], v[204:207]
    v_mfma_f32_16x16x32_bf16 v[208:211], a[220:223], a[160:163], v[208:211]
    buffer_load_dwordx4 v235, s[40:43], s56 offen offset:3072 lds
    v_mfma_f32_16x16x32_bf16 v[212:215], a[220:223], a[164:167], v[212:215]
    s_waitcnt vmcnt(58) lgkmcnt(0)
    v_mfma_f32_16x16x32_bf16 v[152:155], a[224:227], a[168:171], v[152:155]
    ds_read_b64_tr_b16 a[192:193], v240 offset:49152
    ds_read_b64_tr_b16 a[194:195], v240 offset:53248
    v_mfma_f32_16x16x32_bf16 v[156:159], a[224:227], a[172:175], v[156:159]
    ds_read_b64_tr_b16 a[196:197], v241 offset:49152
    ds_read_b64_tr_b16 a[198:199], v241 offset:53248
    v_mfma_f32_16x16x32_bf16 v[160:163], a[228:231], a[168:171], v[160:163]
    ds_read_b64_tr_b16 a[200:201], v242 offset:49152
    ds_read_b64_tr_b16 a[202:203], v242 offset:53248
    buffer_load_dwordx4 a[96:99], v248, s[44:47], s57 offen offset:0 sc1
    v_mfma_f32_16x16x32_bf16 v[164:167], a[228:231], a[172:175], v[164:167]
    ds_read_b64_tr_b16 a[204:205], v243 offset:49152
    ds_read_b64_tr_b16 a[206:207], v243 offset:53248
    v_mfma_f32_16x16x32_bf16 v[168:171], a[232:235], a[168:171], v[168:171]
    ds_read_b64_tr_b16 a[208:209], v244 offset:49152
    ds_read_b64_tr_b16 a[210:211], v244 offset:53248
    v_mfma_f32_16x16x32_bf16 v[172:175], a[232:235], a[172:175], v[172:175]
    ds_read_b64_tr_b16 a[212:213], v245 offset:49152
    ds_read_b64_tr_b16 a[214:215], v245 offset:53248
    v_mfma_f32_16x16x32_bf16 v[176:179], a[236:239], a[168:171], v[176:179]
    ds_read_b64_tr_b16 a[216:217], v246 offset:49152
    ds_read_b64_tr_b16 a[218:219], v246 offset:53248
    s_add_u32 m0, s58, 4096
    s_nop 0
    buffer_load_dwordx4 v236, s[40:43], s56 offen offset:0 lds
    v_mfma_f32_16x16x32_bf16 v[180:183], a[236:239], a[172:175], v[180:183]
    ds_read_b64_tr_b16 a[220:221], v247 offset:49152
    ds_read_b64_tr_b16 a[222:223], v247 offset:53248
    v_mfma_f32_16x16x32_bf16 v[184:187], a[240:243], a[168:171], v[184:187]
    v_mfma_f32_16x16x32_bf16 v[188:191], a[240:243], a[172:175], v[188:191]
    v_mfma_f32_16x16x32_bf16 v[192:195], a[244:247], a[168:171], v[192:195]
    buffer_load_dwordx4 a[100:103], v248, s[44:47], s57 offen offset:256 sc1
    v_mfma_f32_16x16x32_bf16 v[196:199], a[244:247], a[172:175], v[196:199]
    v_mfma_f32_16x16x32_bf16 v[200:203], a[248:251], a[168:171], v[200:203]
    v_mfma_f32_16x16x32_bf16 v[204:207], a[248:251], a[172:175], v[204:207]
    v_mfma_f32_16x16x32_bf16 v[208:211], a[252:255], a[168:171], v[208:211]
    buffer_load_dwordx4 v237, s[40:43], s56 offen offset:1024 lds
    v_mfma_f32_16x16x32_bf16 v[212:215], a[252:255], a[172:175], v[212:215]
    s_waitcnt vmcnt(58) lgkmcnt(0)
    v_mfma_f32_16x16x32_bf16 v[152:155], a[192:195], a[176:179], v[152:155]
    ds_read_b64_tr_b16 a[224:225], v240 offset:57344
    ds_read_b64_tr_b16 a[226:227], v240 offset:61440
    v_mfma_f32_16x16x32_bf16 v[156:159], a[192:195], a[180:183], v[156:159]
    ds_read_b64_tr_b16 a[228:229], v241 offset:57344
    ds_read_b64_tr_b16 a[230:231], v241 offset:61440
    v_mfma_f32_16x16x32_bf16 v[160:163], a[196:199], a[176:179], v[160:163]
    ds_read_b64_tr_b16 a[232:233], v242 offset:57344
    ds_read_b64_tr_b16 a[234:235], v242 offset:61440
    buffer_load_dwordx4 a[104:107], v248, s[44:47], s57 offen offset:2048 sc1
    v_mfma_f32_16x16x32_bf16 v[164:167], a[196:199], a[180:183], v[164:167]
    ds_read_b64_tr_b16 a[236:237], v243 offset:57344
    ds_read_b64_tr_b16 a[238:239], v243 offset:61440
    v_mfma_f32_16x16x32_bf16 v[168:171], a[200:203], a[176:179], v[168:171]
    ds_read_b64_tr_b16 a[240:241], v244 offset:57344
    ds_read_b64_tr_b16 a[242:243], v244 offset:61440
    v_mfma_f32_16x16x32_bf16 v[172:175], a[200:203], a[180:183], v[172:175]
    ds_read_b64_tr_b16 a[244:245], v245 offset:57344
    ds_read_b64_tr_b16 a[246:247], v245 offset:61440
    v_mfma_f32_16x16x32_bf16 v[176:179], a[204:207], a[176:179], v[176:179]
    ds_read_b64_tr_b16 a[248:249], v246 offset:57344
    ds_read_b64_tr_b16 a[250:251], v246 offset:61440
    buffer_load_dwordx4 v238, s[40:43], s56 offen offset:2048 lds
    v_mfma_f32_16x16x32_bf16 v[180:183], a[204:207], a[180:183], v[180:183]
    ds_read_b64_tr_b16 a[252:253], v247 offset:57344
    ds_read_b64_tr_b16 a[254:255], v247 offset:61440
    v_mfma_f32_16x16x32_bf16 v[184:187], a[208:211], a[176:179], v[184:187]
    v_mfma_f32_16x16x32_bf16 v[188:191], a[208:211], a[180:183], v[188:191]
    v_mfma_f32_16x16x32_bf16 v[192:195], a[212:215], a[176:179], v[192:195]
    buffer_load_dwordx4 a[108:111], v248, s[44:47], s57 offen offset:2304 sc1
    s_add_u32 s57, s57, 4096
    v_mfma_f32_16x16x32_bf16 v[196:199], a[212:215], a[180:183], v[196:199]
    v_mfma_f32_16x16x32_bf16 v[200:203], a[216:219], a[176:179], v[200:203]
    v_mfma_f32_16x16x32_bf16 v[204:207], a[216:219], a[180:183], v[204:207]
    v_mfma_f32_16x16x32_bf16 v[208:211], a[220:223], a[176:179], v[208:211]
    buffer_load_dwordx4 v239, s[40:43], s56 offen offset:3072 lds
    v_mfma_f32_16x16x32_bf16 v[212:215], a[220:223], a[180:183], v[212:215]
    s_waitcnt vmcnt(33) lgkmcnt(0)
    s_barrier
    v_mfma_f32_16x16x32_bf16 v[152:155], a[224:227], a[184:187], v[152:155]
    s_cmp_eq_u32 s91, 1
    s_cbranch_scc1 L_p2_sig
L_p2_sigback:
    v_xor_b32 v240, 0x10000, v240
    v_xor_b32 v241, 0x10000, v241
    v_xor_b32 v242, 0x10000, v242
    v_mfma_f32_16x16x32_bf16 v[156:159], a[224:227], a[188:191], v[156:159]
    v_xor_b32 v243, 0x10000, v243
    v_xor_b32 v244, 0x10000, v244
    v_xor_b32 v245, 0x10000, v245
    v_mfma_f32_16x16x32_bf16 v[160:163], a[228:231], a[184:187], v[160:163]
    v_xor_b32 v246, 0x10000, v246
    v_xor_b32 v247, 0x10000, v247
    ds_read_b64_tr_b16 a[192:193], v240 offset:0
    buffer_load_dwordx4 a[112:115], v248, s[44:47], s57 offen offset:0 sc1
    v_mfma_f32_16x16x32_bf16 v[164:167], a[228:231], a[188:191], v[164:167]
    ds_read_b64_tr_b16 a[194:195], v240 offset:4096
    ds_read_b64_tr_b16 a[196:197], v241 offset:0
    ds_read_b64_tr_b16 a[198:199], v241 offset:4096
    v_mfma_f32_16x16x32_bf16 v[168:171], a[232:235], a[184:187], v[168:171]
    ds_read_b64_tr_b16 a[200:201], v242 offset:0
    ds_read_b64_tr_b16 a[202:203], v242 offset:4096
    ds_read_b64_tr_b16 a[204:205], v243 offset:0
    s_add_u32 s56, s56, 262144
    s_add_u32 s58, s58, 32768
    s_and_b32 s58, s58, 131071
    s_mov_b32 m0, s58
    s_nop 0
    v_mfma_f32_16x16x32_bf16 v[172:175], a[232:235], a[188:191], v[172:175]
    ds_read_b64_tr_b16 a[206:207], v243 offset:4096
    ds_read_b64_tr_b16 a[208:209], v244 offset:0
    ds_read_b64_tr_b16 a[210:211], v244 offset:4096
    v_mfma_f32_16x16x32_bf16 v[176:179], a[236:239], a[184:187], v[176:179]
    ds_read_b64_tr_b16 a[212:213], v245 offset:0
    ds_read_b64_tr_b16 a[214:215], v245 offset:4096
    ds_read_b64_tr_b16 a[216:217], v246 offset:0
    buffer_load_dwordx4 v232, s[40:43], s56 offen offset:0 lds
    v_mfma_f32_16x16x32_bf16 v[180:183], a[236:239], a[188:191], v[180:183]
    ds_read_b64_tr_b16 a[218:219], v246 offset:4096
    ds_read_b64_tr_b16 a[220:221], v247 offset:0
    ds_read_b64_tr_b16 a[222:223], v247 offset:4096
    v_mfma_f32_16x16x32_bf16 v[184:187], a[240:243], a[184:187], v[184:187]
    v_mfma_f32_16x16x32_bf16 v[188:191], a[240:243], a[188:191], v[188:191]
    v_mfma_f32_16x16x32_bf16 v[192:195], a[244:247], a[184:187], v[192:195]
    buffer_load_dwordx4 a[116:119], v248, s[44:47], s57 offen offset:256 sc1
    v_mfma_f32_16x16x32_bf16 v[196:199], a[244:247], a[188:191], v[196:199]
    v_mfma_f32_16x16x32_bf16 v[200:203], a[248:251], a[184:187], v[200:203]
    v_mfma_f32_16x16x32_bf16 v[204:207], a[248:251], a[188:191], v[204:207]
    v_mfma_f32_16x16x32_bf16 v[208:211], a[252:255], a[184:187], v[208:211]
    buffer_load_dwordx4 v233, s[40:43], s56 offen offset:1024 lds
    v_mfma_f32_16x16x32_bf16 v[212:215], a[252:255], a[188:191], v[212:215]
    s_waitcnt vmcnt(55) lgkmcnt(0)
    v_mfma_f32_16x16x32_bf16 v[152:155], a[192:195], a[0:3], v[152:155]
    ds_read_b64_tr_b16 a[224:225], v240 offset:8192
    ds_read_b64_tr_b16 a[226:227], v240 offset:12288
    v_mfma_f32_16x16x32_bf16 v[156:159], a[192:195], a[4:7], v[156:159]
    ds_read_b64_tr_b16 a[228:229], v241 offset:8192
    ds_read_b64_tr_b16 a[230:231], v241 offset:12288
    v_mfma_f32_16x16x32_bf16 v[160:163], a[196:199], a[0:3], v[160:163]
    ds_read_b64_tr_b16 a[232:233], v242 offset:8192
    ds_read_b64_tr_b16 a[234:235], v242 offset:12288
    buffer_load_dwordx4 a[120:123], v248, s[44:47], s57 offen offset:2048 sc1
    v_mfma_f32_16x16x32_bf16 v[164:167], a[196:199], a[4:7], v[164:167]
    ds_read_b64_tr_b16 a[236:237], v243 offset:8192
    ds_read_b64_tr_b16 a[238:239], v243 offset:12288
    v_mfma_f32_16x16x32_bf16 v[168:171], a[200:203], a[0:3], v[168:171]
    ds_read_b64_tr_b16 a[240:241], v244 offset:8192
    ds_read_b64_tr_b16 a[242:243], v244 offset:12288
    v_mfma_f32_16x16x32_bf16 v[172:175], a[200:203], a[4:7], v[172:175]
    ds_read_b64_tr_b16 a[244:245], v245 offset:8192
    ds_read_b64_tr_b16 a[246:247], v245 offset:12288
    v_mfma_f32_16x16x32_bf16 v[176:179], a[204:207], a[0:3], v[176:179]
    ds_read_b64_tr_b16 a[248:249], v246 offset:8192
    ds_read_b64_tr_b16 a[250:251], v246 offset:12288
    buffer_load_dwordx4 v234, s[40:43], s56 offen offset:2048 lds
    v_mfma_f32_16x16x32_bf16 v[180:183], a[204:207], a[4:7], v[180:183]
    ds_read_b64_tr_b16 a[252:253], v247 offset:8192
    ds_read_b64_tr_b16 a[254:255], v247 offset:12288
    v_mfma_f32_16x16x32_bf16 v[184:187], a[208:211], a[0:3], v[184:187]
    v_mfma_f32_16x16x32_bf16 v[188:191], a[208:211], a[4:7], v[188:191]
    v_mfma_f32_16x16x32_bf16 v[192:195], a[212:215], a[0:3], v[192:195]
    buffer_load_dwordx4 a[124:127], v248, s[44:47], s57 offen offset:2304 sc1
    s_add_u32 s57, s57, 4096
    v_mfma_f32_16x16x32_bf16 v[196:199], a[212:215], a[4:7], v[196:199]
    v_mfma_f32_16x16x32_bf16 v[200:203], a[216:219], a[0:3], v[200:203]
    v_mfma_f32_16x16x32_bf16 v[204:207], a[216:219], a[4:7], v[204:207]
    v_mfma_f32_16x16x32_bf16 v[208:211], a[220:223], a[0:3], v[208:211]
    buffer_load_dwordx4 v235, s[40:43], s56 offen offset:3072 lds
    v_mfma_f32_16x16x32_bf16 v[212:215], a[220:223], a[4:7], v[212:215]
    s_waitcnt vmcnt(57) lgkmcnt(0)
    v_mfma_f32_16x16x32_bf16 v[152:155], a[224:227], a[8:11], v[152:155]
    s_cmp_eq_u32 s29, 1
    s_cselect_b32 s46, 0, s46
    ds_read_b64_tr_b16 a[192:193], v240 offset:16384
    ds_read_b64_tr_b16 a[194:195], v240 offset:20480
    v_mfma_f32_16x16x32_bf16 v[156:159], a[224:227], a[12:15], v[156:159]
    ds_read_b64_tr_b16 a[196:197], v241 offset:16384
    ds_read_b64_tr_b16 a[198:199], v241 offset:20480
    v_mfma_f32_16x16x32_bf16 v[160:163], a[228:231], a[8:11], v[160:163]
    ds_read_b64_tr_b16 a[200:201], v242 offset:16384
    ds_read_b64_tr_b16 a[202:203], v242 offset:20480
    buffer_load_dwordx4 a[128:131], v248, s[44:47], s57 offen offset:0 sc1
    v_mfma_f32_16x16x32_bf16 v[164:167], a[228:231], a[12:15], v[164:167]
    ds_read_b64_tr_b16 a[204:205], v243 offset:16384
    ds_read_b64_tr_b16 a[206:207], v243 offset:20480
    v_mfma_f32_16x16x32_bf16 v[168:171], a[232:235], a[8:11], v[168:171]
    ds_read_b64_tr_b16 a[208:209], v244 offset:16384
    ds_read_b64_tr_b16 a[210:211], v244 offset:20480
    v_mfma_f32_16x16x32_bf16 v[172:175], a[232:235], a[12:15], v[172:175]
    ds_read_b64_tr_b16 a[212:213], v245 offset:16384
    ds_read_b64_tr_b16 a[214:215], v245 offset:20480
    v_mfma_f32_16x16x32_bf16 v[176:179], a[236:239], a[8:11], v[176:179]
    ds_read_b64_tr_b16 a[216:217], v246 offset:16384
    ds_read_b64_tr_b16 a[218:219], v246 offset:20480
    s_add_u32 m0, s58, 4096
    s_nop 0
    buffer_load_dwordx4 v236, s[40:43], s56 offen offset:0 lds
    v_mfma_f32_16x16x32_bf16 v[180:183], a[236:239], a[12:15], v[180:183]
    ds_read_b64_tr_b16 a[220:221], v247 offset:16384
    ds_read_b64_tr_b16 a[222:223], v247 offset:20480
    v_mfma_f32_16x16x32_bf16 v[184:187], a[240:243], a[8:11], v[184:187]
    v_mfma_f32_16x16x32_bf16 v[188:191], a[240:243], a[12:15], v[188:191]
    v_mfma_f32_16x16x32_bf16 v[192:195], a[244:247], a[8:11], v[192:195]
    buffer_load_dwordx4 a[132:135], v248, s[44:47], s57 offen offset:256 sc1
    v_mfma_f32_16x16x32_bf16 v[196:199], a[244:247], a[12:15], v[196:199]
    v_mfma_f32_16x16x32_bf16 v[200:203], a[248:251], a[8:11], v[200:203]
    v_mfma_f32_16x16x32_bf16 v[204:207], a[248:251], a[12:15], v[204:207]
    v_mfma_f32_16x16x32_bf16 v[208:211], a[252:255], a[8:11], v[208:211]
    buffer_load_dwordx4 v237, s[40:43], s56 offen offset:1024 lds
    v_mfma_f32_16x16x32_bf16 v[212:215], a[252:255], a[12:15], v[212:215]
    s_waitcnt vmcnt(58) lgkmcnt(0)
    v_mfma_f32_16x16x32_bf16 v[152:155], a[192:195], a[16:19], v[152:155]
    ds_read_b64_tr_b16 a[224:225], v240 offset:24576
    ds_read_b64_tr_b16 a[226:227], v240 offset:28672
    v_mfma_f32_16x16x32_bf16 v[156:159], a[192:195], a[20:23], v[156:159]
    ds_read_b64_tr_b16 a[228:229], v241 offset:24576
    ds_read_b64_tr_b16 a[230:231], v241 offset:28672
    v_mfma_f32_16x16x32_bf16 v[160:163], a[196:199], a[16:19], v[160:163]
    ds_read_b64_tr_b16 a[232:233], v242 offset:24576
    ds_read_b64_tr_b16 a[234:235], v242 offset:28672
    buffer_load_dwordx4 a[136:139], v248, s[44:47], s57 offen offset:2048 sc1
    v_mfma_f32_16x16x32_bf16 v[164:167], a[196:199], a[20:23], v[164:167]
    ds_read_b64_tr_b16 a[236:237], v243 offset:24576
    ds_read_b64_tr_b16 a[238:239], v243 offset:28672
    v_mfma_f32_16x16x32_bf16 v[168:171], a[200:203], a[16:19], v[168:171]
    ds_read_b64_tr_b16 a[240:241], v244 offset:24576
    ds_read_b64_tr_b16 a[242:243], v244 offset:28672
    v_mfma_f32_16x16x32_bf16 v[172:175], a[200:203], a[20:23], v[172:175]
    ds_read_b64_tr_b16 a[244:245], v245 offset:24576
    ds_read_b64_tr_b16 a[246:247], v245 offset:28672
    v_mfma_f32_16x16x32_bf16 v[176:179], a[204:207], a[16:19], v[176:179]
    ds_read_b64_tr_b16 a[248:249], v246 offset:24576
    ds_read_b64_tr_b16 a[250:251], v246 offset:28672
    buffer_load_dwordx4 v238, s[40:43], s56 offen offset:2048 lds
    v_mfma_f32_16x16x32_bf16 v[180:183], a[204:207], a[20:23], v[180:183]
    ds_read_b64_tr_b16 a[252:253], v247 offset:24576
    ds_read_b64_tr_b16 a[254:255], v247 offset:28672
    v_mfma_f32_16x16x32_bf16 v[184:187], a[208:211], a[16:19], v[184:187]
    v_mfma_f32_16x16x32_bf16 v[188:191], a[208:211], a[20:23], v[188:191]
    v_mfma_f32_16x16x32_bf16 v[192:195], a[212:215], a[16:19], v[192:195]
    buffer_load_dwordx4 a[140:143], v248, s[44:47], s57 offen offset:2304 sc1
    s_add_u32 s57, s57, 4096
    v_mfma_f32_16x16x32_bf16 v[196:199], a[212:215], a[20:23], v[196:199]
    v_mfma_f32_16x16x32_bf16 v[200:203], a[216:219], a[16:19], v[200:203]
    v_mfma_f32_16x16x32_bf16 v[204:207], a[216:219], a[20:23], v[204:207]
    v_mfma_f32_16x16x32_bf16 v[208:211], a[220:223], a[16:19], v[208:211]
    buffer_load_dwordx4 v239, s[40:43], s56 offen offset:3072 lds
    v_mfma_f32_16x16x32_bf16 v[212:215], a[220:223], a[20:23], v[212:215]
    s_waitcnt vmcnt(32) lgkmcnt(0)
    s_barrier
    v_mfma_f32_16x16x32_bf16 v[152:155], a[224:227], a[24:27], v[152:155]
    ds_read_b64_tr_b16 a[192:193], v240 offset:32768
    ds_read_b64_tr_b16 a[194:195], v240 offset:36864
    v_mfma_f32_16x16x32_bf16 v[156:159], a[224:227], a[28:31], v[156:159]
    ds_read_b64_tr_b16 a[196:197], v241 offset:32768
    ds_read_b64_tr_b16 a[198:199], v241 offset:36864
    v_mfma_f32_16x16x32_bf16 v[160:163], a[228:231], a[24:27], v[160:163]
    ds_read_b64_tr_b16 a[200:201], v242 offset:32768
    ds_read_b64_tr_b16 a[202:203], v242 offset:36864
    buffer_load_dwordx4 a[144:147], v248, s[44:47], s57 offen offset:0 sc1
    v_mfma_f32_16x16x32_bf16 v[164:167], a[228:231], a[28:31], v[164:167]
    ds_read_b64_tr_b16 a[204:205], v243 offset:32768
    ds_read_b64_tr_b16 a[206:207], v243 offset:36864
    v_mfma_f32_16x16x32_bf16 v[168:171], a[232:235], a[24:27], v[168:171]
    ds_read_b64_tr_b16 a[208:209], v244 offset:32768
    ds_read_b64_tr_b16 a[210:211], v244 offset:36864
    s_add_u32 s56, s56, 262144
    s_add_u32 s58, s58, 32768
    s_and_b32 s58, s58, 131071
    s_mov_b32 m0, s58
    s_nop 0
    v_mfma_f32_16x16x32_bf16 v[172:175], a[232:235], a[28:31], v[172:175]
    ds_read_b64_tr_b16 a[212:213], v245 offset:32768
    ds_read_b64_tr_b16 a[214:215], v245 offset:36864
    v_mfma_f32_16x16x32_bf16 v[176:179], a[236:239], a[24:27], v[176:179]
    ds_read_b64_tr_b16 a[216:217], v246 offset:32768
    ds_read_b64_tr_b16 a[218:219], v246 offset:36864
    buffer_load_dwordx4 v232, s[40:43], s56 offen offset:0 lds
    v_mfma_f32_16x16x32_bf16 v[180:183], a[236:239], a[28:31], v[180:183]
    ds_read_b64_tr_b16 a[220:221], v247 offset:32768
    ds_read_b64_tr_b16 a[222:223], v247 offset:36864
    v_mfma_f32_16x16x32_bf16 v[184:187], a[240:243], a[24:27], v[184:187]
    v_mfma_f32_16x16x32_bf16 v[188:191], a[240:243], a[28:31], v[188:191]
    v_mfma_f32_16x16x32_bf16 v[192:195], a[244:247], a[24:27], v[192:195]
    buffer_load_dwordx4 a[148:151], v248, s[44:47], s57 offen offset:256 sc1
    v_mfma_f32_16x16x32_bf16 v[196:199], a[244:247], a[28:31], v[196:199]
    v_mfma_f32_16x16x32_bf16 v[200:203], a[248:251], a[24:27], v[200:203]
    v_mfma_f32_16x16x32_bf16 v[204:207], a[248:251], a[28:31], v[204:207]
    v_mfma_f32_16x16x32_bf16 v[208:211], a[252:255], a[24:27], v[208:211]
    buffer_load_dwordx4 v233, s[40:43], s56 offen offset:1024 lds
    v_mfma_f32_16x16x32_bf16 v[212:215], a[252:255], a[28:31], v[212:215]
    s_waitcnt vmcnt(58) lgkmcnt(0)
    v_mfma_f32_16x16x32_bf16 v[152:155], a[192:195], a[32:35], v[152:155]
    ds_read_b64_tr_b16 a[224:225], v240 offset:40960
    ds_read_b64_tr_b16 a[226:227], v240 offset:45056
    v_mfma_f32_16x16x32_bf16 v[156:159], a[192:195], a[36:39], v[156:159]
    ds_read_b64_tr_b16 a[228:229], v241 offset:40960
    ds_read_b64_tr_b16 a[230:231], v241 offset:45056
    v_mfma_f32_16x16x32_bf16 v[160:163], a[196:199], a[32:35], v[160:163]
    ds_read_b64_tr_b16 a[232:233], v242 offset:40960
    ds_read_b64_tr_b16 a[234:235], v242 offset:45056
    buffer_load_dwordx4 a[152:155], v248, s[44:47], s57 offen offset:2048 sc1
    v_mfma_f32_16x16x32_bf16 v[164:167], a[196:199], a[36:39], v[164:167]
    ds_read_b64_tr_b16 a[236:237], v243 offset:40960
    ds_read_b64_tr_b16 a[238:239], v243 offset:45056
    v_mfma_f32_16x16x32_bf16 v[168:171], a[200:203], a[32:35], v[168:171]
    ds_read_b64_tr_b16 a[240:241], v244 offset:40960
    ds_read_b64_tr_b16 a[242:243], v244 offset:45056
    v_mfma_f32_16x16x32_bf16 v[172:175], a[200:203], a[36:39], v[172:175]
    ds_read_b64_tr_b16 a[244:245], v245 offset:40960
    ds_read_b64_tr_b16 a[246:247], v245 offset:45056
    v_mfma_f32_16x16x32_bf16 v[176:179], a[204:207], a[32:35], v[176:179]
    ds_read_b64_tr_b16 a[248:249], v246 offset:40960
    ds_read_b64_tr_b16 a[250:251], v246 offset:45056
    buffer_load_dwordx4 v234, s[40:43], s56 offen offset:2048 lds
    v_mfma_f32_16x16x32_bf16 v[180:183], a[204:207], a[36:39], v[180:183]
    ds_read_b64_tr_b16 a[252:253], v247 offset:40960
    ds_read_b64_tr_b16 a[254:255], v247 offset:45056
    v_mfma_f32_16x16x32_bf16 v[184:187], a[208:211], a[32:35], v[184:187]
    v_mfma_f32_16x16x32_bf16 v[188:191], a[208:211], a[36:39], v[188:191]
    v_mfma_f32_16x16x32_bf16 v[192:195], a[212:215], a[32:35], v[192:195]
    buffer_load_dwordx4 a[156:159], v248, s[44:47], s57 offen offset:2304 sc1
    s_add_u32 s57, s57, 4096
    v_mfma_f32_16x16x32_bf16 v[196:199], a[212:215], a[36:39], v[196:199]
    v_mfma_f32_16x16x32_bf16 v[200:203], a[216:219], a[32:35], v[200:203]
    v_mfma_f32_16x16x32_bf16 v[204:207], a[216:219], a[36:39], v[204:207]
    v_mfma_f32_16x16x32_bf16 v[208:211], a[220:223], a[32:35], v[208:211]
    buffer_load_dwordx4 v235, s[40:43], s56 offen offset:3072 lds
    v_mfma_f32_16x16x32_bf16 v[212:215], a[220:223], a[36:39], v[212:215]
    s_waitcnt vmcnt(58) lgkmcnt(0)
    v_mfma_f32_16x16x32_bf16 v[152:155], a[224:227], a[40:43], v[152:155]
    ds_read_b64_tr_b16 a[192:193], v240 offset:49152
    ds_read_b64_tr_b16 a[194:195], v240 offset:53248
    v_mfma_f32_16x16x32_bf16 v[156:159], a[224:227], a[44:47], v[156:159]
    ds_read_b64_tr_b16 a[196:197], v241 offset:49152
    ds_read_b64_tr_b16 a[198:199], v241 offset:53248
    v_mfma_f32_16x16x32_bf16 v[160:163], a[228:231], a[40:43], v[160:163]
    ds_read_b64_tr_b16 a[200:201], v242 offset:49152
    ds_read_b64_tr_b16 a[202:203], v242 offset:53248
    buffer_load_dwordx4 a[160:163], v248, s[44:47], s57 offen offset:0 sc1
    v_mfma_f32_16x16x32_bf16 v[164:167], a[228:231], a[44:47], v[164:167]
    ds_read_b64_tr_b16 a[204:205], v243 offset:49152
    ds_read_b64_tr_b16 a[206:207], v243 offset:53248
    v_mfma_f32_16x16x32_bf16 v[168:171], a[232:235], a[40:43], v[168:171]
    ds_read_b64_tr_b16 a[208:209], v244 offset:49152
    ds_read_b64_tr_b16 a[210:211], v244 offset:53248
    v_mfma_f32_16x16x32_bf16 v[172:175], a[232:235], a[44:47], v[172:175]
    ds_read_b64_tr_b16 a[212:213], v245 offset:49152
    ds_read_b64_tr_b16 a[214:215], v245 offset:53248
    v_mfma_f32_16x16x32_bf16 v[176:179], a[236:239], a[40:43], v[176:179]
    ds_read_b64_tr_b16 a[216:217], v246 offset:49152
    ds_read_b64_tr_b16 a[218:219], v246 offset:53248
    s_add_u32 m0, s58, 4096
    s_nop 0
    buffer_load_dwordx4 v236, s[40:43], s56 offen offset:0 lds
    v_mfma_f32_16x16x32_bf16 v[180:183], a[236:239], a[44:47], v[180:183]
    ds_read_b64_tr_b16 a[220:221], v247 offset:49152
    ds_read_b64_tr_b16 a[222:223], v247 offset:53248
    v_mfma_f32_16x16x32_bf16 v[184:187], a[240:243], a[40:43], v[184:187]
    v_mfma_f32_16x16x32_bf16 v[188:191], a[240:243], a[44:47], v[188:191]
    v_mfma_f32_16x16x32_bf16 v[192:195], a[244:247], a[40:43], v[192:195]
    buffer_load_dwordx4 a[164:167], v248, s[44:47], s57 offen offset:256 sc1
    v_mfma_f32_16x16x32_bf16 v[196:199], a[244:247], a[44:47], v[196:199]
    v_mfma_f32_16x16x32_bf16 v[200:203], a[248:251], a[40:43], v[200:203]
    v_mfma_f32_16x16x32_bf16 v[204:207], a[248:251], a[44:47], v[204:207]
    v_mfma_f32_16x16x32_bf16 v[208:211], a[252:255], a[40:43], v[208:211]
    buffer_load_dwordx4 v237, s[40:43], s56 offen offset:1024 lds
    v_mfma_f32_16x16x32_bf16 v[212:215], a[252:255], a[44:47], v[212:215]
    s_waitcnt vmcnt(58) lgkmcnt(0)
    v_mfma_f32_16x16x32_bf16 v[152:155], a[192:195], a[48:51], v[152:155]
    ds_read_b64_tr_b16 a[224:225], v240 offset:57344
    ds_read_b64_tr_b16 a[226:227], v240 offset:61440
    v_mfma_f32_16x16x32_bf16 v[156:159], a[192:195], a[52:55], v[156:159]
    ds_read_b64_tr_b16 a[228:229], v241 offset:57344
    ds_read_b64_tr_b16 a[230:231], v241 offset:61440
    v_mfma_f32_16x16x32_bf16 v[160:163], a[196:199], a[48:51], v[160:163]
    ds_read_b64_tr_b16 a[232:233], v242 offset:57344
    ds_read_b64_tr_b16 a[234:235], v242 offset:61440
    buffer_load_dwordx4 a[168:171], v248, s[44:47], s57 offen offset:2048 sc1
    v_mfma_f32_16x16x32_bf16 v[164:167], a[196:199], a[52:55], v[164:167]
    ds_read_b64_tr_b16 a[236:237], v243 offset:57344
    ds_read_b64_tr_b16 a[238:239], v243 offset:61440
    v_mfma_f32_16x16x32_bf16 v[168:171], a[200:203], a[48:51], v[168:171]
    ds_read_b64_tr_b16 a[240:241], v244 offset:57344
    ds_read_b64_tr_b16 a[242:243], v244 offset:61440
    v_mfma_f32_16x16x32_bf16 v[172:175], a[200:203], a[52:55], v[172:175]
    ds_read_b64_tr_b16 a[244:245], v245 offset:57344
    ds_read_b64_tr_b16 a[246:247], v245 offset:61440
    v_mfma_f32_16x16x32_bf16 v[176:179], a[204:207], a[48:51], v[176:179]
    ds_read_b64_tr_b16 a[248:249], v246 offset:57344
    ds_read_b64_tr_b16 a[250:251], v246 offset:61440
    buffer_load_dwordx4 v238, s[40:43], s56 offen offset:2048 lds
    v_mfma_f32_16x16x32_bf16 v[180:183], a[204:207], a[52:55], v[180:183]
    ds_read_b64_tr_b16 a[252:253], v247 offset:57344
    ds_read_b64_tr_b16 a[254:255], v247 offset:61440
    v_mfma_f32_16x16x32_bf16 v[184:187], a[208:211], a[48:51], v[184:187]
    v_mfma_f32_16x16x32_bf16 v[188:191], a[208:211], a[52:55], v[188:191]
    v_mfma_f32_16x16x32_bf16 v[192:195], a[212:215], a[48:51], v[192:195]
    buffer_load_dwordx4 a[172:175], v248, s[44:47], s57 offen offset:2304 sc1
    s_add_u32 s57, s57, 4096
    v_mfma_f32_16x16x32_bf16 v[196:199], a[212:215], a[52:55], v[196:199]
    v_mfma_f32_16x16x32_bf16 v[200:203], a[216:219], a[48:51], v[200:203]
    v_mfma_f32_16x16x32_bf16 v[204:207], a[216:219], a[52:55], v[204:207]
    v_mfma_f32_16x16x32_bf16 v[208:211], a[220:223], a[48:51], v[208:211]
    buffer_load_dwordx4 v239, s[40:43], s56 offen offset:3072 lds
    v_mfma_f32_16x16x32_bf16 v[212:215], a[220:223], a[52:55], v[212:215]
    s_waitcnt vmcnt(32) lgkmcnt(0)
    s_barrier
    v_mfma_f32_16x16x32_bf16 v[152:155], a[224:227], a[56:59], v[152:155]
    v_xor_b32 v240, 0x10000, v240
    v_xor_b32 v241, 0x10000, v241
    v_xor_b32 v242, 0x10000, v242
    v_mfma_f32_16x16x32_bf16 v[156:159], a[224:227], a[60:63], v[156:159]
    v_xor_b32 v243, 0x10000, v243
    v_xor_b32 v244, 0x10000, v244
    v_xor_b32 v245, 0x10000, v245
    v_mfma_f32_16x16x32_bf16 v[160:163], a[228:231], a[56:59], v[160:163]
    v_xor_b32 v246, 0x10000, v246
    v_xor_b32 v247, 0x10000, v247
    ds_read_b64_tr_b16 a[192:193], v240 offset:0
    buffer_load_dwordx4 a[176:179], v248, s[44:47], s57 offen offset:0 sc1
    v_mfma_f32_16x16x32_bf16 v[164:167], a[228:231], a[60:63], v[164:167]
    ds_read_b64_tr_b16 a[194:195], v240 offset:4096
    ds_read_b64_tr_b16 a[196:197], v241 offset:0
    ds_read_b64_tr_b16 a[198:199], v241 offset:4096
    v_mfma_f32_16x16x32_bf16 v[168:171], a[232:235], a[56:59], v[168:171]
    ds_read_b64_tr_b16 a[200:201], v242 offset:0
    ds_read_b64_tr_b16 a[202:203], v242 offset:4096
    ds_read_b64_tr_b16 a[204:205], v243 offset:0
    s_add_u32 s56, s56, 262144
    s_add_u32 s58, s58, 32768
    s_and_b32 s58, s58, 131071
    s_mov_b32 m0, s58
    s_nop 0
    v_mfma_f32_16x16x32_bf16 v[172:175], a[232:235], a[60:63], v[172:175]
    ds_read_b64_tr_b16 a[206:207], v243 offset:4096
    ds_read_b64_tr_b16 a[208:209], v244 offset:0
    ds_read_b64_tr_b16 a[210:211], v244 offset:4096
    v_mfma_f32_16x16x32_bf16 v[176:179], a[236:239], a[56:59], v[176:179]
    ds_read_b64_tr_b16 a[212:213], v245 offset:0
    ds_read_b64_tr_b16 a[214:215], v245 offset:4096
    ds_read_b64_tr_b16 a[216:217], v246 offset:0
    buffer_load_dwordx4 v232, s[40:43], s56 offen offset:0 lds
    v_mfma_f32_16x16x32_bf16 v[180:183], a[236:239], a[60:63], v[180:183]
    ds_read_b64_tr_b16 a[218:219], v246 offset:4096
    ds_read_b64_tr_b16 a[220:221], v247 offset:0
    ds_read_b64_tr_b16 a[222:223], v247 offset:4096
    v_mfma_f32_16x16x32_bf16 v[184:187], a[240:243], a[56:59], v[184:187]
    v_mfma_f32_16x16x32_bf16 v[188:191], a[240:243], a[60:63], v[188:191]
    v_mfma_f32_16x16x32_bf16 v[192:195], a[244:247], a[56:59], v[192:195]
    buffer_load_dwordx4 a[180:183], v248, s[44:47], s57 offen offset:256 sc1
    v_mfma_f32_16x16x32_bf16 v[196:199], a[244:247], a[60:63], v[196:199]
    v_mfma_f32_16x16x32_bf16 v[200:203], a[248:251], a[56:59], v[200:203]
    v_mfma_f32_16x16x32_bf16 v[204:207], a[248:251], a[60:63], v[204:207]
    v_mfma_f32_16x16x32_bf16 v[208:211], a[252:255], a[56:59], v[208:211]
    buffer_load_dwordx4 v233, s[40:43], s56 offen offset:1024 lds
    v_mfma_f32_16x16x32_bf16 v[212:215], a[252:255], a[60:63], v[212:215]
    s_waitcnt vmcnt(58) lgkmcnt(0)
    v_mfma_f32_16x16x32_bf16 v[152:155], a[192:195], a[64:67], v[152:155]
    ds_read_b64_tr_b16 a[224:225], v240 offset:8192
    ds_read_b64_tr_b16 a[226:227], v240 offset:12288
    v_mfma_f32_16x16x32_bf16 v[156:159], a[192:195], a[68:71], v[156:159]
    ds_read_b64_tr_b16 a[228:229], v241 offset:8192
    ds_read_b64_tr_b16 a[230:231], v241 offset:12288
    v_mfma_f32_16x16x32_bf16 v[160:163], a[196:199], a[64:67], v[160:163]
    ds_read_b64_tr_b16 a[232:233], v242 offset:8192
    ds_read_b64_tr_b16 a[234:235], v242 offset:12288
    buffer_load_dwordx4 a[184:187], v248, s[44:47], s57 offen offset:2048 sc1
    v_mfma_f32_16x16x32_bf16 v[164:167], a[196:199], a[68:71], v[164:167]
    ds_read_b64_tr_b16 a[236:237], v243 offset:8192
    ds_read_b64_tr_b16 a[238:239], v243 offset:12288
    v_mfma_f32_16x16x32_bf16 v[168:171], a[200:203], a[64:67], v[168:171]
    ds_read_b64_tr_b16 a[240:241], v244 offset:8192
    ds_read_b64_tr_b16 a[242:243], v244 offset:12288
    v_mfma_f32_16x16x32_bf16 v[172:175], a[200:203], a[68:71], v[172:175]
    ds_read_b64_tr_b16 a[244:245], v245 offset:8192
    ds_read_b64_tr_b16 a[246:247], v245 offset:12288
    v_mfma_f32_16x16x32_bf16 v[176:179], a[204:207], a[64:67], v[176:179]
    ds_read_b64_tr_b16 a[248:249], v246 offset:8192
    ds_read_b64_tr_b16 a[250:251], v246 offset:12288
    buffer_load_dwordx4 v234, s[40:43], s56 offen offset:2048 lds
    v_mfma_f32_16x16x32_bf16 v[180:183], a[204:207], a[68:71], v[180:183]
    ds_read_b64_tr_b16 a[252:253], v247 offset:8192
    ds_read_b64_tr_b16 a[254:255], v247 offset:12288
    v_mfma_f32_16x16x32_bf16 v[184:187], a[208:211], a[64:67], v[184:187]
    v_mfma_f32_16x16x32_bf16 v[188:191], a[208:211], a[68:71], v[188:191]
    v_mfma_f32_16x16x32_bf16 v[192:195], a[212:215], a[64:67], v[192:195]
    buffer_load_dwordx4 a[188:191], v248, s[44:47], s57 offen offset:2304 sc1
    s_add_u32 s57, s57, 4096
    v_mfma_f32_16x16x32_bf16 v[196:199], a[212:215], a[68:71], v[196:199]
    v_mfma_f32_16x16x32_bf16 v[200:203], a[216:219], a[64:67], v[200:203]
    v_mfma_f32_16x16x32_bf16 v[204:207], a[216:219], a[68:71], v[204:207]
    v_mfma_f32_16x16x32_bf16 v[208:211], a[220:223], a[64:67], v[208:211]
    buffer_load_dwordx4 v235, s[40:43], s56 offen offset:3072 lds
    v_mfma_f32_16x16x32_bf16 v[212:215], a[220:223], a[68:71], v[212:215]
    s_waitcnt vmcnt(57) lgkmcnt(0)
    v_mfma_f32_16x16x32_bf16 v[152:155], a[224:227], a[72:75], v[152:155]
    s_cmp_eq_u32 s29, s90
    s_cbranch_scc1 L_p2_asw
L_p2_aback:
    ds_read_b64_tr_b16 a[192:193], v240 offset:16384
    ds_read_b64_tr_b16 a[194:195], v240 offset:20480
    v_mfma_f32_16x16x32_bf16 v[156:159], a[224:227], a[76:79], v[156:159]
    ds_read_b64_tr_b16 a[196:197], v241 offset:16384
    ds_read_b64_tr_b16 a[198:199], v241 offset:20480
    v_mfma_f32_16x16x32_bf16 v[160:163], a[228:231], a[72:75], v[160:163]
    ds_read_b64_tr_b16 a[200:201], v242 offset:16384
    ds_read_b64_tr_b16 a[202:203], v242 offset:20480
    buffer_load_dwordx4 a[0:3], v248, s[44:47], s57 offen offset:0 sc1
    v_mfma_f32_16x16x32_bf16 v[164:167], a[228:231], a[76:79], v[164:167]
    ds_read_b64_tr_b16 a[204:205], v243 offset:16384
    ds_read_b64_tr_b16 a[206:207], v243 offset:20480
    v_mfma_f32_16x16x32_bf16 v[168:171], a[232:235], a[72:75], v[168:171]
    ds_read_b64_tr_b16 a[208:209], v244 offset:16384
    ds_read_b64_tr_b16 a[210:211], v244 offset:20480
    v_mfma_f32_16x16x32_bf16 v[172:175], a[232:235], a[76:79], v[172:175]
    ds_read_b64_tr_b16 a[212:213], v245 offset:16384
    ds_read_b64_tr_b16 a[214:215], v245 offset:20480
    v_mfma_f32_16x16x32_bf16 v[176:179], a[236:239], a[72:75], v[176:179]
    ds_read_b64_tr_b16 a[216:217], v246 offset:16384
    ds_read_b64_tr_b16 a[218:219], v246 offset:20480
    s_add_u32 m0, s58, 4096
    s_nop 0
    buffer_load_dwordx4 v236, s[40:43], s56 offen offset:0 lds
    v_mfma_f32_16x16x32_bf16 v[180:183], a[236:239], a[76:79], v[180:183]
    ds_read_b64_tr_b16 a[220:221], v247 offset:16384
    ds_read_b64_tr_b16 a[222:223], v247 offset:20480
    v_mfma_f32_16x16x32_bf16 v[184:187], a[240:243], a[72:75], v[184:187]
    v_mfma_f32_16x16x32_bf16 v[188:191], a[240:243], a[76:79], v[188:191]
    v_mfma_f32_16x16x32_bf16 v[192:195], a[244:247], a[72:75], v[192:195]
    buffer_load_dwordx4 a[4:7], v248, s[44:47], s57 offen offset:256 sc1
    v_mfma_f32_16x16x32_bf16 v[196:199], a[244:247], a[76:79], v[196:199]
    v_mfma_f32_16x16x32_bf16 v[200:203], a[248:251], a[72:75], v[200:203]
    v_mfma_f32_16x16x32_bf16 v[204:207], a[248:251], a[76:79], v[204:207]
    v_mfma_f32_16x16x32_bf16 v[208:211], a[252:255], a[72:75], v[208:211]
    buffer_load_dwordx4 v237, s[40:43], s56 offen offset:1024 lds
    v_mfma_f32_16x16x32_bf16 v[212:215], a[252:255], a[76:79], v[212:215]
    s_waitcnt vmcnt(57) lgkmcnt(0)
    v_mfma_f32_16x16x32_bf16 v[152:155], a[192:195], a[80:83], v[152:155]
    ds_read_b64_tr_b16 a[224:225], v240 offset:24576
    ds_read_b64_tr_b16 a[226:227], v240 offset:28672
    v_mfma_f32_16x16x32_bf16 v[156:159], a[192:195], a[84:87], v[156:159]
    ds_read_b64_tr_b16 a[228:229], v241 offset:24576
    ds_read_b64_tr_b16 a[230:231], v241 offset:28672
    v_mfma_f32_16x16x32_bf16 v[160:163], a[196:199], a[80:83], v[160:163]
    ds_read_b64_tr_b16 a[232:233], v242 offset:24576
    ds_read_b64_tr_b16 a[234:235], v242 offset:28672
    buffer_load_dwordx4 a[8:11], v248, s[44:47], s57 offen offset:2048 sc1
    v_mfma_f32_16x16x32_bf16 v[164:167], a[196:199], a[84:87], v[164:167]
    ds_read_b64_tr_b16 a[236:237], v243 offset:24576
    ds_read_b64_tr_b16 a[238:239], v243 offset:28672
    v_mfma_f32_16x16x32_bf16 v[168:171], a[200:203], a[80:83], v[168:171]
    ds_read_b64_tr_b16 a[240:241], v244 offset:24576
    ds_read_b64_tr_b16 a[242:243], v244 offset:28672
    v_mfma_f32_16x16x32_bf16 v[172:175], a[200:203], a[84:87], v[172:175]
    ds_read_b64_tr_b16 a[244:245], v245 offset:24576
    ds_read_b64_tr_b16 a[246:247], v245 offset:28672
    v_mfma_f32_16x16x32_bf16 v[176:179], a[204:207], a[80:83], v[176:179]
    ds_read_b64_tr_b16 a[248:249], v246 offset:24576
    ds_read_b64_tr_b16 a[250:251], v246 offset:28672
    buffer_load_dwordx4 v238, s[40:43], s56 offen offset:2048 lds
    v_mfma_f32_16x16x32_bf16 v[180:183], a[204:207], a[84:87], v[180:183]
    ds_read_b64_tr_b16 a[252:253], v247 offset:24576
    ds_read_b64_tr_b16 a[254:255], v247 offset:28672
    v_mfma_f32_16x16x32_bf16 v[184:187], a[208:211], a[80:83], v[184:187]
    v_mfma_f32_16x16x32_bf16 v[188:191], a[208:211], a[84:87], v[188:191]
    v_mfma_f32_16x16x32_bf16 v[192:195], a[212:215], a[80:83], v[192:195]
    buffer_load_dwordx4 a[12:15], v248, s[44:47], s57 offen offset:2304 sc1
    s_add_u32 s57, s57, 4096
    v_mfma_f32_16x16x32_bf16 v[196:199], a[212:215], a[84:87], v[196:199]
    v_mfma_f32_16x16x32_bf16 v[200:203], a[216:219], a[80:83], v[200:203]
    v_mfma_f32_16x16x32_bf16 v[204:207], a[216:219], a[84:87], v[204:207]
    v_mfma_f32_16x16x32_bf16 v[208:211], a[220:223], a[80:83], v[208:211]
    buffer_load_dwordx4 v239, s[40:43], s56 offen offset:3072 lds
    v_mfma_f32_16x16x32_bf16 v[212:215], a[220:223], a[84:87], v[212:215]
    s_waitcnt vmcnt(32) lgkmcnt(0)
    s_barrier
    v_mfma_f32_16x16x32_bf16 v[152:155], a[224:227], a[88:91], v[152:155]
    ds_read_b64_tr_b16 a[192:193], v240 offset:32768
    ds_read_b64_tr_b16 a[194:195], v240 offset:36864
    v_mfma_f32_16x16x32_bf16 v[156:159], a[224:227], a[92:95], v[156:159]
    ds_read_b64_tr_b16 a[196:197], v241 offset:32768
    ds_read_b64_tr_b16 a[198:199], v241 offset:36864
    v_mfma_f32_16x16x32_bf16 v[160:163], a[228:231], a[88:91], v[160:163]
    ds_read_b64_tr_b16 a[200:201], v242 offset:32768
    ds_read_b64_tr_b16 a[202:203], v242 offset:36864
    buffer_load_dwordx4 a[16:19], v248, s[44:47], s57 offen offset:0 sc1
    v_mfma_f32_16x16x32_bf16 v[164:167], a[228:231], a[92:95], v[164:167]
    ds_read_b64_tr_b16 a[204:205], v243 offset:32768
    ds_read_b64_tr_b16 a[206:207], v243 offset:36864
    v_mfma_f32_16x16x32_bf16 v[168:171], a[232:235], a[88:91], v[168:171]
    ds_read_b64_tr_b16 a[208:209], v244 offset:32768
    ds_read_b64_tr_b16 a[210:211], v244 offset:36864
    s_add_u32 s56, s56, 262144
    s_cmp_eq_u32 s29, s90
    s_cselect_b32 s56, s88, s56
    s_cselect_b32 s40, s52, s40
    s_cselect_b32 s41, s53, s41
    s_cselect_b32 s42, s54, s42
    s_add_u32 s58, s58, 32768
    s_and_b32 s58, s58, 131071
    s_mov_b32 m0, s58
    s_nop 0
    v_mfma_f32_16x16x32_bf16 v[172:175], a[232:235], a[92:95], v[172:175]
    ds_read_b64_tr_b16 a[212:213], v245 offset:32768
    ds_read_b64_tr_b16 a[214:215], v245 offset:36864
    v_mfma_f32_16x16x32_bf16 v[176:179], a[236:239], a[88:91], v[176:179]
    ds_read_b64_tr_b16 a[216:217], v246 offset:32768
    ds_read_b64_tr_b16 a[218:219], v246 offset:36864
    buffer_load_dwordx4 v232, s[40:43], s56 offen offset:0 lds
    v_mfma_f32_16x16x32_bf16 v[180:183], a[236:239], a[92:95], v[180:183]
    ds_read_b64_tr_b16 a[220:221], v247 offset:32768
    ds_read_b64_tr_b16 a[222:223], v247 offset:36864
    v_mfma_f32_16x16x32_bf16 v[184:187], a[240:243], a[88:91], v[184:187]
    v_mfma_f32_16x16x32_bf16 v[188:191], a[240:243], a[92:95], v[188:191]
    v_mfma_f32_16x16x32_bf16 v[192:195], a[244:247], a[88:91], v[192:195]
    buffer_load_dwordx4 a[20:23], v248, s[44:47], s57 offen offset:256 sc1
    v_mfma_f32_16x16x32_bf16 v[196:199], a[244:247], a[92:95], v[196:199]
    v_mfma_f32_16x16x32_bf16 v[200:203], a[248:251], a[88:91], v[200:203]
    v_mfma_f32_16x16x32_bf16 v[204:207], a[248:251], a[92:95], v[204:207]
    v_mfma_f32_16x16x32_bf16 v[208:211], a[252:255], a[88:91], v[208:211]
    buffer_load_dwordx4 v233, s[40:43], s56 offen offset:1024 lds
    v_mfma_f32_16x16x32_bf16 v[212:215], a[252:255], a[92:95], v[212:215]
    s_waitcnt vmcnt(57) lgkmcnt(0)
    v_mfma_f32_16x16x32_bf16 v[152:155], a[192:195], a[96:99], v[152:155]
    ds_read_b64_tr_b16 a[224:225], v240 offset:40960
    ds_read_b64_tr_b16 a[226:227], v240 offset:45056
    v_mfma_f32_16x16x32_bf16 v[156:159], a[192:195], a[100:103], v[156:159]
    ds_read_b64_tr_b16 a[228:229], v241 offset:40960
    ds_read_b64_tr_b16 a[230:231], v241 offset:45056
    v_mfma_f32_16x16x32_bf16 v[160:163], a[196:199], a[96:99], v[160:163]
    ds_read_b64_tr_b16 a[232:233], v242 offset:40960
    ds_read_b64_tr_b16 a[234:235], v242 offset:45056
    buffer_load_dwordx4 a[24:27], v248, s[44:47], s57 offen offset:2048 sc1
    v_mfma_f32_16x16x32_bf16 v[164:167], a[196:199], a[100:103], v[164:167]
    ds_read_b64_tr_b16 a[236:237], v243 offset:40960
    ds_read_b64_tr_b16 a[238:239], v243 offset:45056
    v_mfma_f32_16x16x32_bf16 v[168:171], a[200:203], a[96:99], v[168:171]
    ds_read_b64_tr_b16 a[240:241], v244 offset:40960
    ds_read_b64_tr_b16 a[242:243], v244 offset:45056
    v_mfma_f32_16x16x32_bf16 v[172:175], a[200:203], a[100:103], v[172:175]
    ds_read_b64_tr_b16 a[244:245], v245 offset:40960
    ds_read_b64_tr_b16 a[246:247], v245 offset:45056
    v_mfma_f32_16x16x32_bf16 v[176:179], a[204:207], a[96:99], v[176:179]
    ds_read_b64_tr_b16 a[248:249], v246 offset:40960
    ds_read_b64_tr_b16 a[250:251], v246 offset:45056
    buffer_load_dwordx4 v234, s[40:43], s56 offen offset:2048 lds
    v_mfma_f32_16x16x32_bf16 v[180:183], a[204:207], a[100:103], v[180:183]
    ds_read_b64_tr_b16 a[252:253], v247 offset:40960
    ds_read_b64_tr_b16 a[254:255], v247 offset:45056
    v_mfma_f32_16x16x32_bf16 v[184:187], a[208:211], a[96:99], v[184:187]
    v_mfma_f32_16x16x32_bf16 v[188:191], a[208:211], a[100:103], v[188:191]
    v_mfma_f32_16x16x32_bf16 v[192:195], a[212:215], a[96:99], v[192:195]
    buffer_load_dwordx4 a[28:31], v248, s[44:47], s57 offen offset:2304 sc1
    s_add_u32 s57, s57, 4096
    v_mfma_f32_16x16x32_bf16 v[196:199], a[212:215], a[100:103], v[196:199]
    v_mfma_f32_16x16x32_bf16 v[200:203], a[216:219], a[96:99], v[200:203]
    v_mfma_f32_16x16x32_bf16 v[204:207], a[216:219], a[100:103], v[204:207]
    v_mfma_f32_16x16x32_bf16 v[208:211], a[220:223], a[96:99], v[208:211]
    buffer_load_dwordx4 v235, s[40:43], s56 offen offset:3072 lds
    v_mfma_f32_16x16x32_bf16 v[212:215], a[220:223], a[100:103], v[212:215]
    s_waitcnt vmcnt(57) lgkmcnt(0)
    v_mfma_f32_16x16x32_bf16 v[152:155], a[224:227], a[104:107], v[152:155]
    ds_read_b64_tr_b16 a[192:193], v240 offset:49152
    ds_read_b64_tr_b16 a[194:195], v240 offset:53248
    v_mfma_f32_16x16x32_bf16 v[156:159], a[224:227], a[108:111], v[156:159]
    ds_read_b64_tr_b16 a[196:197], v241 offset:49152
    ds_read_b64_tr_b16 a[198:199], v241 offset:53248
    v_mfma_f32_16x16x32_bf16 v[160:163], a[228:231], a[104:107], v[160:163]
    ds_read_b64_tr_b16 a[200:201], v242 offset:49152
    ds_read_b64_tr_b16 a[202:203], v242 offset:53248
    buffer_load_dwordx4 a[32:35], v248, s[44:47], s57 offen offset:0 sc1
    v_mfma_f32_16x16x32_bf16 v[164:167], a[228:231], a[108:111], v[164:167]
    ds_read_b64_tr_b16 a[204:205], v243 offset:49152
    ds_read_b64_tr_b16 a[206:207], v243 offset:53248
    v_mfma_f32_16x16x32_bf16 v[168:171], a[232:235], a[104:107], v[168:171]
    ds_read_b64_tr_b16 a[208:209], v244 offset:49152
    ds_read_b64_tr_b16 a[210:211], v244 offset:53248
    v_mfma_f32_16x16x32_bf16 v[172:175], a[232:235], a[108:111], v[172:175]
    ds_read_b64_tr_b16 a[212:213], v245 offset:49152
    ds_read_b64_tr_b16 a[214:215], v245 offset:53248
    v_mfma_f32_16x16x32_bf16 v[176:179], a[236:239], a[104:107], v[176:179]
    ds_read_b64_tr_b16 a[216:217], v246 offset:49152
    ds_read_b64_tr_b16 a[218:219], v246 offset:53248
    s_add_u32 m0, s58, 4096
    s_nop 0
    buffer_load_dwordx4 v236, s[40:43], s56 offen offset:0 lds
    v_mfma_f32_16x16x32_bf16 v[180:183], a[236:239], a[108:111], v[180:183]
    ds_read_b64_tr_b16 a[220:221], v247 offset:49152
    ds_read_b64_tr_b16 a[222:223], v247 offset:53248
    v_mfma_f32_16x16x32_bf16 v[184:187], a[240:243], a[104:107], v[184:187]
    v_mfma_f32_16x16x32_bf16 v[188:191], a[240:243], a[108:111], v[188:191]
    v_mfma_f32_16x16x32_bf16 v[192:195], a[244:247], a[104:107], v[192:195]
    buffer_load_dwordx4 a[36:39], v248, s[44:47], s57 offen offset:256 sc1
    v_mfma_f32_16x16x32_bf16 v[196:199], a[244:247], a[108:111], v[196:199]
    v_mfma_f32_16x16x32_bf16 v[200:203], a[248:251], a[104:107], v[200:203]
    v_mfma_f32_16x16x32_bf16 v[204:207], a[248:251], a[108:111], v[204:207]
    v_mfma_f32_16x16x32_bf16 v[208:211], a[252:255], a[104:107], v[208:211]
    buffer_load_dwordx4 v237, s[40:43], s56 offen offset:1024 lds
    v_mfma_f32_16x16x32_bf16 v[212:215], a[252:255], a[108:111], v[212:215]
    s_waitcnt vmcnt(57) lgkmcnt(0)
    v_mfma_f32_16x16x32_bf16 v[152:155], a[192:195], a[112:115], v[152:155]
    ds_read_b64_tr_b16 a[224:225], v240 offset:57344
    ds_read_b64_tr_b16 a[226:227], v240 offset:61440
    v_mfma_f32_16x16x32_bf16 v[156:159], a[192:195], a[116:119], v[156:159]
    ds_read_b64_tr_b16 a[228:229], v241 offset:57344
    ds_read_b64_tr_b16 a[230:231], v241 offset:61440
    v_mfma_f32_16x16x32_bf16 v[160:163], a[196:199], a[112:115], v[160:163]
    ds_read_b64_tr_b16 a[232:233], v242 offset:57344
    ds_read_b64_tr_b16 a[234:235], v242 offset:61440
    buffer_load_dwordx4 a[40:43], v248, s[44:47], s57 offen offset:2048 sc1
    v_mfma_f32_16x16x32_bf16 v[164:167], a[196:199], a[116:119], v[164:167]
    ds_read_b64_tr_b16 a[236:237], v243 offset:57344
    ds_read_b64_tr_b16 a[238:239], v243 offset:61440
    v_mfma_f32_16x16x32_bf16 v[168:171], a[200:203], a[112:115], v[168:171]
    ds_read_b64_tr_b16 a[240:241], v244 offset:57344
    ds_read_b64_tr_b16 a[242:243], v244 offset:61440
    v_mfma_f32_16x16x32_bf16 v[172:175], a[200:203], a[116:119], v[172:175]
    ds_read_b64_tr_b16 a[244:245], v245 offset:57344
    ds_read_b64_tr_b16 a[246:247], v245 offset:61440
    v_mfma_f32_16x16x32_bf16 v[176:179], a[204:207], a[112:115], v[176:179]
    ds_read_b64_tr_b16 a[248:249], v246 offset:57344
    ds_read_b64_tr_b16 a[250:251], v246 offset:61440
    buffer_load_dwordx4 v238, s[40:43], s56 offen offset:2048 lds
    v_mfma_f32_16x16x32_bf16 v[180:183], a[204:207], a[116:119], v[180:183]
    ds_read_b64_tr_b16 a[252:253], v247 offset:57344
    ds_read_b64_tr_b16 a[254:255], v247 offset:61440
    v_mfma_f32_16x16x32_bf16 v[184:187], a[208:211], a[112:115], v[184:187]
    v_mfma_f32_16x16x32_bf16 v[188:191], a[208:211], a[116:119], v[188:191]
    v_mfma_f32_16x16x32_bf16 v[192:195], a[212:215], a[112:115], v[192:195]
    buffer_load_dwordx4 a[44:47], v248, s[44:47], s57 offen offset:2304 sc1
    s_add_u32 s57, s57, 4096
    v_mfma_f32_16x16x32_bf16 v[196:199], a[212:215], a[116:119], v[196:199]
    v_mfma_f32_16x16x32_bf16 v[200:203], a[216:219], a[112:115], v[200:203]
    v_mfma_f32_16x16x32_bf16 v[204:207], a[216:219], a[116:119], v[204:207]
    v_mfma_f32_16x16x32_bf16 v[208:211], a[220:223], a[112:115], v[208:211]
    buffer_load_dwordx4 v239, s[40:43], s56 offen offset:3072 lds
    v_mfma_f32_16x16x32_bf16 v[212:215], a[220:223], a[116:119], v[212:215]
    s_waitcnt vmcnt(32) lgkmcnt(0)
    s_barrier
    v_mfma_f32_16x16x32_bf16 v[152:155], a[224:227], a[120:123], v[152:155]
    v_xor_b32 v240, 0x10000, v240
    v_xor_b32 v241, 0x10000, v241
    v_xor_b32 v242, 0x10000, v242
    v_mfma_f32_16x16x32_bf16 v[156:159], a[224:227], a[124:127], v[156:159]
    v_xor_b32 v243, 0x10000, v243
    v_xor_b32 v244, 0x10000, v244
    v_xor_b32 v245, 0x10000, v245
    v_mfma_f32_16x16x32_bf16 v[160:163], a[228:231], a[120:123], v[160:163]
    v_xor_b32 v246, 0x10000, v246
    v_xor_b32 v247, 0x10000, v247
    ds_read_b64_tr_b16 a[192:193], v240 offset:0
    buffer_load_dwordx4 a[48:51], v248, s[44:47], s57 offen offset:0 sc1
    v_mfma_f32_16x16x32_bf16 v[164:167], a[228:231], a[124:127], v[164:167]
    ds_read_b64_tr_b16 a[194:195], v240 offset:4096
    ds_read_b64_tr_b16 a[196:197], v241 offset:0
    ds_read_b64_tr_b16 a[198:199], v241 offset:4096
    v_mfma_f32_16x16x32_bf16 v[168:171], a[232:235], a[120:123], v[168:171]
    ds_read_b64_tr_b16 a[200:201], v242 offset:0
    ds_read_b64_tr_b16 a[202:203], v242 offset:4096
    ds_read_b64_tr_b16 a[204:205], v243 offset:0
    s_add_u32 s56, s56, 262144
    s_add_u32 s58, s58, 32768
    s_and_b32 s58, s58, 131071
    s_mov_b32 m0, s58
    s_nop 0
    v_mfma_f32_16x16x32_bf16 v[172:175], a[232:235], a[124:127], v[172:175]
    ds_read_b64_tr_b16 a[206:207], v243 offset:4096
    ds_read_b64_tr_b16 a[208:209], v244 offset:0
    ds_read_b64_tr_b16 a[210:211], v244 offset:4096
    v_mfma_f32_16x16x32_bf16 v[176:179], a[236:239], a[120:123], v[176:179]
    ds_read_b64_tr_b16 a[212:213], v245 offset:0
    ds_read_b64_tr_b16 a[214:215], v245 offset:4096
    ds_read_b64_tr_b16 a[216:217], v246 offset:0
    buffer_load_dwordx4 v232, s[40:43], s56 offen offset:0 lds
    v_mfma_f32_16x16x32_bf16 v[180:183], a[236:239], a[124:127], v[180:183]
    ds_read_b64_tr_b16 a[218:219], v246 offset:4096
    ds_read_b64_tr_b16 a[220:221], v247 offset:0
    ds_read_b64_tr_b16 a[222:223], v247 offset:4096
    v_mfma_f32_16x16x32_bf16 v[184:187], a[240:243], a[120:123], v[184:187]
    v_mfma_f32_16x16x32_bf16 v[188:191], a[240:243], a[124:127], v[188:191]
    v_mfma_f32_16x16x32_bf16 v[192:195], a[244:247], a[120:123], v[192:195]
    buffer_load_dwordx4 a[52:55], v248, s[44:47], s57 offen offset:256 sc1
    v_mfma_f32_16x16x32_bf16 v[196:199], a[244:247], a[124:127], v[196:199]
    v_mfma_f32_16x16x32_bf16 v[200:203], a[248:251], a[120:123], v[200:203]
    v_mfma_f32_16x16x32_bf16 v[204:207], a[248:251], a[124:127], v[204:207]
    v_mfma_f32_16x16x32_bf16 v[208:211], a[252:255], a[120:123], v[208:211]
    buffer_load_dwordx4 v233, s[40:43], s56 offen offset:1024 lds
    v_mfma_f32_16x16x32_bf16 v[212:215], a[252:255], a[124:127], v[212:215]
    s_sub_u32 s29, s29, 1
    s_cmp_lg_u32 s29, 0
    s_cbranch_scc1 L_p2_gloop
    s_branch L_p2_gdone
L_p2_asw:
    v_readlane_b32 s6, v221, 0
    s_nop 3
    s_cmp_ge_u32 s6, 128
    s_cbranch_scc1 L_p2_asw2
    s_mov_b32 s7, 0x8000
L_p2_spino:
    buffer_load_dword v221, v222, s[48:51], 0 offen sc1
    s_waitcnt vmcnt(0)
    v_readlane_b32 s6, v221, 0
    s_sub_u32 s7, s7, 1
    s_cmp_eq_u32 s7, 0
    s_cbranch_scc1 L_p2_spuno
    s_cmp_ge_u32 s6, 128
    s_cbranch_scc1 L_p2_spuno
    s_sleep 4
    s_branch L_p2_spino
L_p2_spuno:
L_p2_asw2:
    s_mov_b32 s57, s89
    s_branch L_p2_aback
L_p2_sig:
    s_mov_b32 s91, 0
    s_waitcnt vmcnt(33)
    s_lshl_b32 s6, s33, 7
    v_mov_b32 v4, 1
    s_mov_b64 s[36:37], exec
    s_mov_b64 exec, 1
    buffer_atomic_add v4, off, s[48:51], s6
    s_mov_b64 exec, s[36:37]
    s_branch L_p2_sigback
L_p2_gdone:
    s_lshl_b32 s6, s62, 3
    s_add_u32 s6, s6, s63
    s_add_u32 s36, s34, 39845888
    s_addc_u32 s37, s35, 0
    s_mul_i32 s7, s6, 69888
    s_lshl_b32 s38, s30, 13
    s_add_u32 s7, s7, s38
    s_add_u32 s36, s36, s7
    s_addc_u32 s37, s37, 0
    s_mov_b32 s8, s36
    s_and_b32 s9, s37, 0xffff
    s_mov_b32 s10, 65536
    s_mov_b32 s11, 0x00020000
    s_lshl_b32 s38, s61, 15
    s_xor_b32 s39, s38, 0x8000
    s_add_u32 s6, s6, 8
    s_lshl_b32 s6, s6, 7
    s_lshl_b32 s7, s61, 2
    s_add_u32 s6, s6, s7
    s_cmp_eq_u32 s61, 0
    s_cbranch_scc0 L_p2_fin1
    buffer_store_dwordx4 v[184:187], v2, s[8:11], s38 offen offset:0 sc1
    buffer_store_dwordx4 v[188:191], v2, s[8:11], s38 offen offset:1024 sc1
    buffer_store_dwordx4 v[192:195], v2, s[8:11], s38 offen offset:2048 sc1
    buffer_store_dwordx4 v[196:199], v2, s[8:11], s38 offen offset:3072 sc1
    s_add_u32 s38, s38, 4096
    buffer_store_dwordx4 v[200:203], v2, s[8:11], s38 offen offset:0 sc1
    buffer_store_dwordx4 v[204:207], v2, s[8:11], s38 offen offset:1024 sc1
    buffer_store_dwordx4 v[208:211], v2, s[8:11], s38 offen offset:2048 sc1
    buffer_store_dwordx4 v[212:215], v2, s[8:11], s38 offen offset:3072 sc1
    v_and_b32 v5, 15, v1
    v_lshrrev_b32 v6, 4, v1
    v_lshlrev_b32 v7, 8, v5
    s_lshl_b32 s7, s30, 13
    v_add_u32 v7, s7, v7
    v_and_b32 v5, 7, v5
    v_add_u32 v64, 0, v6
    v_xor_b32 v64, v64, v5
    v_lshl_add_u32 v64, v64, 4, v7
    v_add_u32 v65, 0, v6
    v_xor_b32 v65, v65, v5
    v_lshl_add_u32 v65, v65, 4, v7
    v_add_u32 v65, 4096, v65
    v_add_u32 v66, 4, v6
    v_xor_b32 v66, v66, v5
    v_lshl_add_u32 v66, v66, 4, v7
    v_add_u32 v67, 4, v6
    v_xor_b32 v67, v67, v5
    v_lshl_add_u32 v67, v67, 4, v7
    v_add_u32 v67, 4096, v67
    v_add_u32 v68, 8, v6
    v_xor_b32 v68, v68, v5
    v_lshl_add_u32 v68, v68, 4, v7
    v_add_u32 v69, 8, v6
    v_xor_b32 v69, v69, v5
    v_lshl_add_u32 v69, v69, 4, v7
    v_add_u32 v69, 4096, v69
    v_add_u32 v70, 12, v6
    v_xor_b32 v70, v70, v5
    v_lshl_add_u32 v70, v70, 4, v7
    v_add_u32 v71, 12, v6
    v_xor_b32 v71, v71, v5
    v_lshl_add_u32 v71, v71, 4, v7
    v_add_u32 v71, 4096, v71
    v_lshrrev_b32 v5, 3, v1
    v_and_b32 v6, 7, v1
    v_lshlrev_b32 v6, 1, v6
    v_xor_b32 v6, v6, v5
    v_lshlrev_b32 v7, 8, v5
    v_add_u32 v7, s7, v7
    v_lshl_add_u32 v72, v6, 4, v7
    v_xor_b32 v73, 16, v72
    s_waitcnt vmcnt(0)
    s_barrier
    s_cmp_eq_u32 s30, 0
    s_cbranch_scc0 L_p2_nf0
    v_mov_b32 v4, 1
    s_mov_b64 exec, 1
    buffer_store_dword v4, off, s[48:51], s6 sc1
    s_mov_b64 exec, -1
L_p2_nf0:
    s_mov_b32 s7, 0x8000
L_p2_spinp0:
    buffer_load_dword v221, v222, s[48:51], 0 offen sc1
    s_waitcnt vmcnt(0)
    v_readlane_b32 s36, v221, 1
    s_sub_u32 s7, s7, 1
    s_cmp_eq_u32 s7, 0
    s_cbranch_scc1 L_p2_spunp0
    s_cmp_ge_u32 s36, 1
    s_cbranch_scc1 L_p2_spunp0
    s_sleep 4
    s_branch L_p2_spinp0
L_p2_spunp0:
    buffer_load_dwordx4 v[32:35], v2, s[8:11], s39 offen offset:0 sc1
    buffer_load_dwordx4 v[36:39], v2, s[8:11], s39 offen offset:1024 sc1
    buffer_load_dwordx4 v[40:43], v2, s[8:11], s39 offen offset:2048 sc1
    buffer_load_dwordx4 v[44:47], v2, s[8:11], s39 offen offset:3072 sc1
    s_add_u32 s39, s39, 4096
    buffer_load_dwordx4 v[48:51], v2, s[8:11], s39 offen offset:0 sc1
    buffer_load_dwordx4 v[52:55], v2, s[8:11], s39 offen offset:1024 sc1
    buffer_load_dwordx4 v[56:59], v2, s[8:11], s39 offen offset:2048 sc1
    buffer_load_dwordx4 v[60:63], v2, s[8:11], s39 offen offset:3072 sc1
    s_waitcnt vmcnt(7)
    v_pk_add_f32 v[152:153], v[152:153], v[32:33]
    v_pk_add_f32 v[154:155], v[154:155], v[34:35]
    ds_write_b128 v64, v[152:155]
    s_waitcnt vmcnt(6)
    v_pk_add_f32 v[156:157], v[156:157], v[36:37]
    v_pk_add_f32 v[158:159], v[158:159], v[38:39]
    ds_write_b128 v65, v[156:159]
    s_waitcnt vmcnt(5)
    v_pk_add_f32 v[160:161], v[160:161], v[40:41]
    v_pk_add_f32 v[162:163], v[162:163], v[42:43]
    ds_write_b128 v66, v[160:163]
    s_waitcnt vmcnt(4)
    v_pk_add_f32 v[164:165], v[164:165], v[44:45]
    v_pk_add_f32 v[166:167], v[166:167], v[46:47]
    ds_write_b128 v67, v[164:167]
    s_waitcnt vmcnt(3)
    v_pk_add_f32 v[168:169], v[168:169], v[48:49]
    v_pk_add_f32 v[170:171], v[170:171], v[50:51]
    ds_write_b128 v68, v[168:171]
    s_waitcnt vmcnt(2)
    v_pk_add_f32 v[172:173], v[172:173], v[52:53]
    v_pk_add_f32 v[174:175], v[174:175], v[54:55]
    ds_write_b128 v69, v[172:175]
    s_waitcnt vmcnt(1)
    v_pk_add_f32 v[176:177], v[176:177], v[56:57]
    v_pk_add_f32 v[178:179], v[178:179], v[58:59]
    ds_write_b128 v70, v[176:179]
    s_waitcnt vmcnt(0)
    v_pk_add_f32 v[180:181], v[180:181], v[60:61]
    v_pk_add_f32 v[182:183], v[182:183], v[62:63]
    ds_write_b128 v71, v[180:183]
    s_waitcnt lgkmcnt(0)
    ds_read_b128 v[32:35], v72 offset:0
    ds_read_b128 v[36:39], v73 offset:0
    ds_read_b128 v[40:43], v72 offset:2048
    ds_read_b128 v[44:47], v73 offset:2048
    ds_read_b128 v[48:51], v72 offset:4096
    ds_read_b128 v[52:55], v73 offset:4096
    ds_read_b128 v[56:59], v72 offset:6144
    ds_read_b128 v[60:63], v73 offset:6144
    s_mov_b32 s39, 0xffff0000
    s_mov_b32 s7, s95
    s_waitcnt lgkmcnt(6)
    v_lshlrev_b32 v24, 16, v112
    v_and_b32 v25, s39, v112
    v_pk_add_f32 v[32:33], v[32:33], v[24:25]
    v_lshlrev_b32 v24, 16, v113
    v_and_b32 v25, s39, v113
    v_pk_add_f32 v[34:35], v[34:35], v[24:25]
    v_lshlrev_b32 v24, 16, v114
    v_and_b32 v25, s39, v114
    v_pk_add_f32 v[36:37], v[36:37], v[24:25]
    v_lshlrev_b32 v24, 16, v115
    v_and_b32 v25, s39, v115
    v_pk_add_f32 v[38:39], v[38:39], v[24:25]
    v_cvt_pk_bf16_f32 v112, v32, v33
    v_cvt_pk_bf16_f32 v113, v34, v35
    v_cvt_pk_bf16_f32 v114, v36, v37
    v_cvt_pk_bf16_f32 v115, v38, v39
    buffer_store_dwordx4 v[112:115], v3, s[16:19], s7 offen sc1
    s_add_u32 s7, s7, 16384
    s_waitcnt lgkmcnt(4)
    v_lshlrev_b32 v24, 16, v116
    v_and_b32 v25, s39, v116
    v_pk_add_f32 v[40:41], v[40:41], v[24:25]
    v_lshlrev_b32 v24, 16, v117
    v_and_b32 v25, s39, v117
    v_pk_add_f32 v[42:43], v[42:43], v[24:25]
    v_lshlrev_b32 v24, 16, v118
    v_and_b32 v25, s39, v118
    v_pk_add_f32 v[44:45], v[44:45], v[24:25]
    v_lshlrev_b32 v24, 16, v119
    v_and_b32 v25, s39, v119
    v_pk_add_f32 v[46:47], v[46:47], v[24:25]
    v_cvt_pk_bf16_f32 v116, v40, v41
    v_cvt_pk_bf16_f32 v117, v42, v43
    v_cvt_pk_bf16_f32 v118, v44, v45
    v_cvt_pk_bf16_f32 v119, v46, v47
    buffer_store_dwordx4 v[116:119], v3, s[16:19], s7 offen sc1
    s_add_u32 s7, s7, 16384
    s_waitcnt lgkmcnt(2)
    v_lshlrev_b32 v24, 16, v120
    v_and_b32 v25, s39, v120
    v_pk_add_f32 v[48:49], v[48:49], v[24:25]
    v_lshlrev_b32 v24, 16, v121
    v_and_b32 v25, s39, v121
    v_pk_add_f32 v[50:51], v[50:51], v[24:25]
    v_lshlrev_b32 v24, 16, v122
    v_and_b32 v25, s39, v122
    v_pk_add_f32 v[52:53], v[52:53], v[24:25]
    v_lshlrev_b32 v24, 16, v123
    v_and_b32 v25, s39, v123
    v_pk_add_f32 v[54:55], v[54:55], v[24:25]
    v_cvt_pk_bf16_f32 v120, v48, v49
    v_cvt_pk_bf16_f32 v121, v50, v51
    v_cvt_pk_bf16_f32 v122, v52, v53
    v_cvt_pk_bf16_f32 v123, v54, v55
    buffer_store_dwordx4 v[120:123], v3, s[16:19], s7 offen sc1
    s_add_u32 s7, s7, 16384
    s_waitcnt lgkmcnt(0)
    v_lshlrev_b32 v24, 16, v124
    v_and_b32 v25, s39, v124
    v_pk_add_f32 v[56:57], v[56:57], v[24:25]
    v_lshlrev_b32 v24, 16, v125
    v_and_b32 v25, s39, v125
    v_pk_add_f32 v[58:59], v[58:59], v[24:25]
    v_lshlrev_b32 v24, 16, v126
    v_and_b32 v25, s39, v126
    v_pk_add_f32 v[60:61], v[60:61], v[24:25]
    v_lshlrev_b32 v24, 16, v127
    v_and_b32 v25, s39, v127
    v_pk_add_f32 v[62:63], v[62:63], v[24:25]
    v_cvt_pk_bf16_f32 v124, v56, v57
    v_cvt_pk_bf16_f32 v125, v58, v59
    v_cvt_pk_bf16_f32 v126, v60, v61
    v_cvt_pk_bf16_f32 v127, v62, v63
    buffer_store_dwordx4 v[124:127], v3, s[16:19], s7 offen sc1
    s_branch L_p2_fin
L_p2_fin1:
    buffer_store_dwordx4 v[152:155], v2, s[8:11], s38 offen offset:0 sc1
    buffer_store_dwordx4 v[156:159], v2, s[8:11], s38 offen offset:1024 sc1
    buffer_store_dwordx4 v[160:163], v2, s[8:11], s38 offen offset:2048 sc1
    buffer_store_dwordx4 v[164:167], v2, s[8:11], s38 offen offset:3072 sc1
    s_add_u32 s38, s38, 4096
    buffer_store_dwordx4 v[168:171], v2, s[8:11], s38 offen offset:0 sc1
    buffer_store_dwordx4 v[172:175], v2, s[8:11], s38 offen offset:1024 sc1
    buffer_store_dwordx4 v[176:179], v2, s[8:11], s38 offen offset:2048 sc1
    buffer_store_dwordx4 v[180:183], v2, s[8:11], s38 offen offset:3072 sc1
    v_and_b32 v5, 15, v1
    v_lshrrev_b32 v6, 4, v1
    v_lshlrev_b32 v7, 8, v5
    s_lshl_b32 s7, s30, 13
    v_add_u32 v7, s7, v7
    v_and_b32 v5, 7, v5
    v_add_u32 v64, 0, v6
    v_xor_b32 v64, v64, v5
    v_lshl_add_u32 v64, v64, 4, v7
    v_add_u32 v65, 0, v6
    v_xor_b32 v65, v65, v5
    v_lshl_add_u32 v65, v65, 4, v7
    v_add_u32 v65, 4096, v65
    v_add_u32 v66, 4, v6
    v_xor_b32 v66, v66, v5
    v_lshl_add_u32 v66, v66, 4, v7
    v_add_u32 v67, 4, v6
    v_xor_b32 v67, v67, v5
    v_lshl_add_u32 v67, v67, 4, v7
    v_add_u32 v67, 4096, v67
    v_add_u32 v68, 8, v6
    v_xor_b32 v68, v68, v5
    v_lshl_add_u32 v68, v68, 4, v7
    v_add_u32 v69, 8, v6
    v_xor_b32 v69, v69, v5
    v_lshl_add_u32 v69, v69, 4, v7
    v_add_u32 v69, 4096, v69
    v_add_u32 v70, 12, v6
    v_xor_b32 v70, v70, v5
    v_lshl_add_u32 v70, v70, 4, v7
    v_add_u32 v71, 12, v6
    v_xor_b32 v71, v71, v5
    v_lshl_add_u32 v71, v71, 4, v7
    v_add_u32 v71, 4096, v71
    v_lshrrev_b32 v5, 3, v1
    v_and_b32 v6, 7, v1
    v_lshlrev_b32 v6, 1, v6
    v_xor_b32 v6, v6, v5
    v_lshlrev_b32 v7, 8, v5
    v_add_u32 v7, s7, v7
    v_lshl_add_u32 v72, v6, 4, v7
    v_xor_b32 v73, 16, v72
    s_waitcnt vmcnt(0)
    s_barrier
    s_cmp_eq_u32 s30, 0
    s_cbranch_scc0 L_p2_nf1
    v_mov_b32 v4, 1
    s_mov_b64 exec, 1
    buffer_store_dword v4, off, s[48:51], s6 sc1
    s_mov_b64 exec, -1
L_p2_nf1:
    s_mov_b32 s7, 0x8000
L_p2_spinp1:
    buffer_load_dword v221, v222, s[48:51], 0 offen sc1
    s_waitcnt vmcnt(0)
    v_readlane_b32 s36, v221, 1
    s_sub_u32 s7, s7, 1
    s_cmp_eq_u32 s7, 0
    s_cbranch_scc1 L_p2_spunp1
    s_cmp_ge_u32 s36, 1
    s_cbranch_scc1 L_p2_spunp1
    s_sleep 4
    s_branch L_p2_spinp1
L_p2_spunp1:
    buffer_load_dwordx4 v[32:35], v2, s[8:11], s39 offen offset:0 sc1
    buffer_load_dwordx4 v[36:39], v2, s[8:11], s39 offen offset:1024 sc1
    buffer_load_dwordx4 v[40:43], v2, s[8:11], s39 offen offset:2048 sc1
    buffer_load_dwordx4 v[44:47], v2, s[8:11], s39 offen offset:3072 sc1
    s_add_u32 s39, s39, 4096
    buffer_load_dwordx4 v[48:51], v2, s[8:11], s39 offen offset:0 sc1
    buffer_load_dwordx4 v[52:55], v2, s[8:11], s39 offen offset:1024 sc1
    buffer_load_dwordx4 v[56:59], v2, s[8:11], s39 offen offset:2048 sc1
    buffer_load_dwordx4 v[60:63], v2, s[8:11], s39 offen offset:3072 sc1
    s_waitcnt vmcnt(7)
    v_pk_add_f32 v[184:185], v[184:185], v[32:33]
    v_pk_add_f32 v[186:187], v[186:187], v[34:35]
    ds_write_b128 v64, v[184:187]
    s_waitcnt vmcnt(6)
    v_pk_add_f32 v[188:189], v[188:189], v[36:37]
    v_pk_add_f32 v[190:191], v[190:191], v[38:39]
    ds_write_b128 v65, v[188:191]
    s_waitcnt vmcnt(5)
    v_pk_add_f32 v[192:193], v[192:193], v[40:41]
    v_pk_add_f32 v[194:195], v[194:195], v[42:43]
    ds_write_b128 v66, v[192:195]
    s_waitcnt vmcnt(4)
    v_pk_add_f32 v[196:197], v[196:197], v[44:45]
    v_pk_add_f32 v[198:199], v[198:199], v[46:47]
    ds_write_b128 v67, v[196:199]
    s_waitcnt vmcnt(3)
    v_pk_add_f32 v[200:201], v[200:201], v[48:49]
    v_pk_add_f32 v[202:203], v[202:203], v[50:51]
    ds_write_b128 v68, v[200:203]
    s_waitcnt vmcnt(2)
    v_pk_add_f32 v[204:205], v[204:205], v[52:53]
    v_pk_add_f32 v[206:207], v[206:207], v[54:55]
    ds_write_b128 v69, v[204:207]
    s_waitcnt vmcnt(1)
    v_pk_add_f32 v[208:209], v[208:209], v[56:57]
    v_pk_add_f32 v[210:211], v[210:211], v[58:59]
    ds_write_b128 v70, v[208:211]
    s_waitcnt vmcnt(0)
    v_pk_add_f32 v[212:213], v[212:213], v[60:61]
    v_pk_add_f32 v[214:215], v[214:215], v[62:63]
    ds_write_b128 v71, v[212:215]
    s_waitcnt lgkmcnt(0)
    ds_read_b128 v[32:35], v72 offset:0
    ds_read_b128 v[36:39], v73 offset:0
    ds_read_b128 v[40:43], v72 offset:2048
    ds_read_b128 v[44:47], v73 offset:2048
    ds_read_b128 v[48:51], v72 offset:4096
    ds_read_b128 v[52:55], v73 offset:4096
    ds_read_b128 v[56:59], v72 offset:6144
    ds_read_b128 v[60:63], v73 offset:6144
    s_mov_b32 s39, 0xffff0000
    s_mov_b32 s7, s95
    s_waitcnt lgkmcnt(6)
    v_lshlrev_b32 v24, 16, v112
    v_and_b32 v25, s39, v112
    v_pk_add_f32 v[32:33], v[32:33], v[24:25]
    v_lshlrev_b32 v24, 16, v113
    v_and_b32 v25, s39, v113
    v_pk_add_f32 v[34:35], v[34:35], v[24:25]
    v_lshlrev_b32 v24, 16, v114
    v_and_b32 v25, s39, v114
    v_pk_add_f32 v[36:37], v[36:37], v[24:25]
    v_lshlrev_b32 v24, 16, v115
    v_and_b32 v25, s39, v115
    v_pk_add_f32 v[38:39], v[38:39], v[24:25]
    v_cvt_pk_bf16_f32 v112, v32, v33
    v_cvt_pk_bf16_f32 v113, v34, v35
    v_cvt_pk_bf16_f32 v114, v36, v37
    v_cvt_pk_bf16_f32 v115, v38, v39
    buffer_store_dwordx4 v[112:115], v3, s[16:19], s7 offen sc1
    s_add_u32 s7, s7, 16384
    s_waitcnt lgkmcnt(4)
    v_lshlrev_b32 v24, 16, v116
    v_and_b32 v25, s39, v116
    v_pk_add_f32 v[40:41], v[40:41], v[24:25]
    v_lshlrev_b32 v24, 16, v117
    v_and_b32 v25, s39, v117
    v_pk_add_f32 v[42:43], v[42:43], v[24:25]
    v_lshlrev_b32 v24, 16, v118
    v_and_b32 v25, s39, v118
    v_pk_add_f32 v[44:45], v[44:45], v[24:25]
    v_lshlrev_b32 v24, 16, v119
    v_and_b32 v25, s39, v119
    v_pk_add_f32 v[46:47], v[46:47], v[24:25]
    v_cvt_pk_bf16_f32 v116, v40, v41
    v_cvt_pk_bf16_f32 v117, v42, v43
    v_cvt_pk_bf16_f32 v118, v44, v45
    v_cvt_pk_bf16_f32 v119, v46, v47
    buffer_store_dwordx4 v[116:119], v3, s[16:19], s7 offen sc1
    s_add_u32 s7, s7, 16384
    s_waitcnt lgkmcnt(2)
    v_lshlrev_b32 v24, 16, v120
    v_and_b32 v25, s39, v120
    v_pk_add_f32 v[48:49], v[48:49], v[24:25]
    v_lshlrev_b32 v24, 16, v121
    v_and_b32 v25, s39, v121
    v_pk_add_f32 v[50:51], v[50:51], v[24:25]
    v_lshlrev_b32 v24, 16, v122
    v_and_b32 v25, s39, v122
    v_pk_add_f32 v[52:53], v[52:53], v[24:25]
    v_lshlrev_b32 v24, 16, v123
    v_and_b32 v25, s39, v123
    v_pk_add_f32 v[54:55], v[54:55], v[24:25]
    v_cvt_pk_bf16_f32 v120, v48, v49
    v_cvt_pk_bf16_f32 v121, v50, v51
    v_cvt_pk_bf16_f32 v122, v52, v53
    v_cvt_pk_bf16_f32 v123, v54, v55
    buffer_store_dwordx4 v[120:123], v3, s[16:19], s7 offen sc1
    s_add_u32 s7, s7, 16384
    s_waitcnt lgkmcnt(0)
    v_lshlrev_b32 v24, 16, v124
    v_and_b32 v25, s39, v124
    v_pk_add_f32 v[56:57], v[56:57], v[24:25]
    v_lshlrev_b32 v24, 16, v125
    v_and_b32 v25, s39, v125
    v_pk_add_f32 v[58:59], v[58:59], v[24:25]
    v_lshlrev_b32 v24, 16, v126
    v_and_b32 v25, s39, v126
    v_pk_add_f32 v[60:61], v[60:61], v[24:25]
    v_lshlrev_b32 v24, 16, v127
    v_and_b32 v25, s39, v127
    v_pk_add_f32 v[62:63], v[62:63], v[24:25]
    v_cvt_pk_bf16_f32 v124, v56, v57
    v_cvt_pk_bf16_f32 v125, v58, v59
    v_cvt_pk_bf16_f32 v126, v60, v61
    v_cvt_pk_bf16_f32 v127, v62, v63
    buffer_store_dwordx4 v[124:127], v3, s[16:19], s7 offen sc1
L_p2_fin:
L_end:
    s_endpgm
.section .rodata,"a"
.p2align 6
.amdhsa_kernel parallel_sum__softmax_full_mha__dense_activation_silu__prompt_kernel
  .amdhsa_next_free_vgpr 512
  .amdhsa_next_free_sgpr 102
  .amdhsa_accum_offset 256
  .amdhsa_group_segment_fixed_size 0
  .amdhsa_kernarg_size 72
  .amdhsa_user_sgpr_count 2
  .amdhsa_user_sgpr_kernarg_segment_ptr 1
  .amdhsa_system_sgpr_workgroup_id_x 1
  .amdhsa_float_denorm_mode_32 3
.end_amdhsa_kernel
```
